```python
import torch

def _softmax(x, axis=-1):
    return torch.softmax(x, dim=axis)
def _gelu(x):
    return torch.nn.functional.gelu(x, approximate="tanh")
def _silu(x):
    return torch.nn.functional.silu(x)
def _sigmoid(x):
    return torch.sigmoid(x)
def _layernorm(x, axis=-1, eps=1e-5):
    m = x.mean(dim=axis, keepdim=True)
    v = x.var(dim=axis, keepdim=True, unbiased=False)
    return (x - m) / torch.sqrt(v + eps)
def _scatter_add(tgt, idx, src, axis=0):
    return tgt.clone().index_add_(axis, idx, src)
def _segment_sum(src, seg, n):
    out = torch.zeros((n,) + src.shape[1:], dtype=src.dtype)
    return out.index_add_(0, seg, src)
def _pad(x, pw):
    flat = tuple(v for pair in reversed(pw) for v in pair)
    return torch.nn.functional.pad(x, flat)

kernel_name = 'interleave_layers__gqa_block_cached__glu_gated_glu__decode'

def setup_inputs():

    _w = (lambda a: (lambda t: t.to(torch.bfloat16) if t.is_floating_point() else t)(torch.as_tensor(a)))
    def _A_setup():
        B, Sq, D = 8, 1, 512
        Hq, Hkv, Sk, Dh = 32, 32, 4096, 128
        assert Hq % Hkv == 0, (Hq, Hkv)
        return {
            "x": _w((lambda *s: torch.randn(*s, dtype=torch.bfloat16) * 0.05)(B, Sq, D)),
            "k_cache": _w((lambda *s: torch.randn(*s, dtype=torch.bfloat16) * 1.6)(B, Hkv, Sk, Dh)),
            "v_cache": _w((lambda *s: torch.randn(*s, dtype=torch.bfloat16) * 1.6)(B, Hkv, Sk, Dh)),
            "wq": _w((lambda *s: torch.randn(*s, dtype=torch.bfloat16) * 1.6)(D, Hq * Dh) * (D ** -0.5)),
            "wo": _w((lambda *s: torch.randn(*s, dtype=torch.bfloat16) * 1.6)(Hq * Dh, D) * ((Hq * Dh) ** -0.5)),
        }
    _A_in = _A_setup()

    def _B_setup():
        B, S, D, F = 8, 1, 512, 1376
        return {
            "x": _w((lambda *s: torch.randn(*s, dtype=torch.bfloat16) * 0.05)(B, S, D)),
            "w_gate": _w((lambda *s: torch.randn(*s, dtype=torch.bfloat16) * 0.05)(D, F)),
            "w_up": _w((lambda *s: torch.randn(*s, dtype=torch.bfloat16) * 0.05)(D, F)),
            "w_down": _w((lambda *s: torch.randn(*s, dtype=torch.bfloat16) * 0.05)(F, D)),
        }
    _B_in = _B_setup()

    return {
        "A_x": _A_in["x"],
        "A_k_cache": _A_in["k_cache"],
        "A_v_cache": _A_in["v_cache"],
        "A_wq": _A_in["wq"],
        "A_wo": _A_in["wo"],
        "B_x": _B_in["x"],
        "B_w_gate": _B_in["w_gate"],
        "B_w_up": _B_in["w_up"],
        "B_w_down": _B_in["w_down"],
    }

def reference(A_x, A_k_cache, A_v_cache, A_wq, A_wo, B_x, B_w_gate, B_w_up, B_w_down):
    def _A_ref(x, k_cache, v_cache, wq, wo):
        B, Sq, D = x.shape
        Hq, Dh = 32, 128
        Hkv = k_cache.shape[1]
        rep = Hq // Hkv
        q = (lambda x, *d: x.permute(*d))((x @ wq).reshape(B, Sq, Hq, Dh), 0, 2, 1, 3)
        k = (lambda x, n, axis: torch.repeat_interleave(x, n, dim=axis))(k_cache, rep, axis=1)
        v = (lambda x, n, axis: torch.repeat_interleave(x, n, dim=axis))(v_cache, rep, axis=1)
        scores = torch.einsum("bhqd,bhkd->bhqk", q, k) * (Dh ** -0.5)
        p = _softmax(scores, axis=-1)
        o = torch.einsum("bhqk,bhkd->bhqd", p, v)
        return (lambda x, *d: x.permute(*d))(o, 0, 2, 1, 3).reshape(B, Sq, Hq * Dh) @ wo

    def _B_ref(x, w_gate, w_up, w_down):
        g = torch.einsum("bsd,df->bsf", x, w_gate)
        u = torch.einsum("bsd,df->bsf", x, w_up)
        h = _sigmoid(g) * u
        return torch.einsum("bsf,fd->bsd", h, w_down)

    x = A_x
    x = x + _A_ref(_layernorm(x, axis=-1), A_k_cache, A_v_cache, A_wq, A_wo)
    x = x + _B_ref(_layernorm(x, axis=-1), B_w_gate, B_w_up, B_w_down)
    x = x + _A_ref(_layernorm(x, axis=-1), A_k_cache, A_v_cache, A_wq, A_wo)
    x = x + _B_ref(_layernorm(x, axis=-1), B_w_gate, B_w_up, B_w_down)
    return x
```

```asm
; @launch grid=(256,1,1) block=(256,1,1) lds=163840
.amdgcn_target "amdgcn-amd-amdhsa--gfx950"
.text
.globl interleave_layers__gqa_block_cached__glu_gated_glu__decode_kernel
.p2align 8
.type interleave_layers__gqa_block_cached__glu_gated_glu__decode_kernel,@function
interleave_layers__gqa_block_cached__glu_gated_glu__decode_kernel:
s_cmp_ge_u32 s2, 256
s_cbranch_scc1 L_end
s_load_dwordx16 s[16:31], s[0:1], 0
s_load_dwordx8 s[32:39], s[0:1], 64
s_getpc_b64 s[90:91]
L_pc:
s_lshr_b32 s92, s2, 3
s_lshl_b32 s92, s92, 11
v_lshrrev_b32 v1, 4, v0
v_lshl_add_u32 v1, v1, 7, s92
v_min_u32 v1, L_code_end-L_pc-4, v1
global_load_dword v255, v1, s[90:91]
v_lshrrev_b32 v1, 6, v0
s_nop 0
v_readfirstlane_b32 s40, v1
v_and_b32 v0, 63, v0
s_and_b32 s41, s2, 7
s_lshr_b32 s42, s2, 3
s_mov_b32 s64, 400000
s_waitcnt lgkmcnt(0)
s_mov_b32 s12, s38
s_and_b32 s13, s39, 0xffff
s_mov_b32 s14, 0x800000
s_mov_b32 s15, 0x20000
s_cmp_lt_u32 s42, 4
s_cbranch_scc1 L_chain
s_sub_u32 s42, s42, 4
s_mov_b32 s72, s41
s_lshl_b32 s73, s42, 2
s_add_u32 s73, s73, s40
v_mov_b32 v35, v0
s_add_u32 s74, s73, 0
s_cmp_ge_u32 s74, 64
s_cbranch_scc1 Lf2
s_sub_u32 s75, s74, 0
s_mov_b32 s76, s22
s_and_b32 s77, s23, 0xffff
s_mov_b32 s78, 0x400000
s_mov_b32 s79, 0x20000
v_lshrrev_b32 v33, 3, v35
v_and_b32 v34, 7, v35
v_lshlrev_b32 v34, 7, v34
v_lshl_add_u32 v33, v33, 13, v34
s_lshl_b32 s75, s75, 16
s_lshl_b32 s80, s72, 10
s_add_u32 s75, s75, s80
v_add_u32 v33, s75, v33
buffer_load_dword v200, v33, s[76:79], 0 offen
s_branch Lf1
Lf2:
s_cmp_ge_u32 s74, 128
s_cbranch_scc1 Lf3
s_sub_u32 s75, s74, 64
s_mov_b32 s76, s24
s_and_b32 s77, s25, 0xffff
s_mov_b32 s78, 0x400000
s_mov_b32 s79, 0x20000
v_lshlrev_b32 v33, 7, v35
s_lshl_b32 s75, s75, 13
s_mul_i32 s80, s72, 524288
s_add_u32 s75, s75, s80
v_add_u32 v33, s75, v33
buffer_load_dword v200, v33, s[76:79], 0 offen
s_branch Lf1
Lf3:
Lf1:
s_add_u32 s74, s73, 112
s_cmp_ge_u32 s74, 128
s_cbranch_scc1 Lf5
s_sub_u32 s75, s74, 64
s_mov_b32 s76, s24
s_and_b32 s77, s25, 0xffff
s_mov_b32 s78, 0x400000
s_mov_b32 s79, 0x20000
v_lshlrev_b32 v33, 7, v35
s_lshl_b32 s75, s75, 13
s_mul_i32 s80, s72, 524288
s_add_u32 s75, s75, s80
v_add_u32 v33, s75, v33
buffer_load_dword v201, v33, s[76:79], 0 offen
s_branch Lf4
Lf5:
s_cmp_ge_u32 s74, 160
s_cbranch_scc1 Lf6
s_sub_u32 s75, s74, 128
s_mov_b32 s76, s28
s_and_b32 s77, s29, 0xffff
s_mov_b32 s78, 0x158000
s_mov_b32 s79, 0x20000
v_lshrrev_b32 v33, 2, v35
v_mul_u32_u24 v33, 2752, v33
v_and_b32 v34, 3, v35
v_lshlrev_b32 v34, 7, v34
v_min_u32 v34, 320, v34
v_add_u32 v33, v34, v33
s_mul_i32 s75, s75, 44032
s_mul_i32 s80, s72, 384
s_add_u32 s75, s75, s80
v_add_u32 v33, s75, v33
buffer_load_dword v201, v33, s[76:79], 0 offen
s_branch Lf4
Lf6:
s_cmp_ge_u32 s74, 192
s_cbranch_scc1 Lf7
s_sub_u32 s75, s74, 160
s_mov_b32 s76, s30
s_and_b32 s77, s31, 0xffff
s_mov_b32 s78, 0x158000
s_mov_b32 s79, 0x20000
v_lshrrev_b32 v33, 2, v35
v_mul_u32_u24 v33, 2752, v33
v_and_b32 v34, 3, v35
v_lshlrev_b32 v34, 7, v34
v_min_u32 v34, 320, v34
v_add_u32 v33, v34, v33
s_mul_i32 s75, s75, 44032
s_mul_i32 s80, s72, 384
s_add_u32 s75, s75, s80
v_add_u32 v33, s75, v33
buffer_load_dword v201, v33, s[76:79], 0 offen
s_branch Lf4
Lf7:
s_cmp_ge_u32 s74, 216
s_cbranch_scc1 Lf8
s_sub_u32 s75, s74, 192
s_mov_b32 s76, s32
s_and_b32 s77, s33, 0xffff
s_mov_b32 s78, 0x158000
s_mov_b32 s79, 0x20000
v_lshlrev_b32 v33, 7, v35
s_lshl_b32 s75, s75, 13
s_mul_i32 s80, s72, 196608
s_add_u32 s75, s75, s80
v_add_u32 v33, s75, v33
buffer_load_dword v201, v33, s[76:79], 0 offen
s_branch Lf4
Lf8:
Lf4:
s_mul_i32 s66, s42, 37
s_lshr_b32 s66, s66, 8
s_mul_i32 s67, s66, 7
s_sub_u32 s42, s42, s67
s_lshl_b32 s41, s41, 2
s_add_u32 s41, s41, s66
s_mov_b32 s4, s18
s_and_b32 s5, s19, 0xffff
s_mov_b32 s6, 0x10000000
s_mov_b32 s7, 0x20000
s_mov_b32 s8, s20
s_and_b32 s9, s21, 0xffff
s_mov_b32 s10, 0x10000000
s_mov_b32 s11, 0x20000
s_lshl_b32 s43, s42, 2
s_add_u32 s43, s43, s40
s_lshl_b32 s44, s41, 20
s_mul_i32 s46, s42, 36
s_add_u32 s46, s46, s40
s_lshl_b32 s46, s46, 12
s_add_u32 s45, s44, s46
s_mul_i32 s47, s40, 38912
s_mov_b32 s48, 0
s_mov_b32 s49, 4096
v_lshlrev_b32 v0, 4, v0
s_add_u32 m0, s47, s48
s_nop 0
buffer_load_dwordx4 v0, s[4:7], s45 offen offset:0 nt lds
buffer_load_dwordx4 v0, s[4:7], s45 offen offset:1024 nt lds
buffer_load_dwordx4 v0, s[4:7], s45 offen offset:2048 nt lds
buffer_load_dwordx4 v0, s[4:7], s45 offen offset:3072 nt lds
s_add_u32 s45, s45, 16384
s_add_u32 m0, s47, 12288
s_nop 0
buffer_load_dwordx4 v0, s[4:7], s45 offen offset:0 nt lds
buffer_load_dwordx4 v0, s[4:7], s45 offen offset:1024 nt lds
buffer_load_dwordx4 v0, s[4:7], s45 offen offset:2048 nt lds
buffer_load_dwordx4 v0, s[4:7], s45 offen offset:3072 nt lds
s_add_u32 s45, s45, 16384
s_lshl_b32 s50, s41, 12
s_mul_i32 s67, s41, 56320
s_mul_i32 s66, s42, 7040
s_add_u32 s67, s67, s66
s_add_u32 s67, s67, 0x100000
s_add_u32 s51, s50, 2048
s_mov_b32 s52, 0
s_mov_b32 s86, 0
s_mov_b32 s87, 0
s_mov_b32 s89, 0
s_mov_b32 s54, 0xaaaaaaaa
s_mov_b32 s55, 0xaaaaaaaa
s_mov_b32 s56, 0xcccccccc
s_mov_b32 s57, 0xcccccccc
s_mov_b32 s58, 0x11111111
s_cmp_lt_u32 s43, 16
s_cselect_b32 s58, 0x11131113, s58
s_mov_b32 s59, s58
s_lshl_b32 s66, s43, 10
s_add_u32 s66, s66, 1032192
s_cmp_lt_u32 s43, 16
s_cselect_b32 s66, s66, 0x40000000
v_add_u32 v2, s66, v0
v_add_u32 v1, s47, v0
v_and_b32 v33, 15, v35
v_lshlrev_b32 v3, 4, v33
v_mov_b32 v34, 0xffff
v_mov_b32 v52, 0xffff0000
v_cmp_eq_u32 vcc, 0, v33
s_nop 1
v_cndmask_b32 v4, 0, v34, vcc
v_cmp_eq_u32 vcc, 1, v33
s_nop 1
v_cndmask_b32 v4, v4, v52, vcc
v_cmp_eq_u32 vcc, 2, v33
s_nop 1
v_cndmask_b32 v5, 0, v34, vcc
v_cmp_eq_u32 vcc, 3, v33
s_nop 1
v_cndmask_b32 v5, v5, v52, vcc
v_cmp_eq_u32 vcc, 4, v33
s_nop 1
v_cndmask_b32 v6, 0, v34, vcc
v_cmp_eq_u32 vcc, 5, v33
s_nop 1
v_cndmask_b32 v6, v6, v52, vcc
v_cmp_eq_u32 vcc, 6, v33
s_nop 1
v_cndmask_b32 v7, 0, v34, vcc
v_cmp_eq_u32 vcc, 7, v33
s_nop 1
v_cndmask_b32 v7, v7, v52, vcc
s_and_b32 s66, s40, 1
s_mul_i32 s85, s66, 2112
s_add_u32 s85, s85, 155648
s_mul_i32 s66, s66, 320
s_add_u32 s67, s67, s66
v_lshl_add_u32 v32, v35, 3, s67
s_mul_i32 s68, s40, 528
s_add_u32 s68, s68, 155648
s_waitcnt vmcnt(7)
s_add_u32 m0, s47, 16384
s_nop 0
buffer_load_dwordx4 v0, s[4:7], s45 offen offset:0 nt lds
s_waitcnt vmcnt(7)
buffer_load_dwordx4 v0, s[4:7], s45 offen offset:1024 nt lds
s_waitcnt vmcnt(7)
buffer_load_dwordx4 v0, s[4:7], s45 offen offset:2048 nt lds
s_waitcnt vmcnt(7)
buffer_load_dwordx4 v0, s[4:7], s45 offen offset:3072 nt lds
s_add_u32 s45, s45, 16384
s_waitcnt vmcnt(7)
s_add_u32 m0, s47, 20480
s_nop 0
buffer_load_dwordx4 v0, s[4:7], s45 offen offset:0 nt lds
s_waitcnt vmcnt(7)
buffer_load_dwordx4 v0, s[4:7], s45 offen offset:1024 nt lds
s_waitcnt vmcnt(7)
buffer_load_dwordx4 v0, s[4:7], s45 offen offset:2048 nt lds
s_waitcnt vmcnt(7)
buffer_load_dwordx4 v0, s[4:7], s45 offen offset:3072 nt lds
s_add_u32 s45, s45, 16384
s_waitcnt vmcnt(7)
s_barrier
buffer_load_dwordx4 v[56:59], v0, s[4:7], s45 offen offset:0 nt
s_waitcnt vmcnt(7)
buffer_load_dwordx4 v[60:63], v0, s[4:7], s45 offen offset:1024 nt
s_waitcnt vmcnt(7)
buffer_load_dwordx4 v[64:67], v0, s[4:7], s45 offen offset:2048 nt
s_waitcnt vmcnt(7)
buffer_load_dwordx4 v[68:71], v0, s[4:7], s45 offen offset:3072 nt
s_add_u32 s45, s45, 16384
s_waitcnt vmcnt(7)
buffer_load_dwordx4 v[72:75], v0, s[4:7], s45 offen offset:0 nt
s_waitcnt vmcnt(7)
buffer_load_dwordx4 v[76:79], v0, s[4:7], s45 offen offset:1024 nt
s_waitcnt vmcnt(7)
buffer_load_dwordx4 v[80:83], v0, s[4:7], s45 offen offset:2048 nt
s_waitcnt vmcnt(7)
buffer_load_dwordx4 v[84:87], v0, s[4:7], s45 offen offset:3072 nt
s_add_u32 s45, s45, 16384
s_waitcnt vmcnt(7)
s_barrier
buffer_load_dwordx4 v[88:91], v0, s[4:7], s45 offen offset:0 nt
s_waitcnt vmcnt(7)
buffer_load_dwordx4 v[92:95], v0, s[4:7], s45 offen offset:1024 nt
s_waitcnt vmcnt(7)
buffer_load_dwordx4 v[96:99], v0, s[4:7], s45 offen offset:2048 nt
s_waitcnt vmcnt(7)
buffer_load_dwordx4 v[100:103], v0, s[4:7], s45 offen offset:3072 nt
s_add_u32 s45, s45, 16384
s_waitcnt vmcnt(7)
buffer_load_dwordx4 v[104:107], v0, s[4:7], s45 offen offset:0 nt
s_waitcnt vmcnt(7)
buffer_load_dwordx4 v[108:111], v0, s[4:7], s45 offen offset:1024 nt
s_waitcnt vmcnt(7)
buffer_load_dwordx4 v[112:115], v0, s[4:7], s45 offen offset:2048 nt
s_waitcnt vmcnt(7)
buffer_load_dwordx4 v[116:119], v0, s[4:7], s45 offen offset:3072 nt
s_add_u32 s45, s45, 16384
s_waitcnt vmcnt(7)
s_barrier
buffer_load_dwordx4 v[120:123], v0, s[4:7], s45 offen offset:0 nt
s_waitcnt vmcnt(7)
buffer_load_dwordx4 v[124:127], v0, s[4:7], s45 offen offset:1024 nt
s_waitcnt vmcnt(7)
buffer_load_dwordx4 v[128:131], v0, s[4:7], s45 offen offset:2048 nt
v_and_b32 v13, 0x70, v0
v_lshrrev_b32 v13, 2, v13
global_load_dword v12, v13, s[36:37] sc1
s_waitcnt vmcnt(8)
buffer_load_dwordx4 v[132:135], v0, s[4:7], s45 offen offset:3072 nt
s_add_u32 s45, s45, 16384
s_waitcnt vmcnt(8)
s_add_u32 m0, s47, 24576
s_nop 0
buffer_load_dwordx4 v2, s[4:7], s44 offen nt lds
s_add_u32 s45, s44, s46
s_waitcnt vmcnt(8)
s_barrier
buffer_load_dwordx4 v[136:139], v0, s[8:11], s45 offen offset:0 nt
s_waitcnt vmcnt(8)
buffer_load_dwordx4 v[140:143], v0, s[8:11], s45 offen offset:1024 nt
s_waitcnt vmcnt(8)
buffer_load_dwordx4 v[144:147], v0, s[8:11], s45 offen offset:2048 nt
s_waitcnt vmcnt(8)
buffer_load_dwordx4 v[148:151], v0, s[8:11], s45 offen offset:3072 nt
s_add_u32 s45, s45, 16384
s_waitcnt vmcnt(8)
buffer_load_dwordx4 v[152:155], v0, s[8:11], s45 offen offset:0 nt
s_waitcnt vmcnt(8)
buffer_load_dwordx4 a[0:3], v0, s[8:11], s45 offen offset:1024 nt
s_waitcnt vmcnt(8)
Ls9:
v_and_b32 v33, 0x80808080, v12
v_cmp_ne_u32 vcc, 0x80808080, v33
s_nop 0
s_cbranch_vccz Ls10
s_sleep 4
global_load_dword v12, v13, s[36:37] sc1
s_waitcnt vmcnt(0)
s_sub_u32 s64, s64, 1
s_cmp_gt_i32 s64, 0
s_cbranch_scc1 Ls9
Ls10:
s_lshr_b32 s66, s41, 2
v_readlane_b32 s67, v12, s66
s_getreg_b32 s66, hwreg(HW_REG_XCC_ID, 0, 4)
s_or_b32 s66, s66, 0x80
s_mul_i32 s66, s66, 0x01010101
s_cmp_eq_u32 s66, s67
s_cselect_b32 s83, 0, 0x80000000
buffer_load_dwordx4 v[8:11], v3, s[12:15], s50 offen sc1
s_waitcnt vmcnt(8)
buffer_load_dwordx4 a[4:7], v0, s[8:11], s45 offen offset:2048 nt
s_waitcnt vmcnt(8)
buffer_load_dwordx4 a[8:11], v0, s[8:11], s45 offen offset:3072 nt
s_add_u32 s45, s45, 16384
s_waitcnt vmcnt(8)
s_barrier
buffer_load_dwordx4 a[12:15], v0, s[8:11], s45 offen offset:0 nt
s_waitcnt vmcnt(8)
buffer_load_dwordx4 a[16:19], v0, s[8:11], s45 offen offset:1024 nt
s_waitcnt vmcnt(8)
buffer_load_dwordx4 a[20:23], v0, s[8:11], s45 offen offset:2048 nt
s_waitcnt vmcnt(8)
buffer_load_dwordx4 a[24:27], v0, s[8:11], s45 offen offset:3072 nt
s_add_u32 s45, s45, 16384
s_waitcnt vmcnt(8)
buffer_load_dwordx4 a[28:31], v0, s[8:11], s45 offen offset:0 nt
s_waitcnt vmcnt(8)
buffer_load_dwordx4 a[32:35], v0, s[8:11], s45 offen offset:1024 nt
s_waitcnt vmcnt(8)
Lq11:
v_max3_u32 v33, v8, v9, v10
v_max_u32 v33, v33, v11
v_cmp_eq_u32 vcc, -1, v33
s_nop 0
s_cbranch_vccz Lq12
s_sleep 1
buffer_load_dwordx4 v[8:11], v3, s[12:15], s50 offen sc1
s_waitcnt vmcnt(0)
s_sub_u32 s64, s64, 1
s_cmp_gt_i32 s64, 0
s_cbranch_scc1 Lq11
Lq12:
s_add_u32 s50, s50, 256
v_add_u32 v33, s48, v1
ds_read_b128 v[36:39], v33 offset:0
ds_read_b128 v[40:43], v33 offset:1024
ds_read_b128 v[44:47], v33 offset:2048
ds_read_b128 v[48:51], v33 offset:3072
s_waitcnt lgkmcnt(0)
v_dot2_f32_bf16 v52, v36, v8, 0
v_dot2_f32_bf16 v53, v40, v8, 0
v_dot2_f32_bf16 v54, v44, v8, 0
v_dot2_f32_bf16 v55, v48, v8, 0
v_dot2c_f32_bf16 v52, v37, v9
v_dot2c_f32_bf16 v53, v41, v9
v_dot2c_f32_bf16 v54, v45, v9
v_dot2c_f32_bf16 v55, v49, v9
v_dot2c_f32_bf16 v52, v38, v10
v_dot2c_f32_bf16 v53, v42, v10
v_dot2c_f32_bf16 v54, v46, v10
v_dot2c_f32_bf16 v55, v50, v10
v_dot2c_f32_bf16 v52, v39, v11
v_dot2c_f32_bf16 v53, v43, v11
v_dot2c_f32_bf16 v54, v47, v11
v_dot2c_f32_bf16 v55, v51, v11
v_add_f32_dpp v33, v52, v52 row_ror:8 row_mask:0xf bank_mask:0x3
v_add_f32_dpp v34, v53, v53 row_ror:8 row_mask:0xf bank_mask:0x3
v_add_f32_dpp v33, v54, v54 row_ror:8 row_mask:0xf bank_mask:0xc
v_add_f32_dpp v34, v55, v55 row_ror:8 row_mask:0xf bank_mask:0xc
s_nop 0
v_add_f32_dpp v24, v33, v33 row_half_mirror row_mask:0xf bank_mask:0x5
v_add_f32_dpp v24, v34, v34 row_half_mirror row_mask:0xf bank_mask:0xa
s_waitcnt vmcnt(7)
buffer_load_dwordx4 a[36:39], v0, s[8:11], s45 offen offset:2048 nt
ds_read_b128 v[36:39], v1 offset:12288
ds_read_b128 v[40:43], v1 offset:13312
ds_read_b128 v[44:47], v1 offset:14336
ds_read_b128 v[48:51], v1 offset:15360
s_waitcnt lgkmcnt(0)
v_dot2_f32_bf16 v52, v36, v8, 0
v_dot2_f32_bf16 v53, v40, v8, 0
v_dot2_f32_bf16 v54, v44, v8, 0
v_dot2_f32_bf16 v55, v48, v8, 0
v_dot2c_f32_bf16 v52, v37, v9
v_dot2c_f32_bf16 v53, v41, v9
v_dot2c_f32_bf16 v54, v45, v9
v_dot2c_f32_bf16 v55, v49, v9
v_dot2c_f32_bf16 v52, v38, v10
v_dot2c_f32_bf16 v53, v42, v10
v_dot2c_f32_bf16 v54, v46, v10
v_dot2c_f32_bf16 v55, v50, v10
v_dot2c_f32_bf16 v52, v39, v11
v_dot2c_f32_bf16 v53, v43, v11
v_dot2c_f32_bf16 v54, v47, v11
v_dot2c_f32_bf16 v55, v51, v11
v_add_f32_dpp v33, v52, v52 row_ror:8 row_mask:0xf bank_mask:0x3
v_add_f32_dpp v34, v53, v53 row_ror:8 row_mask:0xf bank_mask:0x3
v_add_f32_dpp v33, v54, v54 row_ror:8 row_mask:0xf bank_mask:0xc
v_add_f32_dpp v34, v55, v55 row_ror:8 row_mask:0xf bank_mask:0xc
s_nop 0
v_add_f32_dpp v35, v33, v33 row_half_mirror row_mask:0xf bank_mask:0x5
v_add_f32_dpp v35, v34, v34 row_half_mirror row_mask:0xf bank_mask:0xa
v_cndmask_b32 v33, v24, v35, s[54:55]
v_cndmask_b32 v34, v35, v24, s[54:55]
s_nop 1
v_add_f32_dpp v24, v34, v33 quad_perm:[1,0,3,2] row_mask:0xf bank_mask:0xf
s_waitcnt vmcnt(7)
buffer_load_dwordx4 a[40:43], v0, s[8:11], s45 offen offset:3072 nt
s_add_u32 s45, s45, 16384
ds_read_b128 v[36:39], v1 offset:16384
ds_read_b128 v[40:43], v1 offset:17408
ds_read_b128 v[44:47], v1 offset:18432
ds_read_b128 v[48:51], v1 offset:19456
s_waitcnt lgkmcnt(0)
v_dot2_f32_bf16 v52, v36, v8, 0
v_dot2_f32_bf16 v53, v40, v8, 0
v_dot2_f32_bf16 v54, v44, v8, 0
v_dot2_f32_bf16 v55, v48, v8, 0
v_dot2c_f32_bf16 v52, v37, v9
v_dot2c_f32_bf16 v53, v41, v9
v_dot2c_f32_bf16 v54, v45, v9
v_dot2c_f32_bf16 v55, v49, v9
v_dot2c_f32_bf16 v52, v38, v10
v_dot2c_f32_bf16 v53, v42, v10
v_dot2c_f32_bf16 v54, v46, v10
v_dot2c_f32_bf16 v55, v50, v10
v_dot2c_f32_bf16 v52, v39, v11
v_dot2c_f32_bf16 v53, v43, v11
v_dot2c_f32_bf16 v54, v47, v11
v_dot2c_f32_bf16 v55, v51, v11
v_add_f32_dpp v33, v52, v52 row_ror:8 row_mask:0xf bank_mask:0x3
v_add_f32_dpp v34, v53, v53 row_ror:8 row_mask:0xf bank_mask:0x3
v_add_f32_dpp v33, v54, v54 row_ror:8 row_mask:0xf bank_mask:0xc
v_add_f32_dpp v34, v55, v55 row_ror:8 row_mask:0xf bank_mask:0xc
s_nop 0
v_add_f32_dpp v27, v33, v33 row_half_mirror row_mask:0xf bank_mask:0x5
v_add_f32_dpp v27, v34, v34 row_half_mirror row_mask:0xf bank_mask:0xa
s_waitcnt vmcnt(7)
s_barrier
buffer_load_dwordx4 a[44:47], v0, s[8:11], s45 offen offset:0 nt
ds_read_b128 v[36:39], v1 offset:20480
ds_read_b128 v[40:43], v1 offset:21504
ds_read_b128 v[44:47], v1 offset:22528
ds_read_b128 v[48:51], v1 offset:23552
s_waitcnt lgkmcnt(0)
v_dot2_f32_bf16 v52, v36, v8, 0
v_dot2_f32_bf16 v53, v40, v8, 0
v_dot2_f32_bf16 v54, v44, v8, 0
v_dot2_f32_bf16 v55, v48, v8, 0
v_dot2c_f32_bf16 v52, v37, v9
v_dot2c_f32_bf16 v53, v41, v9
v_dot2c_f32_bf16 v54, v45, v9
v_dot2c_f32_bf16 v55, v49, v9
v_dot2c_f32_bf16 v52, v38, v10
v_dot2c_f32_bf16 v53, v42, v10
v_dot2c_f32_bf16 v54, v46, v10
v_dot2c_f32_bf16 v55, v50, v10
v_dot2c_f32_bf16 v52, v39, v11
v_dot2c_f32_bf16 v53, v43, v11
v_dot2c_f32_bf16 v54, v47, v11
v_dot2c_f32_bf16 v55, v51, v11
v_add_f32_dpp v33, v52, v52 row_ror:8 row_mask:0xf bank_mask:0x3
v_add_f32_dpp v34, v53, v53 row_ror:8 row_mask:0xf bank_mask:0x3
v_add_f32_dpp v33, v54, v54 row_ror:8 row_mask:0xf bank_mask:0xc
v_add_f32_dpp v34, v55, v55 row_ror:8 row_mask:0xf bank_mask:0xc
s_nop 0
v_add_f32_dpp v35, v33, v33 row_half_mirror row_mask:0xf bank_mask:0x5
v_add_f32_dpp v35, v34, v34 row_half_mirror row_mask:0xf bank_mask:0xa
v_cndmask_b32 v33, v27, v35, s[54:55]
v_cndmask_b32 v34, v35, v27, s[54:55]
s_nop 1
v_add_f32_dpp v27, v34, v33 quad_perm:[1,0,3,2] row_mask:0xf bank_mask:0xf
v_cndmask_b32 v33, v24, v27, s[56:57]
v_cndmask_b32 v34, v27, v24, s[56:57]
s_nop 1
v_add_f32_dpp v24, v34, v33 quad_perm:[2,3,0,1] row_mask:0xf bank_mask:0xf
s_waitcnt vmcnt(7)
buffer_load_dwordx4 a[48:51], v0, s[8:11], s45 offen offset:1024 nt
v_dot2_f32_bf16 v52, v56, v8, 0
v_dot2_f32_bf16 v53, v60, v8, 0
v_dot2_f32_bf16 v54, v64, v8, 0
v_dot2_f32_bf16 v55, v68, v8, 0
v_dot2c_f32_bf16 v52, v57, v9
v_dot2c_f32_bf16 v53, v61, v9
v_dot2c_f32_bf16 v54, v65, v9
v_dot2c_f32_bf16 v55, v69, v9
v_dot2c_f32_bf16 v52, v58, v10
v_dot2c_f32_bf16 v53, v62, v10
v_dot2c_f32_bf16 v54, v66, v10
v_dot2c_f32_bf16 v55, v70, v10
v_dot2c_f32_bf16 v52, v59, v11
v_dot2c_f32_bf16 v53, v63, v11
v_dot2c_f32_bf16 v54, v67, v11
v_dot2c_f32_bf16 v55, v71, v11
v_add_f32_dpp v33, v52, v52 row_ror:8 row_mask:0xf bank_mask:0x3
v_add_f32_dpp v34, v53, v53 row_ror:8 row_mask:0xf bank_mask:0x3
v_add_f32_dpp v33, v54, v54 row_ror:8 row_mask:0xf bank_mask:0xc
v_add_f32_dpp v34, v55, v55 row_ror:8 row_mask:0xf bank_mask:0xc
s_nop 0
v_add_f32_dpp v25, v33, v33 row_half_mirror row_mask:0xf bank_mask:0x5
v_add_f32_dpp v25, v34, v34 row_half_mirror row_mask:0xf bank_mask:0xa
s_waitcnt vmcnt(7)
buffer_load_dwordx4 a[52:55], v0, s[8:11], s45 offen offset:2048 nt
v_dot2_f32_bf16 v52, v72, v8, 0
v_dot2_f32_bf16 v53, v76, v8, 0
v_dot2_f32_bf16 v54, v80, v8, 0
v_dot2_f32_bf16 v55, v84, v8, 0
v_dot2c_f32_bf16 v52, v73, v9
v_dot2c_f32_bf16 v53, v77, v9
v_dot2c_f32_bf16 v54, v81, v9
v_dot2c_f32_bf16 v55, v85, v9
v_dot2c_f32_bf16 v52, v74, v10
v_dot2c_f32_bf16 v53, v78, v10
v_dot2c_f32_bf16 v54, v82, v10
v_dot2c_f32_bf16 v55, v86, v10
v_dot2c_f32_bf16 v52, v75, v11
v_dot2c_f32_bf16 v53, v79, v11
v_dot2c_f32_bf16 v54, v83, v11
v_dot2c_f32_bf16 v55, v87, v11
v_add_f32_dpp v33, v52, v52 row_ror:8 row_mask:0xf bank_mask:0x3
v_add_f32_dpp v34, v53, v53 row_ror:8 row_mask:0xf bank_mask:0x3
v_add_f32_dpp v33, v54, v54 row_ror:8 row_mask:0xf bank_mask:0xc
v_add_f32_dpp v34, v55, v55 row_ror:8 row_mask:0xf bank_mask:0xc
s_nop 0
v_add_f32_dpp v35, v33, v33 row_half_mirror row_mask:0xf bank_mask:0x5
v_add_f32_dpp v35, v34, v34 row_half_mirror row_mask:0xf bank_mask:0xa
v_cndmask_b32 v33, v25, v35, s[54:55]
v_cndmask_b32 v34, v35, v25, s[54:55]
s_nop 1
v_add_f32_dpp v25, v34, v33 quad_perm:[1,0,3,2] row_mask:0xf bank_mask:0xf
s_waitcnt vmcnt(7)
buffer_load_dwordx4 a[56:59], v0, s[8:11], s45 offen offset:3072 nt
s_add_u32 s45, s45, 16384
v_dot2_f32_bf16 v52, v88, v8, 0
v_dot2_f32_bf16 v53, v92, v8, 0
v_dot2_f32_bf16 v54, v96, v8, 0
v_dot2_f32_bf16 v55, v100, v8, 0
v_dot2c_f32_bf16 v52, v89, v9
v_dot2c_f32_bf16 v53, v93, v9
v_dot2c_f32_bf16 v54, v97, v9
v_dot2c_f32_bf16 v55, v101, v9
v_dot2c_f32_bf16 v52, v90, v10
v_dot2c_f32_bf16 v53, v94, v10
v_dot2c_f32_bf16 v54, v98, v10
v_dot2c_f32_bf16 v55, v102, v10
v_dot2c_f32_bf16 v52, v91, v11
v_dot2c_f32_bf16 v53, v95, v11
v_dot2c_f32_bf16 v54, v99, v11
v_dot2c_f32_bf16 v55, v103, v11
v_add_f32_dpp v33, v52, v52 row_ror:8 row_mask:0xf bank_mask:0x3
v_add_f32_dpp v34, v53, v53 row_ror:8 row_mask:0xf bank_mask:0x3
v_add_f32_dpp v33, v54, v54 row_ror:8 row_mask:0xf bank_mask:0xc
v_add_f32_dpp v34, v55, v55 row_ror:8 row_mask:0xf bank_mask:0xc
s_nop 0
v_add_f32_dpp v27, v33, v33 row_half_mirror row_mask:0xf bank_mask:0x5
v_add_f32_dpp v27, v34, v34 row_half_mirror row_mask:0xf bank_mask:0xa
s_waitcnt vmcnt(7)
buffer_load_dwordx4 a[60:63], v0, s[8:11], s45 offen offset:0 nt
v_dot2_f32_bf16 v52, v104, v8, 0
v_dot2_f32_bf16 v53, v108, v8, 0
v_dot2_f32_bf16 v54, v112, v8, 0
v_dot2_f32_bf16 v55, v116, v8, 0
v_dot2c_f32_bf16 v52, v105, v9
v_dot2c_f32_bf16 v53, v109, v9
v_dot2c_f32_bf16 v54, v113, v9
v_dot2c_f32_bf16 v55, v117, v9
v_dot2c_f32_bf16 v52, v106, v10
v_dot2c_f32_bf16 v53, v110, v10
v_dot2c_f32_bf16 v54, v114, v10
v_dot2c_f32_bf16 v55, v118, v10
v_dot2c_f32_bf16 v52, v107, v11
v_dot2c_f32_bf16 v53, v111, v11
v_dot2c_f32_bf16 v54, v115, v11
v_dot2c_f32_bf16 v55, v119, v11
v_add_f32_dpp v33, v52, v52 row_ror:8 row_mask:0xf bank_mask:0x3
v_add_f32_dpp v34, v53, v53 row_ror:8 row_mask:0xf bank_mask:0x3
v_add_f32_dpp v33, v54, v54 row_ror:8 row_mask:0xf bank_mask:0xc
v_add_f32_dpp v34, v55, v55 row_ror:8 row_mask:0xf bank_mask:0xc
s_nop 0
v_add_f32_dpp v35, v33, v33 row_half_mirror row_mask:0xf bank_mask:0x5
v_add_f32_dpp v35, v34, v34 row_half_mirror row_mask:0xf bank_mask:0xa
v_cndmask_b32 v33, v27, v35, s[54:55]
v_cndmask_b32 v34, v35, v27, s[54:55]
s_nop 1
v_add_f32_dpp v27, v34, v33 quad_perm:[1,0,3,2] row_mask:0xf bank_mask:0xf
v_cndmask_b32 v33, v25, v27, s[56:57]
v_cndmask_b32 v34, v27, v25, s[56:57]
s_nop 1
v_add_f32_dpp v25, v34, v33 quad_perm:[2,3,0,1] row_mask:0xf bank_mask:0xf
s_waitcnt vmcnt(7)
buffer_load_dwordx4 a[64:67], v0, s[8:11], s45 offen offset:1024 nt
v_dot2_f32_bf16 v52, v120, v8, 0
v_dot2_f32_bf16 v53, v124, v8, 0
v_dot2_f32_bf16 v54, v128, v8, 0
v_dot2_f32_bf16 v55, v132, v8, 0
v_dot2c_f32_bf16 v52, v121, v9
v_dot2c_f32_bf16 v53, v125, v9
v_dot2c_f32_bf16 v54, v129, v9
v_dot2c_f32_bf16 v55, v133, v9
v_dot2c_f32_bf16 v52, v122, v10
v_dot2c_f32_bf16 v53, v126, v10
v_dot2c_f32_bf16 v54, v130, v10
v_dot2c_f32_bf16 v55, v134, v10
v_dot2c_f32_bf16 v52, v123, v11
v_dot2c_f32_bf16 v53, v127, v11
v_dot2c_f32_bf16 v54, v131, v11
v_dot2c_f32_bf16 v55, v135, v11
v_add_f32_dpp v33, v52, v52 row_ror:8 row_mask:0xf bank_mask:0x3
v_add_f32_dpp v34, v53, v53 row_ror:8 row_mask:0xf bank_mask:0x3
v_add_f32_dpp v33, v54, v54 row_ror:8 row_mask:0xf bank_mask:0xc
v_add_f32_dpp v34, v55, v55 row_ror:8 row_mask:0xf bank_mask:0xc
s_nop 0
v_add_f32_dpp v26, v33, v33 row_half_mirror row_mask:0xf bank_mask:0x5
v_add_f32_dpp v26, v34, v34 row_half_mirror row_mask:0xf bank_mask:0xa
s_waitcnt vmcnt(7)
buffer_load_dwordx4 a[68:71], v0, s[8:11], s45 offen offset:2048 nt
ds_read_b128 v[36:39], v1 offset:24576
s_waitcnt lgkmcnt(0)
v_dot2_f32_bf16 v52, v36, v8, 0
v_dot2_f32_bf16 v52, v37, v9, v52
v_dot2_f32_bf16 v52, v38, v10, v52
v_dot2_f32_bf16 v52, v39, v11, v52
s_nop 2
v_add_f32_dpp v33, v52, v52 row_ror:8 row_mask:0xf bank_mask:0xf
s_nop 1
v_add_f32_dpp v35, v33, v33 row_half_mirror row_mask:0xf bank_mask:0xf
v_cndmask_b32 v33, v26, v35, s[54:55]
v_cndmask_b32 v34, v35, v26, s[54:55]
s_nop 1
v_add_f32_dpp v26, v34, v33 quad_perm:[1,0,3,2] row_mask:0xf bank_mask:0xf
s_nop 1
v_add_f32_dpp v26, v26, v26 quad_perm:[2,3,0,1] row_mask:0xf bank_mask:0xf
v_mul_f32 v24, 0x3e0293ee, v24
v_mul_f32 v25, 0x3e0293ee, v25
v_mul_f32 v26, 0x3e0293ee, v26
v_mov_b32 v34, 0xff800000
v_cndmask_b32 v26, v34, v26, s[58:59]
v_max3_f32 v33, v24, v25, v26
s_nop 1
v_max_f32_dpp v33, v33, v33 quad_perm:[1,0,3,2] row_mask:0xf bank_mask:0xf
s_nop 1
v_max_f32_dpp v33, v33, v33 quad_perm:[2,3,0,1] row_mask:0xf bank_mask:0xf
s_nop 1
v_max_f32_dpp v33, v33, v33 row_ror:4 row_mask:0xf bank_mask:0xf
s_nop 1
v_max_f32_dpp v33, v33, v33 row_ror:8 row_mask:0xf bank_mask:0xf
s_nop 1
v_max_f32_dpp v33, v33, v33 row_bcast:15 row_mask:0xa bank_mask:0xf
s_nop 1
v_max_f32_dpp v33, v33, v33 row_bcast:31 row_mask:0xc bank_mask:0xf
s_nop 0
v_readlane_b32 s60, v33, 63
s_nop 1
v_subrev_f32 v24, s60, v24
v_subrev_f32 v25, s60, v25
v_subrev_f32 v26, s60, v26
v_exp_f32 v24, v24
v_exp_f32 v25, v25
v_exp_f32 v26, v26
v_add_f32 v33, v24, v25
v_add_f32 v33, v33, v26
v_cvt_pk_bf16_f32 v24, v24, v24
v_cvt_pk_bf16_f32 v25, v25, v25
v_cvt_pk_bf16_f32 v26, v26, v26
v_add_f32_dpp v33, v33, v33 quad_perm:[1,0,3,2] row_mask:0xf bank_mask:0xf
s_nop 1
v_add_f32_dpp v33, v33, v33 quad_perm:[2,3,0,1] row_mask:0xf bank_mask:0xf
s_nop 1
v_add_f32_dpp v33, v33, v33 row_ror:4 row_mask:0xf bank_mask:0xf
s_nop 1
v_add_f32_dpp v33, v33, v33 row_ror:8 row_mask:0xf bank_mask:0xf
s_nop 1
v_add_f32_dpp v33, v33, v33 row_bcast:15 row_mask:0xa bank_mask:0xf
s_nop 1
v_add_f32_dpp v33, v33, v33 row_bcast:31 row_mask:0xc bank_mask:0xf
s_nop 0
v_readlane_b32 s61, v33, 63
s_waitcnt vmcnt(7)
buffer_load_dwordx4 a[72:75], v0, s[8:11], s45 offen offset:3072 nt
s_add_u32 s45, s45, 16384
v_and_b32_dpp v36, v24, v4 row_newbcast:0 row_mask:0xf bank_mask:0xf
v_and_b32_dpp v37, v24, v5 row_newbcast:0 row_mask:0xf bank_mask:0xf
v_and_b32_dpp v38, v24, v6 row_newbcast:0 row_mask:0xf bank_mask:0xf
v_and_b32_dpp v39, v24, v7 row_newbcast:0 row_mask:0xf bank_mask:0xf
s_nop 1
v_mfma_f32_16x16x32_bf16 v[16:19], v[36:39], v[136:139], 0
v_and_b32_dpp v40, v24, v4 row_newbcast:4 row_mask:0xf bank_mask:0xf
v_and_b32_dpp v41, v24, v5 row_newbcast:4 row_mask:0xf bank_mask:0xf
v_and_b32_dpp v42, v24, v6 row_newbcast:4 row_mask:0xf bank_mask:0xf
v_and_b32_dpp v43, v24, v7 row_newbcast:4 row_mask:0xf bank_mask:0xf
s_nop 1
v_mfma_f32_16x16x32_bf16 v[16:19], v[40:43], v[140:143], v[16:19]
s_waitcnt vmcnt(7)
s_barrier
buffer_load_dwordx4 a[76:79], v0, s[8:11], s45 offen offset:0 nt
v_and_b32_dpp v44, v24, v4 row_newbcast:8 row_mask:0xf bank_mask:0xf
v_and_b32_dpp v45, v24, v5 row_newbcast:8 row_mask:0xf bank_mask:0xf
v_and_b32_dpp v46, v24, v6 row_newbcast:8 row_mask:0xf bank_mask:0xf
v_and_b32_dpp v47, v24, v7 row_newbcast:8 row_mask:0xf bank_mask:0xf
s_nop 1
v_mfma_f32_16x16x32_bf16 v[16:19], v[44:47], v[144:147], v[16:19]
v_and_b32_dpp v48, v24, v4 row_newbcast:12 row_mask:0xf bank_mask:0xf
v_and_b32_dpp v49, v24, v5 row_newbcast:12 row_mask:0xf bank_mask:0xf
v_and_b32_dpp v50, v24, v6 row_newbcast:12 row_mask:0xf bank_mask:0xf
v_and_b32_dpp v51, v24, v7 row_newbcast:12 row_mask:0xf bank_mask:0xf
s_nop 1
v_mfma_f32_16x16x32_bf16 v[16:19], v[48:51], v[148:151], v[16:19]
buffer_load_dwordx4 v[8:11], v3, s[12:15], s50 offen sc1
s_waitcnt vmcnt(8)
buffer_load_dwordx4 a[80:83], v0, s[8:11], s45 offen offset:1024 nt
v_and_b32_dpp v36, v24, v4 row_newbcast:1 row_mask:0xf bank_mask:0xf
v_and_b32_dpp v37, v24, v5 row_newbcast:1 row_mask:0xf bank_mask:0xf
v_and_b32_dpp v38, v24, v6 row_newbcast:1 row_mask:0xf bank_mask:0xf
v_and_b32_dpp v39, v24, v7 row_newbcast:1 row_mask:0xf bank_mask:0xf
s_nop 1
v_mfma_f32_16x16x32_bf16 v[16:19], v[36:39], v[152:155], v[16:19]
v_and_b32_dpp v40, v24, v4 row_newbcast:5 row_mask:0xf bank_mask:0xf
v_and_b32_dpp v41, v24, v5 row_newbcast:5 row_mask:0xf bank_mask:0xf
v_and_b32_dpp v42, v24, v6 row_newbcast:5 row_mask:0xf bank_mask:0xf
v_and_b32_dpp v43, v24, v7 row_newbcast:5 row_mask:0xf bank_mask:0xf
s_nop 1
v_mfma_f32_16x16x32_bf16 v[16:19], v[40:43], a[0:3], v[16:19]
s_waitcnt vmcnt(8)
buffer_load_dwordx4 a[84:87], v0, s[8:11], s45 offen offset:2048 nt
v_and_b32_dpp v44, v24, v4 row_newbcast:9 row_mask:0xf bank_mask:0xf
v_and_b32_dpp v45, v24, v5 row_newbcast:9 row_mask:0xf bank_mask:0xf
v_and_b32_dpp v46, v24, v6 row_newbcast:9 row_mask:0xf bank_mask:0xf
v_and_b32_dpp v47, v24, v7 row_newbcast:9 row_mask:0xf bank_mask:0xf
s_nop 1
v_mfma_f32_16x16x32_bf16 v[16:19], v[44:47], a[4:7], v[16:19]
v_and_b32_dpp v48, v24, v4 row_newbcast:13 row_mask:0xf bank_mask:0xf
v_and_b32_dpp v49, v24, v5 row_newbcast:13 row_mask:0xf bank_mask:0xf
v_and_b32_dpp v50, v24, v6 row_newbcast:13 row_mask:0xf bank_mask:0xf
v_and_b32_dpp v51, v24, v7 row_newbcast:13 row_mask:0xf bank_mask:0xf
s_nop 1
v_mfma_f32_16x16x32_bf16 v[16:19], v[48:51], a[8:11], v[16:19]
s_waitcnt vmcnt(8)
buffer_load_dwordx4 a[88:91], v0, s[8:11], s45 offen offset:3072 nt
s_add_u32 s45, s45, 16384
v_and_b32_dpp v36, v24, v4 row_newbcast:2 row_mask:0xf bank_mask:0xf
v_and_b32_dpp v37, v24, v5 row_newbcast:2 row_mask:0xf bank_mask:0xf
v_and_b32_dpp v38, v24, v6 row_newbcast:2 row_mask:0xf bank_mask:0xf
v_and_b32_dpp v39, v24, v7 row_newbcast:2 row_mask:0xf bank_mask:0xf
s_nop 1
v_mfma_f32_16x16x32_bf16 v[16:19], v[36:39], a[12:15], v[16:19]
v_and_b32_dpp v40, v24, v4 row_newbcast:6 row_mask:0xf bank_mask:0xf
v_and_b32_dpp v41, v24, v5 row_newbcast:6 row_mask:0xf bank_mask:0xf
v_and_b32_dpp v42, v24, v6 row_newbcast:6 row_mask:0xf bank_mask:0xf
v_and_b32_dpp v43, v24, v7 row_newbcast:6 row_mask:0xf bank_mask:0xf
s_nop 1
v_mfma_f32_16x16x32_bf16 v[16:19], v[40:43], a[16:19], v[16:19]
s_waitcnt vmcnt(8)
buffer_load_dwordx4 a[92:95], v0, s[8:11], s45 offen offset:0 nt
v_and_b32_dpp v44, v24, v4 row_newbcast:10 row_mask:0xf bank_mask:0xf
v_and_b32_dpp v45, v24, v5 row_newbcast:10 row_mask:0xf bank_mask:0xf
v_and_b32_dpp v46, v24, v6 row_newbcast:10 row_mask:0xf bank_mask:0xf
v_and_b32_dpp v47, v24, v7 row_newbcast:10 row_mask:0xf bank_mask:0xf
s_nop 1
v_mfma_f32_16x16x32_bf16 v[16:19], v[44:47], a[20:23], v[16:19]
v_and_b32_dpp v48, v24, v4 row_newbcast:14 row_mask:0xf bank_mask:0xf
v_and_b32_dpp v49, v24, v5 row_newbcast:14 row_mask:0xf bank_mask:0xf
v_and_b32_dpp v50, v24, v6 row_newbcast:14 row_mask:0xf bank_mask:0xf
v_and_b32_dpp v51, v24, v7 row_newbcast:14 row_mask:0xf bank_mask:0xf
s_nop 1
v_mfma_f32_16x16x32_bf16 v[16:19], v[48:51], a[24:27], v[16:19]
s_waitcnt vmcnt(8)
buffer_load_dwordx4 a[96:99], v0, s[8:11], s45 offen offset:1024 nt
v_and_b32_dpp v36, v24, v4 row_newbcast:3 row_mask:0xf bank_mask:0xf
v_and_b32_dpp v37, v24, v5 row_newbcast:3 row_mask:0xf bank_mask:0xf
v_and_b32_dpp v38, v24, v6 row_newbcast:3 row_mask:0xf bank_mask:0xf
v_and_b32_dpp v39, v24, v7 row_newbcast:3 row_mask:0xf bank_mask:0xf
s_nop 1
v_mfma_f32_16x16x32_bf16 v[16:19], v[36:39], a[28:31], v[16:19]
v_and_b32_dpp v40, v24, v4 row_newbcast:7 row_mask:0xf bank_mask:0xf
v_and_b32_dpp v41, v24, v5 row_newbcast:7 row_mask:0xf bank_mask:0xf
v_and_b32_dpp v42, v24, v6 row_newbcast:7 row_mask:0xf bank_mask:0xf
v_and_b32_dpp v43, v24, v7 row_newbcast:7 row_mask:0xf bank_mask:0xf
s_nop 1
v_mfma_f32_16x16x32_bf16 v[16:19], v[40:43], a[32:35], v[16:19]
s_waitcnt vmcnt(8)
buffer_load_dwordx4 a[100:103], v0, s[8:11], s45 offen offset:2048 nt
v_and_b32_dpp v44, v24, v4 row_newbcast:11 row_mask:0xf bank_mask:0xf
v_and_b32_dpp v45, v24, v5 row_newbcast:11 row_mask:0xf bank_mask:0xf
v_and_b32_dpp v46, v24, v6 row_newbcast:11 row_mask:0xf bank_mask:0xf
v_and_b32_dpp v47, v24, v7 row_newbcast:11 row_mask:0xf bank_mask:0xf
s_nop 1
v_mfma_f32_16x16x32_bf16 v[16:19], v[44:47], a[36:39], v[16:19]
v_and_b32_dpp v48, v24, v4 row_newbcast:15 row_mask:0xf bank_mask:0xf
v_and_b32_dpp v49, v24, v5 row_newbcast:15 row_mask:0xf bank_mask:0xf
v_and_b32_dpp v50, v24, v6 row_newbcast:15 row_mask:0xf bank_mask:0xf
v_and_b32_dpp v51, v24, v7 row_newbcast:15 row_mask:0xf bank_mask:0xf
s_nop 1
v_mfma_f32_16x16x32_bf16 v[16:19], v[48:51], a[40:43], v[16:19]
s_waitcnt vmcnt(8)
buffer_load_dwordx4 a[104:107], v0, s[8:11], s45 offen offset:3072 nt
s_add_u32 s45, s45, 16384
v_and_b32_dpp v36, v25, v4 row_newbcast:0 row_mask:0xf bank_mask:0xf
v_and_b32_dpp v37, v25, v5 row_newbcast:0 row_mask:0xf bank_mask:0xf
v_and_b32_dpp v38, v25, v6 row_newbcast:0 row_mask:0xf bank_mask:0xf
v_and_b32_dpp v39, v25, v7 row_newbcast:0 row_mask:0xf bank_mask:0xf
s_nop 1
v_mfma_f32_16x16x32_bf16 v[16:19], v[36:39], a[44:47], v[16:19]
v_and_b32_dpp v40, v25, v4 row_newbcast:4 row_mask:0xf bank_mask:0xf
v_and_b32_dpp v41, v25, v5 row_newbcast:4 row_mask:0xf bank_mask:0xf
v_and_b32_dpp v42, v25, v6 row_newbcast:4 row_mask:0xf bank_mask:0xf
v_and_b32_dpp v43, v25, v7 row_newbcast:4 row_mask:0xf bank_mask:0xf
s_nop 1
v_mfma_f32_16x16x32_bf16 v[16:19], v[40:43], a[48:51], v[16:19]
s_waitcnt vmcnt(8)
s_barrier
buffer_load_dwordx4 a[108:111], v0, s[8:11], s45 offen offset:0 nt
v_and_b32_dpp v44, v25, v4 row_newbcast:8 row_mask:0xf bank_mask:0xf
v_and_b32_dpp v45, v25, v5 row_newbcast:8 row_mask:0xf bank_mask:0xf
v_and_b32_dpp v46, v25, v6 row_newbcast:8 row_mask:0xf bank_mask:0xf
v_and_b32_dpp v47, v25, v7 row_newbcast:8 row_mask:0xf bank_mask:0xf
s_nop 1
v_mfma_f32_16x16x32_bf16 v[16:19], v[44:47], a[52:55], v[16:19]
v_and_b32_dpp v48, v25, v4 row_newbcast:12 row_mask:0xf bank_mask:0xf
v_and_b32_dpp v49, v25, v5 row_newbcast:12 row_mask:0xf bank_mask:0xf
v_and_b32_dpp v50, v25, v6 row_newbcast:12 row_mask:0xf bank_mask:0xf
v_and_b32_dpp v51, v25, v7 row_newbcast:12 row_mask:0xf bank_mask:0xf
s_nop 1
v_mfma_f32_16x16x32_bf16 v[16:19], v[48:51], a[56:59], v[16:19]
s_waitcnt vmcnt(8)
s_nop 6
Lq13:
v_max3_u32 v33, v8, v9, v10
v_max_u32 v33, v33, v11
v_cmp_eq_u32 vcc, -1, v33
s_nop 0
s_cbranch_vccz Lq14
s_sleep 1
buffer_load_dwordx4 v[8:11], v3, s[12:15], s50 offen sc1
s_waitcnt vmcnt(0)
s_sub_u32 s64, s64, 1
s_cmp_gt_i32 s64, 0
s_cbranch_scc1 Lq13
Lq14:
s_add_u32 s50, s50, 256
s_waitcnt vmcnt(7)
buffer_load_dwordx4 a[112:115], v0, s[8:11], s45 offen offset:1024 nt
v_and_b32_dpp v36, v25, v4 row_newbcast:1 row_mask:0xf bank_mask:0xf
v_and_b32_dpp v37, v25, v5 row_newbcast:1 row_mask:0xf bank_mask:0xf
v_and_b32_dpp v38, v25, v6 row_newbcast:1 row_mask:0xf bank_mask:0xf
v_and_b32_dpp v39, v25, v7 row_newbcast:1 row_mask:0xf bank_mask:0xf
s_nop 1
v_mfma_f32_16x16x32_bf16 v[16:19], v[36:39], a[60:63], v[16:19]
v_and_b32_dpp v40, v25, v4 row_newbcast:5 row_mask:0xf bank_mask:0xf
v_and_b32_dpp v41, v25, v5 row_newbcast:5 row_mask:0xf bank_mask:0xf
v_and_b32_dpp v42, v25, v6 row_newbcast:5 row_mask:0xf bank_mask:0xf
v_and_b32_dpp v43, v25, v7 row_newbcast:5 row_mask:0xf bank_mask:0xf
s_nop 1
v_mfma_f32_16x16x32_bf16 v[16:19], v[40:43], a[64:67], v[16:19]
s_waitcnt vmcnt(7)
buffer_load_dwordx4 a[116:119], v0, s[8:11], s45 offen offset:2048 nt
v_and_b32_dpp v44, v25, v4 row_newbcast:9 row_mask:0xf bank_mask:0xf
v_and_b32_dpp v45, v25, v5 row_newbcast:9 row_mask:0xf bank_mask:0xf
v_and_b32_dpp v46, v25, v6 row_newbcast:9 row_mask:0xf bank_mask:0xf
v_and_b32_dpp v47, v25, v7 row_newbcast:9 row_mask:0xf bank_mask:0xf
s_nop 1
v_mfma_f32_16x16x32_bf16 v[16:19], v[44:47], a[68:71], v[16:19]
v_and_b32_dpp v48, v25, v4 row_newbcast:13 row_mask:0xf bank_mask:0xf
v_and_b32_dpp v49, v25, v5 row_newbcast:13 row_mask:0xf bank_mask:0xf
v_and_b32_dpp v50, v25, v6 row_newbcast:13 row_mask:0xf bank_mask:0xf
v_and_b32_dpp v51, v25, v7 row_newbcast:13 row_mask:0xf bank_mask:0xf
s_nop 1
v_mfma_f32_16x16x32_bf16 v[16:19], v[48:51], a[72:75], v[16:19]
s_waitcnt vmcnt(7)
buffer_load_dwordx4 a[120:123], v0, s[8:11], s45 offen offset:3072 nt
s_add_u32 s45, s45, 16384
v_and_b32_dpp v36, v25, v4 row_newbcast:2 row_mask:0xf bank_mask:0xf
v_and_b32_dpp v37, v25, v5 row_newbcast:2 row_mask:0xf bank_mask:0xf
v_and_b32_dpp v38, v25, v6 row_newbcast:2 row_mask:0xf bank_mask:0xf
v_and_b32_dpp v39, v25, v7 row_newbcast:2 row_mask:0xf bank_mask:0xf
s_nop 1
v_mfma_f32_16x16x32_bf16 v[16:19], v[36:39], a[76:79], v[16:19]
v_and_b32_dpp v40, v25, v4 row_newbcast:6 row_mask:0xf bank_mask:0xf
v_and_b32_dpp v41, v25, v5 row_newbcast:6 row_mask:0xf bank_mask:0xf
v_and_b32_dpp v42, v25, v6 row_newbcast:6 row_mask:0xf bank_mask:0xf
v_and_b32_dpp v43, v25, v7 row_newbcast:6 row_mask:0xf bank_mask:0xf
s_nop 1
v_mfma_f32_16x16x32_bf16 v[16:19], v[40:43], a[80:83], v[16:19]
s_waitcnt vmcnt(7)
buffer_load_dwordx4 a[124:127], v2, s[8:11], s44 offen nt
s_add_u32 s44, s44, 0x2000000
s_mov_b32 s88, s87
s_mov_b32 s87, s46
s_add_u32 s45, s44, s46
v_and_b32_dpp v44, v25, v4 row_newbcast:10 row_mask:0xf bank_mask:0xf
v_and_b32_dpp v45, v25, v5 row_newbcast:10 row_mask:0xf bank_mask:0xf
v_and_b32_dpp v46, v25, v6 row_newbcast:10 row_mask:0xf bank_mask:0xf
v_and_b32_dpp v47, v25, v7 row_newbcast:10 row_mask:0xf bank_mask:0xf
s_nop 1
v_mfma_f32_16x16x32_bf16 v[16:19], v[44:47], a[84:87], v[16:19]
v_and_b32_dpp v48, v25, v4 row_newbcast:14 row_mask:0xf bank_mask:0xf
v_and_b32_dpp v49, v25, v5 row_newbcast:14 row_mask:0xf bank_mask:0xf
v_and_b32_dpp v50, v25, v6 row_newbcast:14 row_mask:0xf bank_mask:0xf
v_and_b32_dpp v51, v25, v7 row_newbcast:14 row_mask:0xf bank_mask:0xf
s_nop 1
v_mfma_f32_16x16x32_bf16 v[16:19], v[48:51], a[88:91], v[16:19]
s_mov_b32 s48, s49
s_add_u32 s49, s49, 4096
s_cmp_eq_u32 s49, 12288
s_cselect_b32 s49, 0, s49
s_waitcnt vmcnt(7)
s_add_u32 m0, s47, s48
s_nop 0
buffer_load_dwordx4 v0, s[4:7], s45 offen offset:0 nt lds
v_and_b32_dpp v36, v25, v4 row_newbcast:3 row_mask:0xf bank_mask:0xf
v_and_b32_dpp v37, v25, v5 row_newbcast:3 row_mask:0xf bank_mask:0xf
v_and_b32_dpp v38, v25, v6 row_newbcast:3 row_mask:0xf bank_mask:0xf
v_and_b32_dpp v39, v25, v7 row_newbcast:3 row_mask:0xf bank_mask:0xf
s_nop 1
v_mfma_f32_16x16x32_bf16 v[16:19], v[36:39], a[92:95], v[16:19]
v_and_b32_dpp v40, v25, v4 row_newbcast:7 row_mask:0xf bank_mask:0xf
v_and_b32_dpp v41, v25, v5 row_newbcast:7 row_mask:0xf bank_mask:0xf
v_and_b32_dpp v42, v25, v6 row_newbcast:7 row_mask:0xf bank_mask:0xf
v_and_b32_dpp v43, v25, v7 row_newbcast:7 row_mask:0xf bank_mask:0xf
s_nop 1
v_mfma_f32_16x16x32_bf16 v[16:19], v[40:43], a[96:99], v[16:19]
s_waitcnt vmcnt(7)
buffer_load_dwordx4 v0, s[4:7], s45 offen offset:1024 nt lds
v_and_b32_dpp v44, v25, v4 row_newbcast:11 row_mask:0xf bank_mask:0xf
v_and_b32_dpp v45, v25, v5 row_newbcast:11 row_mask:0xf bank_mask:0xf
v_and_b32_dpp v46, v25, v6 row_newbcast:11 row_mask:0xf bank_mask:0xf
v_and_b32_dpp v47, v25, v7 row_newbcast:11 row_mask:0xf bank_mask:0xf
s_nop 1
v_mfma_f32_16x16x32_bf16 v[16:19], v[44:47], a[100:103], v[16:19]
s_waitcnt vmcnt(7)
buffer_load_dwordx4 v0, s[4:7], s45 offen offset:2048 nt lds
v_and_b32_dpp v48, v25, v4 row_newbcast:15 row_mask:0xf bank_mask:0xf
v_and_b32_dpp v49, v25, v5 row_newbcast:15 row_mask:0xf bank_mask:0xf
v_and_b32_dpp v50, v25, v6 row_newbcast:15 row_mask:0xf bank_mask:0xf
v_and_b32_dpp v51, v25, v7 row_newbcast:15 row_mask:0xf bank_mask:0xf
s_nop 1
v_mfma_f32_16x16x32_bf16 v[16:19], v[48:51], a[104:107], v[16:19]
s_waitcnt vmcnt(7)
buffer_load_dwordx4 v0, s[4:7], s45 offen offset:3072 nt lds
s_add_u32 s45, s45, 16384
v_and_b32_dpp v36, v26, v4 row_newbcast:0 row_mask:0xf bank_mask:0xf
v_and_b32_dpp v37, v26, v5 row_newbcast:0 row_mask:0xf bank_mask:0xf
v_and_b32_dpp v38, v26, v6 row_newbcast:0 row_mask:0xf bank_mask:0xf
v_and_b32_dpp v39, v26, v7 row_newbcast:0 row_mask:0xf bank_mask:0xf
s_nop 1
v_mfma_f32_16x16x32_bf16 v[16:19], v[36:39], a[108:111], v[16:19]
s_waitcnt vmcnt(7)
s_add_u32 m0, s47, 25600
s_nop 0
buffer_load_dwordx4 v0, s[4:7], s45 offen offset:0 nt lds
v_and_b32_dpp v40, v26, v4 row_newbcast:4 row_mask:0xf bank_mask:0xf
v_and_b32_dpp v41, v26, v5 row_newbcast:4 row_mask:0xf bank_mask:0xf
v_and_b32_dpp v42, v26, v6 row_newbcast:4 row_mask:0xf bank_mask:0xf
v_and_b32_dpp v43, v26, v7 row_newbcast:4 row_mask:0xf bank_mask:0xf
s_nop 1
v_mfma_f32_16x16x32_bf16 v[16:19], v[40:43], a[112:115], v[16:19]
s_waitcnt vmcnt(7)
buffer_load_dwordx4 v0, s[4:7], s45 offen offset:1024 nt lds
v_and_b32_dpp v44, v26, v4 row_newbcast:8 row_mask:0xf bank_mask:0xf
v_and_b32_dpp v45, v26, v5 row_newbcast:8 row_mask:0xf bank_mask:0xf
v_and_b32_dpp v46, v26, v6 row_newbcast:8 row_mask:0xf bank_mask:0xf
v_and_b32_dpp v47, v26, v7 row_newbcast:8 row_mask:0xf bank_mask:0xf
s_nop 1
v_mfma_f32_16x16x32_bf16 v[16:19], v[44:47], a[116:119], v[16:19]
s_waitcnt vmcnt(7)
buffer_load_dwordx4 v0, s[4:7], s45 offen offset:2048 nt lds
v_and_b32_dpp v48, v26, v4 row_newbcast:12 row_mask:0xf bank_mask:0xf
v_and_b32_dpp v49, v26, v5 row_newbcast:12 row_mask:0xf bank_mask:0xf
v_and_b32_dpp v50, v26, v6 row_newbcast:12 row_mask:0xf bank_mask:0xf
v_and_b32_dpp v51, v26, v7 row_newbcast:12 row_mask:0xf bank_mask:0xf
s_nop 1
v_mfma_f32_16x16x32_bf16 v[16:19], v[48:51], a[120:123], v[16:19]
s_waitcnt vmcnt(7)
buffer_load_dwordx4 v0, s[4:7], s45 offen offset:3072 nt lds
s_add_u32 s45, s45, 16384
v_and_b32_dpp v36, v26, v4 row_newbcast:1 row_mask:0xf bank_mask:0xf
v_and_b32_dpp v37, v26, v5 row_newbcast:1 row_mask:0xf bank_mask:0xf
v_and_b32_dpp v38, v26, v6 row_newbcast:1 row_mask:0xf bank_mask:0xf
v_and_b32_dpp v39, v26, v7 row_newbcast:1 row_mask:0xf bank_mask:0xf
s_nop 1
v_mfma_f32_16x16x32_bf16 v[16:19], v[36:39], a[124:127], v[16:19]
v_add_u32 v33, s68, v0
s_nop 6
v_writelane_b32 v16, s60, 32
v_writelane_b32 v17, s61, 32
s_mov_b32 exec_lo, 0xffffffff
s_mov_b32 exec_hi, 0x1
ds_write_b128 v33, v[16:19] offset:0
s_mov_b64 exec, -1
s_add_u32 m0, s47, 29696
s_nop 0
buffer_load_dwordx4 v0, s[4:7], s45 offen offset:0 nt lds
buffer_load_dwordx4 v0, s[4:7], s45 offen offset:1024 nt lds
v_mov_b32 v34, s85
v_add_u32 v33, s85, v0
s_bitcmp0_b32 s40, 1
s_waitcnt lgkmcnt(0)
s_barrier
s_cbranch_scc0 Lp15
ds_read_b64 v[52:53], v34 offset:512
ds_read_b64 v[54:55], v34 offset:1040
ds_read_b64 v[16:17], v34 offset:1568
ds_read_b64 v[18:19], v34 offset:2096
s_mov_b32 exec_lo, 0xffffffff
s_mov_b32 exec_hi, 0x0
ds_read_b128 v[36:39], v33 offset:0
ds_read_b128 v[40:43], v33 offset:528
ds_read_b128 v[44:47], v33 offset:1056
ds_read_b128 v[48:51], v33 offset:1584
s_mov_b64 exec, -1
s_waitcnt lgkmcnt(4)
v_max3_f32 v33, v52, v54, v16
v_max_f32 v33, v33, v18
v_sub_f32 v52, v52, v33
v_sub_f32 v54, v54, v33
v_sub_f32 v16, v16, v33
v_sub_f32 v18, v18, v33
v_exp_f32 v52, v52
v_exp_f32 v54, v54
v_exp_f32 v16, v16
v_exp_f32 v18, v18
v_mul_f32 v35, v52, v53
v_fmac_f32 v35, v54, v55
v_fmac_f32 v35, v16, v17
v_fmac_f32 v35, v18, v19
s_waitcnt lgkmcnt(0)
v_mul_f32 v36, v52, v36
v_mul_f32 v37, v52, v37
v_mul_f32 v38, v52, v38
v_mul_f32 v39, v52, v39
v_fmac_f32 v36, v54, v40
v_fmac_f32 v37, v54, v41
v_fmac_f32 v38, v54, v42
v_fmac_f32 v39, v54, v43
v_fmac_f32 v36, v16, v44
v_fmac_f32 v37, v16, v45
v_fmac_f32 v38, v16, v46
v_fmac_f32 v39, v16, v47
v_fmac_f32 v36, v18, v48
v_fmac_f32 v37, v18, v49
v_fmac_f32 v38, v18, v50
v_fmac_f32 v39, v18, v51
v_cvt_pk_bf16_f32 v36, v36, v37
v_cvt_pk_bf16_f32 v37, v38, v39
s_mov_b32 exec_lo, 0x0
s_mov_b32 exec_hi, 0xff
v_mov_b32 v36, v33
v_or_b32 v37, s83, v35
s_mov_b32 exec_lo, -1
v_and_or_b32 v36, v36, -2, s89
v_and_or_b32 v37, v37, -2, s89
s_cmp_lg_u32 s83, 0
s_cbranch_scc1 Lp16
buffer_store_dwordx2 v[36:37], v32, s[12:15], s52 offen
s_branch Lp17
Lp16:
buffer_store_dwordx2 v[36:37], v32, s[12:15], s52 offen sc1
Lp17:
s_mov_b64 exec, -1
Lp15:
s_xor_b32 s52, s52, 640
s_waitcnt vmcnt(9)
s_waitcnt vmcnt(8)
s_waitcnt vmcnt(7)
buffer_load_dwordx4 v0, s[4:7], s45 offen offset:2048 nt lds
s_waitcnt vmcnt(7)
buffer_load_dwordx4 v0, s[4:7], s45 offen offset:3072 nt lds
s_add_u32 s45, s45, 16384
v_add_u32 v33, s48, v1
ds_read_b128 v[36:39], v33 offset:0
ds_read_b128 v[40:43], v33 offset:1024
ds_read_b128 v[44:47], v33 offset:2048
ds_read_b128 v[48:51], v33 offset:3072
s_waitcnt lgkmcnt(0)
v_dot2_f32_bf16 v52, v36, v8, 0
v_dot2_f32_bf16 v53, v40, v8, 0
v_dot2_f32_bf16 v54, v44, v8, 0
v_dot2_f32_bf16 v55, v48, v8, 0
v_dot2c_f32_bf16 v52, v37, v9
v_dot2c_f32_bf16 v53, v41, v9
v_dot2c_f32_bf16 v54, v45, v9
v_dot2c_f32_bf16 v55, v49, v9
v_dot2c_f32_bf16 v52, v38, v10
v_dot2c_f32_bf16 v53, v42, v10
v_dot2c_f32_bf16 v54, v46, v10
v_dot2c_f32_bf16 v55, v50, v10
v_dot2c_f32_bf16 v52, v39, v11
v_dot2c_f32_bf16 v53, v43, v11
v_dot2c_f32_bf16 v54, v47, v11
v_dot2c_f32_bf16 v55, v51, v11
v_add_f32_dpp v33, v52, v52 row_ror:8 row_mask:0xf bank_mask:0x3
v_add_f32_dpp v34, v53, v53 row_ror:8 row_mask:0xf bank_mask:0x3
v_add_f32_dpp v33, v54, v54 row_ror:8 row_mask:0xf bank_mask:0xc
v_add_f32_dpp v34, v55, v55 row_ror:8 row_mask:0xf bank_mask:0xc
s_nop 0
v_add_f32_dpp v24, v33, v33 row_half_mirror row_mask:0xf bank_mask:0x5
v_add_f32_dpp v24, v34, v34 row_half_mirror row_mask:0xf bank_mask:0xa
s_waitcnt vmcnt(7)
s_add_u32 m0, s47, 33792
s_nop 0
buffer_load_dwordx4 v0, s[4:7], s45 offen offset:0 nt lds
s_waitcnt vmcnt(7)
buffer_load_dwordx4 v0, s[4:7], s45 offen offset:1024 nt lds
s_waitcnt vmcnt(7)
buffer_load_dwordx4 v0, s[4:7], s45 offen offset:2048 nt lds
s_waitcnt vmcnt(7)
buffer_load_dwordx4 v0, s[4:7], s45 offen offset:3072 nt lds
s_add_u32 s45, s45, 16384
ds_read_b128 v[36:39], v1 offset:25600
ds_read_b128 v[40:43], v1 offset:26624
ds_read_b128 v[44:47], v1 offset:27648
ds_read_b128 v[48:51], v1 offset:28672
s_waitcnt lgkmcnt(0)
v_dot2_f32_bf16 v52, v36, v8, 0
v_dot2_f32_bf16 v53, v40, v8, 0
v_dot2_f32_bf16 v54, v44, v8, 0
v_dot2_f32_bf16 v55, v48, v8, 0
v_dot2c_f32_bf16 v52, v37, v9
v_dot2c_f32_bf16 v53, v41, v9
v_dot2c_f32_bf16 v54, v45, v9
v_dot2c_f32_bf16 v55, v49, v9
v_dot2c_f32_bf16 v52, v38, v10
v_dot2c_f32_bf16 v53, v42, v10
v_dot2c_f32_bf16 v54, v46, v10
v_dot2c_f32_bf16 v55, v50, v10
v_dot2c_f32_bf16 v52, v39, v11
v_dot2c_f32_bf16 v53, v43, v11
v_dot2c_f32_bf16 v54, v47, v11
v_dot2c_f32_bf16 v55, v51, v11
v_add_f32_dpp v33, v52, v52 row_ror:8 row_mask:0xf bank_mask:0x3
v_add_f32_dpp v34, v53, v53 row_ror:8 row_mask:0xf bank_mask:0x3
v_add_f32_dpp v33, v54, v54 row_ror:8 row_mask:0xf bank_mask:0xc
v_add_f32_dpp v34, v55, v55 row_ror:8 row_mask:0xf bank_mask:0xc
s_nop 0
v_add_f32_dpp v35, v33, v33 row_half_mirror row_mask:0xf bank_mask:0x5
v_add_f32_dpp v35, v34, v34 row_half_mirror row_mask:0xf bank_mask:0xa
v_cndmask_b32 v33, v24, v35, s[54:55]
v_cndmask_b32 v34, v35, v24, s[54:55]
s_nop 1
v_add_f32_dpp v24, v34, v33 quad_perm:[1,0,3,2] row_mask:0xf bank_mask:0xf
s_waitcnt vmcnt(7)
s_barrier
buffer_load_dwordx4 v[156:159], v0, s[4:7], s45 offen offset:0 nt
s_waitcnt vmcnt(7)
buffer_load_dwordx4 v[160:163], v0, s[4:7], s45 offen offset:1024 nt
s_waitcnt vmcnt(7)
buffer_load_dwordx4 v[164:167], v0, s[4:7], s45 offen offset:2048 nt
s_waitcnt vmcnt(7)
buffer_load_dwordx4 v[168:171], v0, s[4:7], s45 offen offset:3072 nt
s_add_u32 s45, s45, 16384
ds_read_b128 v[36:39], v1 offset:29696
ds_read_b128 v[40:43], v1 offset:30720
ds_read_b128 v[44:47], v1 offset:31744
ds_read_b128 v[48:51], v1 offset:32768
s_waitcnt lgkmcnt(0)
v_dot2_f32_bf16 v52, v36, v8, 0
v_dot2_f32_bf16 v53, v40, v8, 0
v_dot2_f32_bf16 v54, v44, v8, 0
v_dot2_f32_bf16 v55, v48, v8, 0
v_dot2c_f32_bf16 v52, v37, v9
v_dot2c_f32_bf16 v53, v41, v9
v_dot2c_f32_bf16 v54, v45, v9
v_dot2c_f32_bf16 v55, v49, v9
v_dot2c_f32_bf16 v52, v38, v10
v_dot2c_f32_bf16 v53, v42, v10
v_dot2c_f32_bf16 v54, v46, v10
v_dot2c_f32_bf16 v55, v50, v10
v_dot2c_f32_bf16 v52, v39, v11
v_dot2c_f32_bf16 v53, v43, v11
v_dot2c_f32_bf16 v54, v47, v11
v_dot2c_f32_bf16 v55, v51, v11
v_add_f32_dpp v33, v52, v52 row_ror:8 row_mask:0xf bank_mask:0x3
v_add_f32_dpp v34, v53, v53 row_ror:8 row_mask:0xf bank_mask:0x3
v_add_f32_dpp v33, v54, v54 row_ror:8 row_mask:0xf bank_mask:0xc
v_add_f32_dpp v34, v55, v55 row_ror:8 row_mask:0xf bank_mask:0xc
s_nop 0
v_add_f32_dpp v27, v33, v33 row_half_mirror row_mask:0xf bank_mask:0x5
v_add_f32_dpp v27, v34, v34 row_half_mirror row_mask:0xf bank_mask:0xa
s_waitcnt vmcnt(7)
buffer_load_dwordx4 v[172:175], v0, s[4:7], s45 offen offset:0 nt
s_waitcnt vmcnt(7)
buffer_load_dwordx4 v[176:179], v0, s[4:7], s45 offen offset:1024 nt
s_waitcnt vmcnt(7)
buffer_load_dwordx4 v[180:183], v0, s[4:7], s45 offen offset:2048 nt
s_waitcnt vmcnt(7)
buffer_load_dwordx4 v[184:187], v0, s[4:7], s45 offen offset:3072 nt
s_add_u32 s45, s45, 16384
ds_read_b128 v[36:39], v1 offset:33792
ds_read_b128 v[40:43], v1 offset:34816
ds_read_b128 v[44:47], v1 offset:35840
ds_read_b128 v[48:51], v1 offset:36864
s_waitcnt lgkmcnt(0)
v_dot2_f32_bf16 v52, v36, v8, 0
v_dot2_f32_bf16 v53, v40, v8, 0
v_dot2_f32_bf16 v54, v44, v8, 0
v_dot2_f32_bf16 v55, v48, v8, 0
v_dot2c_f32_bf16 v52, v37, v9
v_dot2c_f32_bf16 v53, v41, v9
v_dot2c_f32_bf16 v54, v45, v9
v_dot2c_f32_bf16 v55, v49, v9
v_dot2c_f32_bf16 v52, v38, v10
v_dot2c_f32_bf16 v53, v42, v10
v_dot2c_f32_bf16 v54, v46, v10
v_dot2c_f32_bf16 v55, v50, v10
v_dot2c_f32_bf16 v52, v39, v11
v_dot2c_f32_bf16 v53, v43, v11
v_dot2c_f32_bf16 v54, v47, v11
v_dot2c_f32_bf16 v55, v51, v11
v_add_f32_dpp v33, v52, v52 row_ror:8 row_mask:0xf bank_mask:0x3
v_add_f32_dpp v34, v53, v53 row_ror:8 row_mask:0xf bank_mask:0x3
v_add_f32_dpp v33, v54, v54 row_ror:8 row_mask:0xf bank_mask:0xc
v_add_f32_dpp v34, v55, v55 row_ror:8 row_mask:0xf bank_mask:0xc
s_nop 0
v_add_f32_dpp v35, v33, v33 row_half_mirror row_mask:0xf bank_mask:0x5
v_add_f32_dpp v35, v34, v34 row_half_mirror row_mask:0xf bank_mask:0xa
v_cndmask_b32 v33, v27, v35, s[54:55]
v_cndmask_b32 v34, v35, v27, s[54:55]
s_nop 1
v_add_f32_dpp v27, v34, v33 quad_perm:[1,0,3,2] row_mask:0xf bank_mask:0xf
v_cndmask_b32 v33, v24, v27, s[56:57]
v_cndmask_b32 v34, v27, v24, s[56:57]
s_nop 1
v_add_f32_dpp v24, v34, v33 quad_perm:[2,3,0,1] row_mask:0xf bank_mask:0xf
s_waitcnt vmcnt(7)
s_barrier
buffer_load_dwordx4 v[188:191], v0, s[4:7], s45 offen offset:0 nt
s_waitcnt vmcnt(7)
buffer_load_dwordx4 v[192:195], v0, s[4:7], s45 offen offset:1024 nt
s_waitcnt vmcnt(7)
buffer_load_dwordx4 v[196:199], v0, s[4:7], s45 offen offset:2048 nt
s_waitcnt vmcnt(7)
buffer_load_dwordx4 v[200:203], v0, s[4:7], s45 offen offset:3072 nt
s_add_u32 s45, s45, 16384
v_dot2_f32_bf16 v52, v156, v8, 0
v_dot2_f32_bf16 v53, v160, v8, 0
v_dot2_f32_bf16 v54, v164, v8, 0
v_dot2_f32_bf16 v55, v168, v8, 0
v_dot2c_f32_bf16 v52, v157, v9
v_dot2c_f32_bf16 v53, v161, v9
v_dot2c_f32_bf16 v54, v165, v9
v_dot2c_f32_bf16 v55, v169, v9
v_dot2c_f32_bf16 v52, v158, v10
v_dot2c_f32_bf16 v53, v162, v10
v_dot2c_f32_bf16 v54, v166, v10
v_dot2c_f32_bf16 v55, v170, v10
v_dot2c_f32_bf16 v52, v159, v11
v_dot2c_f32_bf16 v53, v163, v11
v_dot2c_f32_bf16 v54, v167, v11
v_dot2c_f32_bf16 v55, v171, v11
v_add_f32_dpp v33, v52, v52 row_ror:8 row_mask:0xf bank_mask:0x3
v_add_f32_dpp v34, v53, v53 row_ror:8 row_mask:0xf bank_mask:0x3
v_add_f32_dpp v33, v54, v54 row_ror:8 row_mask:0xf bank_mask:0xc
v_add_f32_dpp v34, v55, v55 row_ror:8 row_mask:0xf bank_mask:0xc
s_nop 0
v_add_f32_dpp v25, v33, v33 row_half_mirror row_mask:0xf bank_mask:0x5
v_add_f32_dpp v25, v34, v34 row_half_mirror row_mask:0xf bank_mask:0xa
s_waitcnt vmcnt(7)
buffer_load_dwordx4 v[204:207], v0, s[4:7], s45 offen offset:0 nt
s_waitcnt vmcnt(7)
buffer_load_dwordx4 v[208:211], v0, s[4:7], s45 offen offset:1024 nt
s_waitcnt vmcnt(7)
buffer_load_dwordx4 v[212:215], v0, s[4:7], s45 offen offset:2048 nt
s_waitcnt vmcnt(7)
buffer_load_dwordx4 v[216:219], v0, s[4:7], s45 offen offset:3072 nt
s_add_u32 s45, s45, 16384
v_dot2_f32_bf16 v52, v172, v8, 0
v_dot2_f32_bf16 v53, v176, v8, 0
v_dot2_f32_bf16 v54, v180, v8, 0
v_dot2_f32_bf16 v55, v184, v8, 0
v_dot2c_f32_bf16 v52, v173, v9
v_dot2c_f32_bf16 v53, v177, v9
v_dot2c_f32_bf16 v54, v181, v9
v_dot2c_f32_bf16 v55, v185, v9
v_dot2c_f32_bf16 v52, v174, v10
v_dot2c_f32_bf16 v53, v178, v10
v_dot2c_f32_bf16 v54, v182, v10
v_dot2c_f32_bf16 v55, v186, v10
v_dot2c_f32_bf16 v52, v175, v11
v_dot2c_f32_bf16 v53, v179, v11
v_dot2c_f32_bf16 v54, v183, v11
v_dot2c_f32_bf16 v55, v187, v11
v_add_f32_dpp v33, v52, v52 row_ror:8 row_mask:0xf bank_mask:0x3
v_add_f32_dpp v34, v53, v53 row_ror:8 row_mask:0xf bank_mask:0x3
v_add_f32_dpp v33, v54, v54 row_ror:8 row_mask:0xf bank_mask:0xc
v_add_f32_dpp v34, v55, v55 row_ror:8 row_mask:0xf bank_mask:0xc
s_nop 0
v_add_f32_dpp v35, v33, v33 row_half_mirror row_mask:0xf bank_mask:0x5
v_add_f32_dpp v35, v34, v34 row_half_mirror row_mask:0xf bank_mask:0xa
v_cndmask_b32 v33, v25, v35, s[54:55]
v_cndmask_b32 v34, v35, v25, s[54:55]
s_nop 1
v_add_f32_dpp v25, v34, v33 quad_perm:[1,0,3,2] row_mask:0xf bank_mask:0xf
s_waitcnt vmcnt(7)
s_barrier
buffer_load_dwordx4 v[220:223], v0, s[4:7], s45 offen offset:0 nt
s_waitcnt vmcnt(7)
buffer_load_dwordx4 v[224:227], v0, s[4:7], s45 offen offset:1024 nt
s_waitcnt vmcnt(7)
buffer_load_dwordx4 v[228:231], v0, s[4:7], s45 offen offset:2048 nt
s_waitcnt vmcnt(7)
buffer_load_dwordx4 v[232:235], v0, s[4:7], s45 offen offset:3072 nt
s_add_u32 s45, s45, 16384
v_dot2_f32_bf16 v52, v188, v8, 0
v_dot2_f32_bf16 v53, v192, v8, 0
v_dot2_f32_bf16 v54, v196, v8, 0
v_dot2_f32_bf16 v55, v200, v8, 0
v_dot2c_f32_bf16 v52, v189, v9
v_dot2c_f32_bf16 v53, v193, v9
v_dot2c_f32_bf16 v54, v197, v9
v_dot2c_f32_bf16 v55, v201, v9
v_dot2c_f32_bf16 v52, v190, v10
v_dot2c_f32_bf16 v53, v194, v10
v_dot2c_f32_bf16 v54, v198, v10
v_dot2c_f32_bf16 v55, v202, v10
v_dot2c_f32_bf16 v52, v191, v11
v_dot2c_f32_bf16 v53, v195, v11
v_dot2c_f32_bf16 v54, v199, v11
v_dot2c_f32_bf16 v55, v203, v11
v_add_f32_dpp v33, v52, v52 row_ror:8 row_mask:0xf bank_mask:0x3
v_add_f32_dpp v34, v53, v53 row_ror:8 row_mask:0xf bank_mask:0x3
v_add_f32_dpp v33, v54, v54 row_ror:8 row_mask:0xf bank_mask:0xc
v_add_f32_dpp v34, v55, v55 row_ror:8 row_mask:0xf bank_mask:0xc
s_nop 0
v_add_f32_dpp v27, v33, v33 row_half_mirror row_mask:0xf bank_mask:0x5
v_add_f32_dpp v27, v34, v34 row_half_mirror row_mask:0xf bank_mask:0xa
s_waitcnt vmcnt(7)
s_add_u32 m0, s47, 37888
s_nop 0
buffer_load_dwordx4 v2, s[4:7], s44 offen nt lds
s_add_u32 s45, s44, s46
s_waitcnt vmcnt(7)
s_cmp_lt_u32 s86, 1
s_cbranch_scc1 1
s_waitcnt vmcnt(5)
s_barrier
buffer_load_dwordx4 v[236:239], v0, s[8:11], s45 offen offset:0 nt
s_waitcnt vmcnt(7)
s_cmp_lt_u32 s86, 1
s_cbranch_scc1 1
s_waitcnt vmcnt(5)
buffer_load_dwordx4 v[240:243], v0, s[8:11], s45 offen offset:1024 nt
s_waitcnt vmcnt(7)
s_cmp_lt_u32 s86, 1
s_cbranch_scc1 1
s_waitcnt vmcnt(5)
buffer_load_dwordx4 v[244:247], v0, s[8:11], s45 offen offset:2048 nt
v_dot2_f32_bf16 v52, v204, v8, 0
v_dot2_f32_bf16 v53, v208, v8, 0
v_dot2_f32_bf16 v54, v212, v8, 0
v_dot2_f32_bf16 v55, v216, v8, 0
v_dot2c_f32_bf16 v52, v205, v9
v_dot2c_f32_bf16 v53, v209, v9
v_dot2c_f32_bf16 v54, v213, v9
v_dot2c_f32_bf16 v55, v217, v9
v_dot2c_f32_bf16 v52, v206, v10
v_dot2c_f32_bf16 v53, v210, v10
v_dot2c_f32_bf16 v54, v214, v10
v_dot2c_f32_bf16 v55, v218, v10
v_dot2c_f32_bf16 v52, v207, v11
v_dot2c_f32_bf16 v53, v211, v11
v_dot2c_f32_bf16 v54, v215, v11
v_dot2c_f32_bf16 v55, v219, v11
v_add_f32_dpp v33, v52, v52 row_ror:8 row_mask:0xf bank_mask:0x3
v_add_f32_dpp v34, v53, v53 row_ror:8 row_mask:0xf bank_mask:0x3
v_add_f32_dpp v33, v54, v54 row_ror:8 row_mask:0xf bank_mask:0xc
v_add_f32_dpp v34, v55, v55 row_ror:8 row_mask:0xf bank_mask:0xc
s_nop 0
v_add_f32_dpp v35, v33, v33 row_half_mirror row_mask:0xf bank_mask:0x5
v_add_f32_dpp v35, v34, v34 row_half_mirror row_mask:0xf bank_mask:0xa
v_cndmask_b32 v33, v27, v35, s[54:55]
v_cndmask_b32 v34, v35, v27, s[54:55]
s_nop 1
v_add_f32_dpp v27, v34, v33 quad_perm:[1,0,3,2] row_mask:0xf bank_mask:0xf
v_cndmask_b32 v33, v25, v27, s[56:57]
v_cndmask_b32 v34, v27, v25, s[56:57]
s_nop 1
v_add_f32_dpp v25, v34, v33 quad_perm:[2,3,0,1] row_mask:0xf bank_mask:0xf
s_waitcnt vmcnt(7)
s_cmp_lt_u32 s86, 1
s_cbranch_scc1 1
s_waitcnt vmcnt(5)
buffer_load_dwordx4 v[248:251], v0, s[8:11], s45 offen offset:3072 nt
s_add_u32 s45, s45, 16384
s_waitcnt vmcnt(7)
s_cmp_lt_u32 s86, 1
s_cbranch_scc1 1
s_waitcnt vmcnt(5)
buffer_load_dwordx4 v[252:255], v0, s[8:11], s45 offen offset:0 nt
s_waitcnt vmcnt(7)
s_cmp_lt_u32 s86, 1
s_cbranch_scc1 1
s_waitcnt vmcnt(5)
buffer_load_dwordx4 a[128:131], v0, s[8:11], s45 offen offset:1024 nt
s_waitcnt vmcnt(7)
s_cmp_lt_u32 s86, 1
s_cbranch_scc1 1
s_waitcnt vmcnt(5)
buffer_load_dwordx4 a[132:135], v0, s[8:11], s45 offen offset:2048 nt
v_dot2_f32_bf16 v52, v220, v8, 0
v_dot2_f32_bf16 v53, v224, v8, 0
v_dot2_f32_bf16 v54, v228, v8, 0
v_dot2_f32_bf16 v55, v232, v8, 0
v_dot2c_f32_bf16 v52, v221, v9
v_dot2c_f32_bf16 v53, v225, v9
v_dot2c_f32_bf16 v54, v229, v9
v_dot2c_f32_bf16 v55, v233, v9
v_dot2c_f32_bf16 v52, v222, v10
v_dot2c_f32_bf16 v53, v226, v10
v_dot2c_f32_bf16 v54, v230, v10
v_dot2c_f32_bf16 v55, v234, v10
v_dot2c_f32_bf16 v52, v223, v11
v_dot2c_f32_bf16 v53, v227, v11
v_dot2c_f32_bf16 v54, v231, v11
v_dot2c_f32_bf16 v55, v235, v11
v_add_f32_dpp v33, v52, v52 row_ror:8 row_mask:0xf bank_mask:0x3
v_add_f32_dpp v34, v53, v53 row_ror:8 row_mask:0xf bank_mask:0x3
v_add_f32_dpp v33, v54, v54 row_ror:8 row_mask:0xf bank_mask:0xc
v_add_f32_dpp v34, v55, v55 row_ror:8 row_mask:0xf bank_mask:0xc
s_nop 0
v_add_f32_dpp v26, v33, v33 row_half_mirror row_mask:0xf bank_mask:0x5
v_add_f32_dpp v26, v34, v34 row_half_mirror row_mask:0xf bank_mask:0xa
s_waitcnt vmcnt(7)
s_cmp_lt_u32 s86, 1
s_cbranch_scc1 1
s_waitcnt vmcnt(5)
buffer_load_dwordx4 a[136:139], v0, s[8:11], s45 offen offset:3072 nt
s_add_u32 s45, s45, 16384
ds_read_b128 v[36:39], v1 offset:37888
s_waitcnt lgkmcnt(0)
v_dot2_f32_bf16 v52, v36, v8, 0
v_dot2_f32_bf16 v52, v37, v9, v52
v_dot2_f32_bf16 v52, v38, v10, v52
v_dot2_f32_bf16 v52, v39, v11, v52
s_nop 2
v_add_f32_dpp v33, v52, v52 row_ror:8 row_mask:0xf bank_mask:0xf
s_nop 1
v_add_f32_dpp v35, v33, v33 row_half_mirror row_mask:0xf bank_mask:0xf
v_cndmask_b32 v33, v26, v35, s[54:55]
v_cndmask_b32 v34, v35, v26, s[54:55]
s_nop 1
v_add_f32_dpp v26, v34, v33 quad_perm:[1,0,3,2] row_mask:0xf bank_mask:0xf
s_nop 1
v_add_f32_dpp v26, v26, v26 quad_perm:[2,3,0,1] row_mask:0xf bank_mask:0xf
v_mul_f32 v24, 0x3e0293ee, v24
v_mul_f32 v25, 0x3e0293ee, v25
v_mul_f32 v26, 0x3e0293ee, v26
v_mov_b32 v34, 0xff800000
v_cndmask_b32 v26, v34, v26, s[58:59]
v_max3_f32 v33, v24, v25, v26
s_nop 1
v_max_f32_dpp v33, v33, v33 quad_perm:[1,0,3,2] row_mask:0xf bank_mask:0xf
s_nop 1
v_max_f32_dpp v33, v33, v33 quad_perm:[2,3,0,1] row_mask:0xf bank_mask:0xf
s_nop 1
v_max_f32_dpp v33, v33, v33 row_ror:4 row_mask:0xf bank_mask:0xf
s_nop 1
v_max_f32_dpp v33, v33, v33 row_ror:8 row_mask:0xf bank_mask:0xf
s_nop 1
v_max_f32_dpp v33, v33, v33 row_bcast:15 row_mask:0xa bank_mask:0xf
s_nop 1
v_max_f32_dpp v33, v33, v33 row_bcast:31 row_mask:0xc bank_mask:0xf
s_nop 0
v_readlane_b32 s60, v33, 63
s_nop 1
v_subrev_f32 v24, s60, v24
v_subrev_f32 v25, s60, v25
v_subrev_f32 v26, s60, v26
v_exp_f32 v24, v24
v_exp_f32 v25, v25
v_exp_f32 v26, v26
v_add_f32 v33, v24, v25
v_add_f32 v33, v33, v26
v_cvt_pk_bf16_f32 v24, v24, v24
v_cvt_pk_bf16_f32 v25, v25, v25
v_cvt_pk_bf16_f32 v26, v26, v26
v_add_f32_dpp v33, v33, v33 quad_perm:[1,0,3,2] row_mask:0xf bank_mask:0xf
s_nop 1
v_add_f32_dpp v33, v33, v33 quad_perm:[2,3,0,1] row_mask:0xf bank_mask:0xf
s_nop 1
v_add_f32_dpp v33, v33, v33 row_ror:4 row_mask:0xf bank_mask:0xf
s_nop 1
v_add_f32_dpp v33, v33, v33 row_ror:8 row_mask:0xf bank_mask:0xf
s_nop 1
v_add_f32_dpp v33, v33, v33 row_bcast:15 row_mask:0xa bank_mask:0xf
s_nop 1
v_add_f32_dpp v33, v33, v33 row_bcast:31 row_mask:0xc bank_mask:0xf
s_nop 0
v_readlane_b32 s61, v33, 63
s_waitcnt vmcnt(7)
s_cmp_lt_u32 s86, 1
s_cbranch_scc1 1
s_waitcnt vmcnt(5)
s_barrier
buffer_load_dwordx4 a[140:143], v0, s[8:11], s45 offen offset:0 nt
v_and_b32_dpp v40, v24, v4 row_newbcast:0 row_mask:0xf bank_mask:0xf
v_and_b32_dpp v41, v24, v5 row_newbcast:0 row_mask:0xf bank_mask:0xf
v_and_b32_dpp v42, v24, v6 row_newbcast:0 row_mask:0xf bank_mask:0xf
v_and_b32_dpp v43, v24, v7 row_newbcast:0 row_mask:0xf bank_mask:0xf
s_nop 1
v_mfma_f32_16x16x32_bf16 v[16:19], v[40:43], v[236:239], 0
s_waitcnt vmcnt(7)
s_cmp_lt_u32 s86, 1
s_cbranch_scc1 1
s_waitcnt vmcnt(5)
buffer_load_dwordx4 a[144:147], v0, s[8:11], s45 offen offset:1024 nt
v_and_b32_dpp v44, v24, v4 row_newbcast:4 row_mask:0xf bank_mask:0xf
v_and_b32_dpp v45, v24, v5 row_newbcast:4 row_mask:0xf bank_mask:0xf
v_and_b32_dpp v46, v24, v6 row_newbcast:4 row_mask:0xf bank_mask:0xf
v_and_b32_dpp v47, v24, v7 row_newbcast:4 row_mask:0xf bank_mask:0xf
s_nop 1
v_mfma_f32_16x16x32_bf16 v[16:19], v[44:47], v[240:243], v[16:19]
s_waitcnt vmcnt(7)
s_cmp_lt_u32 s86, 1
s_cbranch_scc1 1
s_waitcnt vmcnt(5)
buffer_load_dwordx4 a[148:151], v0, s[8:11], s45 offen offset:2048 nt
v_and_b32_dpp v48, v24, v4 row_newbcast:8 row_mask:0xf bank_mask:0xf
v_and_b32_dpp v49, v24, v5 row_newbcast:8 row_mask:0xf bank_mask:0xf
v_and_b32_dpp v50, v24, v6 row_newbcast:8 row_mask:0xf bank_mask:0xf
v_and_b32_dpp v51, v24, v7 row_newbcast:8 row_mask:0xf bank_mask:0xf
s_nop 1
v_mfma_f32_16x16x32_bf16 v[16:19], v[48:51], v[244:247], v[16:19]
s_waitcnt vmcnt(7)
s_cmp_lt_u32 s86, 1
s_cbranch_scc1 1
s_waitcnt vmcnt(5)
buffer_load_dwordx4 a[152:155], v0, s[8:11], s45 offen offset:3072 nt
s_add_u32 s45, s45, 16384
v_and_b32_dpp v36, v24, v4 row_newbcast:12 row_mask:0xf bank_mask:0xf
v_and_b32_dpp v37, v24, v5 row_newbcast:12 row_mask:0xf bank_mask:0xf
v_and_b32_dpp v38, v24, v6 row_newbcast:12 row_mask:0xf bank_mask:0xf
v_and_b32_dpp v39, v24, v7 row_newbcast:12 row_mask:0xf bank_mask:0xf
s_nop 1
v_mfma_f32_16x16x32_bf16 v[16:19], v[36:39], v[248:251], v[16:19]
s_waitcnt vmcnt(7)
s_cmp_lt_u32 s86, 1
s_cbranch_scc1 1
s_waitcnt vmcnt(5)
buffer_load_dwordx4 a[156:159], v0, s[8:11], s45 offen offset:0 nt
v_and_b32_dpp v40, v24, v4 row_newbcast:1 row_mask:0xf bank_mask:0xf
v_and_b32_dpp v41, v24, v5 row_newbcast:1 row_mask:0xf bank_mask:0xf
v_and_b32_dpp v42, v24, v6 row_newbcast:1 row_mask:0xf bank_mask:0xf
v_and_b32_dpp v43, v24, v7 row_newbcast:1 row_mask:0xf bank_mask:0xf
s_nop 1
v_mfma_f32_16x16x32_bf16 v[16:19], v[40:43], v[252:255], v[16:19]
s_waitcnt vmcnt(7)
s_cmp_lt_u32 s86, 1
s_cbranch_scc1 1
s_waitcnt vmcnt(5)
buffer_load_dwordx4 a[160:163], v0, s[8:11], s45 offen offset:1024 nt
v_and_b32_dpp v44, v24, v4 row_newbcast:5 row_mask:0xf bank_mask:0xf
v_and_b32_dpp v45, v24, v5 row_newbcast:5 row_mask:0xf bank_mask:0xf
v_and_b32_dpp v46, v24, v6 row_newbcast:5 row_mask:0xf bank_mask:0xf
v_and_b32_dpp v47, v24, v7 row_newbcast:5 row_mask:0xf bank_mask:0xf
s_nop 1
v_mfma_f32_16x16x32_bf16 v[16:19], v[44:47], a[128:131], v[16:19]
buffer_load_dwordx4 v[8:11], v3, s[12:15], s50 offen sc1
s_waitcnt vmcnt(8)
s_cmp_lt_u32 s86, 1
s_cbranch_scc1 1
s_waitcnt vmcnt(5)
buffer_load_dwordx4 a[164:167], v0, s[8:11], s45 offen offset:2048 nt
v_and_b32_dpp v48, v24, v4 row_newbcast:9 row_mask:0xf bank_mask:0xf
v_and_b32_dpp v49, v24, v5 row_newbcast:9 row_mask:0xf bank_mask:0xf
v_and_b32_dpp v50, v24, v6 row_newbcast:9 row_mask:0xf bank_mask:0xf
v_and_b32_dpp v51, v24, v7 row_newbcast:9 row_mask:0xf bank_mask:0xf
s_nop 1
v_mfma_f32_16x16x32_bf16 v[16:19], v[48:51], a[132:135], v[16:19]
s_waitcnt vmcnt(8)
s_cmp_lt_u32 s86, 1
s_cbranch_scc1 1
s_waitcnt vmcnt(5)
buffer_load_dwordx4 a[168:171], v0, s[8:11], s45 offen offset:3072 nt
s_add_u32 s45, s45, 16384
v_and_b32_dpp v36, v24, v4 row_newbcast:13 row_mask:0xf bank_mask:0xf
v_and_b32_dpp v37, v24, v5 row_newbcast:13 row_mask:0xf bank_mask:0xf
v_and_b32_dpp v38, v24, v6 row_newbcast:13 row_mask:0xf bank_mask:0xf
v_and_b32_dpp v39, v24, v7 row_newbcast:13 row_mask:0xf bank_mask:0xf
s_nop 1
v_mfma_f32_16x16x32_bf16 v[16:19], v[36:39], a[136:139], v[16:19]
s_waitcnt vmcnt(8)
s_cmp_lt_u32 s86, 1
s_cbranch_scc1 1
s_waitcnt vmcnt(5)
s_barrier
buffer_load_dwordx4 a[172:175], v0, s[8:11], s45 offen offset:0 nt
v_and_b32_dpp v40, v24, v4 row_newbcast:2 row_mask:0xf bank_mask:0xf
v_and_b32_dpp v41, v24, v5 row_newbcast:2 row_mask:0xf bank_mask:0xf
v_and_b32_dpp v42, v24, v6 row_newbcast:2 row_mask:0xf bank_mask:0xf
v_and_b32_dpp v43, v24, v7 row_newbcast:2 row_mask:0xf bank_mask:0xf
s_nop 1
v_mfma_f32_16x16x32_bf16 v[16:19], v[40:43], a[140:143], v[16:19]
s_waitcnt vmcnt(8)
s_cmp_lt_u32 s86, 1
s_cbranch_scc1 1
s_waitcnt vmcnt(5)
buffer_load_dwordx4 a[176:179], v0, s[8:11], s45 offen offset:1024 nt
v_and_b32_dpp v44, v24, v4 row_newbcast:6 row_mask:0xf bank_mask:0xf
v_and_b32_dpp v45, v24, v5 row_newbcast:6 row_mask:0xf bank_mask:0xf
v_and_b32_dpp v46, v24, v6 row_newbcast:6 row_mask:0xf bank_mask:0xf
v_and_b32_dpp v47, v24, v7 row_newbcast:6 row_mask:0xf bank_mask:0xf
s_nop 1
v_mfma_f32_16x16x32_bf16 v[16:19], v[44:47], a[144:147], v[16:19]
s_waitcnt vmcnt(8)
s_cmp_lt_u32 s86, 1
s_cbranch_scc1 1
s_waitcnt vmcnt(5)
buffer_load_dwordx4 a[180:183], v0, s[8:11], s45 offen offset:2048 nt
v_and_b32_dpp v48, v24, v4 row_newbcast:10 row_mask:0xf bank_mask:0xf
v_and_b32_dpp v49, v24, v5 row_newbcast:10 row_mask:0xf bank_mask:0xf
v_and_b32_dpp v50, v24, v6 row_newbcast:10 row_mask:0xf bank_mask:0xf
v_and_b32_dpp v51, v24, v7 row_newbcast:10 row_mask:0xf bank_mask:0xf
s_nop 1
v_mfma_f32_16x16x32_bf16 v[16:19], v[48:51], a[148:151], v[16:19]
s_waitcnt vmcnt(8)
s_cmp_lt_u32 s86, 1
s_cbranch_scc1 1
s_waitcnt vmcnt(5)
buffer_load_dwordx4 a[184:187], v0, s[8:11], s45 offen offset:3072 nt
s_add_u32 s45, s45, 16384
v_and_b32_dpp v36, v24, v4 row_newbcast:14 row_mask:0xf bank_mask:0xf
v_and_b32_dpp v37, v24, v5 row_newbcast:14 row_mask:0xf bank_mask:0xf
v_and_b32_dpp v38, v24, v6 row_newbcast:14 row_mask:0xf bank_mask:0xf
v_and_b32_dpp v39, v24, v7 row_newbcast:14 row_mask:0xf bank_mask:0xf
s_nop 1
v_mfma_f32_16x16x32_bf16 v[16:19], v[36:39], a[152:155], v[16:19]
s_waitcnt vmcnt(8)
s_cmp_lt_u32 s86, 1
s_cbranch_scc1 1
s_waitcnt vmcnt(5)
buffer_load_dwordx4 a[188:191], v0, s[8:11], s45 offen offset:0 nt
v_and_b32_dpp v40, v24, v4 row_newbcast:3 row_mask:0xf bank_mask:0xf
v_and_b32_dpp v41, v24, v5 row_newbcast:3 row_mask:0xf bank_mask:0xf
v_and_b32_dpp v42, v24, v6 row_newbcast:3 row_mask:0xf bank_mask:0xf
v_and_b32_dpp v43, v24, v7 row_newbcast:3 row_mask:0xf bank_mask:0xf
s_nop 1
v_mfma_f32_16x16x32_bf16 v[16:19], v[40:43], a[156:159], v[16:19]
s_waitcnt vmcnt(8)
s_cmp_lt_u32 s86, 1
s_cbranch_scc1 1
s_waitcnt vmcnt(5)
buffer_load_dwordx4 a[192:195], v0, s[8:11], s45 offen offset:1024 nt
v_and_b32_dpp v44, v24, v4 row_newbcast:7 row_mask:0xf bank_mask:0xf
v_and_b32_dpp v45, v24, v5 row_newbcast:7 row_mask:0xf bank_mask:0xf
v_and_b32_dpp v46, v24, v6 row_newbcast:7 row_mask:0xf bank_mask:0xf
v_and_b32_dpp v47, v24, v7 row_newbcast:7 row_mask:0xf bank_mask:0xf
s_nop 1
v_mfma_f32_16x16x32_bf16 v[16:19], v[44:47], a[160:163], v[16:19]
s_waitcnt vmcnt(8)
s_nop 6
Lq18:
v_max3_u32 v33, v8, v9, v10
v_max_u32 v33, v33, v11
v_cmp_eq_u32 vcc, -1, v33
s_nop 0
s_cbranch_vccz Lq19
s_sleep 1
buffer_load_dwordx4 v[8:11], v3, s[12:15], s50 offen sc1
s_waitcnt vmcnt(0)
s_sub_u32 s64, s64, 1
s_cmp_gt_i32 s64, 0
s_cbranch_scc1 Lq18
Lq19:
s_add_u32 s50, s50, 256
s_waitcnt vmcnt(7)
s_cmp_lt_u32 s86, 1
s_cbranch_scc1 1
s_waitcnt vmcnt(5)
buffer_load_dwordx4 a[196:199], v0, s[8:11], s45 offen offset:2048 nt
v_and_b32_dpp v48, v24, v4 row_newbcast:11 row_mask:0xf bank_mask:0xf
v_and_b32_dpp v49, v24, v5 row_newbcast:11 row_mask:0xf bank_mask:0xf
v_and_b32_dpp v50, v24, v6 row_newbcast:11 row_mask:0xf bank_mask:0xf
v_and_b32_dpp v51, v24, v7 row_newbcast:11 row_mask:0xf bank_mask:0xf
s_nop 1
v_mfma_f32_16x16x32_bf16 v[16:19], v[48:51], a[164:167], v[16:19]
s_waitcnt vmcnt(7)
s_cmp_lt_u32 s86, 1
s_cbranch_scc1 1
s_waitcnt vmcnt(5)
buffer_load_dwordx4 a[200:203], v0, s[8:11], s45 offen offset:3072 nt
s_add_u32 s45, s45, 16384
v_and_b32_dpp v36, v24, v4 row_newbcast:15 row_mask:0xf bank_mask:0xf
v_and_b32_dpp v37, v24, v5 row_newbcast:15 row_mask:0xf bank_mask:0xf
v_and_b32_dpp v38, v24, v6 row_newbcast:15 row_mask:0xf bank_mask:0xf
v_and_b32_dpp v39, v24, v7 row_newbcast:15 row_mask:0xf bank_mask:0xf
s_nop 1
v_mfma_f32_16x16x32_bf16 v[16:19], v[36:39], a[168:171], v[16:19]
buffer_load_dwordx4 v[12:15], v3, s[12:15], s51 offen sc1
s_waitcnt vmcnt(8)
s_cmp_lt_u32 s86, 1
s_cbranch_scc1 1
s_waitcnt vmcnt(5)
s_barrier
buffer_load_dwordx4 a[204:207], v0, s[8:11], s45 offen offset:0 nt
v_and_b32_dpp v40, v25, v4 row_newbcast:0 row_mask:0xf bank_mask:0xf
v_and_b32_dpp v41, v25, v5 row_newbcast:0 row_mask:0xf bank_mask:0xf
v_and_b32_dpp v42, v25, v6 row_newbcast:0 row_mask:0xf bank_mask:0xf
v_and_b32_dpp v43, v25, v7 row_newbcast:0 row_mask:0xf bank_mask:0xf
s_nop 1
v_mfma_f32_16x16x32_bf16 v[16:19], v[40:43], a[172:175], v[16:19]
s_waitcnt vmcnt(8)
s_cmp_lt_u32 s86, 1
s_cbranch_scc1 1
s_waitcnt vmcnt(5)
buffer_load_dwordx4 a[208:211], v0, s[8:11], s45 offen offset:1024 nt
v_and_b32_dpp v44, v25, v4 row_newbcast:4 row_mask:0xf bank_mask:0xf
v_and_b32_dpp v45, v25, v5 row_newbcast:4 row_mask:0xf bank_mask:0xf
v_and_b32_dpp v46, v25, v6 row_newbcast:4 row_mask:0xf bank_mask:0xf
v_and_b32_dpp v47, v25, v7 row_newbcast:4 row_mask:0xf bank_mask:0xf
s_nop 1
v_mfma_f32_16x16x32_bf16 v[16:19], v[44:47], a[176:179], v[16:19]
s_waitcnt vmcnt(8)
s_cmp_lt_u32 s86, 1
s_cbranch_scc1 1
s_waitcnt vmcnt(5)
buffer_load_dwordx4 a[212:215], v0, s[8:11], s45 offen offset:2048 nt
v_and_b32_dpp v48, v25, v4 row_newbcast:8 row_mask:0xf bank_mask:0xf
v_and_b32_dpp v49, v25, v5 row_newbcast:8 row_mask:0xf bank_mask:0xf
v_and_b32_dpp v50, v25, v6 row_newbcast:8 row_mask:0xf bank_mask:0xf
v_and_b32_dpp v51, v25, v7 row_newbcast:8 row_mask:0xf bank_mask:0xf
s_nop 1
v_mfma_f32_16x16x32_bf16 v[16:19], v[48:51], a[180:183], v[16:19]
s_waitcnt vmcnt(8)
s_cmp_lt_u32 s86, 1
s_cbranch_scc1 1
s_waitcnt vmcnt(5)
buffer_load_dwordx4 a[216:219], v0, s[8:11], s45 offen offset:3072 nt
s_add_u32 s45, s45, 16384
v_and_b32_dpp v36, v25, v4 row_newbcast:12 row_mask:0xf bank_mask:0xf
v_and_b32_dpp v37, v25, v5 row_newbcast:12 row_mask:0xf bank_mask:0xf
v_and_b32_dpp v38, v25, v6 row_newbcast:12 row_mask:0xf bank_mask:0xf
v_and_b32_dpp v39, v25, v7 row_newbcast:12 row_mask:0xf bank_mask:0xf
s_nop 1
v_mfma_f32_16x16x32_bf16 v[16:19], v[36:39], a[184:187], v[16:19]
s_waitcnt vmcnt(8)
s_cmp_lt_u32 s86, 1
s_cbranch_scc1 1
s_waitcnt vmcnt(5)
buffer_load_dwordx4 a[220:223], v0, s[8:11], s45 offen offset:0 nt
v_and_b32_dpp v40, v25, v4 row_newbcast:1 row_mask:0xf bank_mask:0xf
v_and_b32_dpp v41, v25, v5 row_newbcast:1 row_mask:0xf bank_mask:0xf
v_and_b32_dpp v42, v25, v6 row_newbcast:1 row_mask:0xf bank_mask:0xf
v_and_b32_dpp v43, v25, v7 row_newbcast:1 row_mask:0xf bank_mask:0xf
s_nop 1
v_mfma_f32_16x16x32_bf16 v[16:19], v[40:43], a[188:191], v[16:19]
s_waitcnt vmcnt(8)
s_cmp_lt_u32 s86, 1
s_cbranch_scc1 1
s_waitcnt vmcnt(5)
buffer_load_dwordx4 a[224:227], v0, s[8:11], s45 offen offset:1024 nt
v_and_b32_dpp v44, v25, v4 row_newbcast:5 row_mask:0xf bank_mask:0xf
v_and_b32_dpp v45, v25, v5 row_newbcast:5 row_mask:0xf bank_mask:0xf
v_and_b32_dpp v46, v25, v6 row_newbcast:5 row_mask:0xf bank_mask:0xf
v_and_b32_dpp v47, v25, v7 row_newbcast:5 row_mask:0xf bank_mask:0xf
s_nop 1
v_mfma_f32_16x16x32_bf16 v[16:19], v[44:47], a[192:195], v[16:19]
s_waitcnt vmcnt(8)
s_cmp_lt_u32 s86, 1
s_cbranch_scc1 1
s_waitcnt vmcnt(5)
buffer_load_dwordx4 a[228:231], v0, s[8:11], s45 offen offset:2048 nt
v_and_b32_dpp v48, v25, v4 row_newbcast:9 row_mask:0xf bank_mask:0xf
v_and_b32_dpp v49, v25, v5 row_newbcast:9 row_mask:0xf bank_mask:0xf
v_and_b32_dpp v50, v25, v6 row_newbcast:9 row_mask:0xf bank_mask:0xf
v_and_b32_dpp v51, v25, v7 row_newbcast:9 row_mask:0xf bank_mask:0xf
s_nop 1
v_mfma_f32_16x16x32_bf16 v[16:19], v[48:51], a[196:199], v[16:19]
s_waitcnt vmcnt(8)
s_cmp_lt_u32 s86, 1
s_cbranch_scc1 1
s_waitcnt vmcnt(5)
buffer_load_dwordx4 a[232:235], v0, s[8:11], s45 offen offset:3072 nt
s_add_u32 s45, s45, 16384
v_and_b32_dpp v36, v25, v4 row_newbcast:13 row_mask:0xf bank_mask:0xf
v_and_b32_dpp v37, v25, v5 row_newbcast:13 row_mask:0xf bank_mask:0xf
v_and_b32_dpp v38, v25, v6 row_newbcast:13 row_mask:0xf bank_mask:0xf
v_and_b32_dpp v39, v25, v7 row_newbcast:13 row_mask:0xf bank_mask:0xf
s_nop 1
v_mfma_f32_16x16x32_bf16 v[16:19], v[36:39], a[200:203], v[16:19]
s_waitcnt vmcnt(8)
v_cmp_eq_u32 vcc, -1, v12
s_nop 0
s_cmp_lg_u64 vcc, 0
s_cselect_b32 s86, 1, 0
s_waitcnt vmcnt(7)
s_cmp_lt_u32 s86, 1
s_cbranch_scc1 1
s_waitcnt vmcnt(5)
s_barrier
buffer_load_dwordx4 a[236:239], v0, s[8:11], s45 offen offset:0 nt
v_and_b32_dpp v40, v25, v4 row_newbcast:2 row_mask:0xf bank_mask:0xf
v_and_b32_dpp v41, v25, v5 row_newbcast:2 row_mask:0xf bank_mask:0xf
v_and_b32_dpp v42, v25, v6 row_newbcast:2 row_mask:0xf bank_mask:0xf
v_and_b32_dpp v43, v25, v7 row_newbcast:2 row_mask:0xf bank_mask:0xf
s_nop 1
v_mfma_f32_16x16x32_bf16 v[16:19], v[40:43], a[204:207], v[16:19]
buffer_load_dwordx4 v[12:15], v3, s[12:15], s51 offen sc1
s_waitcnt vmcnt(8)
s_cmp_lt_u32 s86, 1
s_cbranch_scc1 1
s_waitcnt vmcnt(5)
buffer_load_dwordx4 a[240:243], v0, s[8:11], s45 offen offset:1024 nt
v_and_b32_dpp v44, v25, v4 row_newbcast:6 row_mask:0xf bank_mask:0xf
v_and_b32_dpp v45, v25, v5 row_newbcast:6 row_mask:0xf bank_mask:0xf
v_and_b32_dpp v46, v25, v6 row_newbcast:6 row_mask:0xf bank_mask:0xf
v_and_b32_dpp v47, v25, v7 row_newbcast:6 row_mask:0xf bank_mask:0xf
s_nop 1
v_mfma_f32_16x16x32_bf16 v[16:19], v[44:47], a[208:211], v[16:19]
s_waitcnt vmcnt(8)
s_cmp_lt_u32 s86, 1
s_cbranch_scc1 1
s_waitcnt vmcnt(5)
buffer_load_dwordx4 a[244:247], v0, s[8:11], s45 offen offset:2048 nt
v_and_b32_dpp v48, v25, v4 row_newbcast:10 row_mask:0xf bank_mask:0xf
v_and_b32_dpp v49, v25, v5 row_newbcast:10 row_mask:0xf bank_mask:0xf
v_and_b32_dpp v50, v25, v6 row_newbcast:10 row_mask:0xf bank_mask:0xf
v_and_b32_dpp v51, v25, v7 row_newbcast:10 row_mask:0xf bank_mask:0xf
s_nop 1
v_mfma_f32_16x16x32_bf16 v[16:19], v[48:51], a[212:215], v[16:19]
s_waitcnt vmcnt(8)
s_cmp_lt_u32 s86, 1
s_cbranch_scc1 1
s_waitcnt vmcnt(5)
buffer_load_dwordx4 a[248:251], v0, s[8:11], s45 offen offset:3072 nt
s_add_u32 s45, s45, 16384
v_and_b32_dpp v36, v25, v4 row_newbcast:14 row_mask:0xf bank_mask:0xf
v_and_b32_dpp v37, v25, v5 row_newbcast:14 row_mask:0xf bank_mask:0xf
v_and_b32_dpp v38, v25, v6 row_newbcast:14 row_mask:0xf bank_mask:0xf
v_and_b32_dpp v39, v25, v7 row_newbcast:14 row_mask:0xf bank_mask:0xf
s_nop 1
v_mfma_f32_16x16x32_bf16 v[16:19], v[36:39], a[216:219], v[16:19]
s_waitcnt vmcnt(8)
s_cmp_lt_u32 s86, 1
s_cbranch_scc1 1
s_waitcnt vmcnt(5)
buffer_load_dwordx4 a[252:255], v2, s[8:11], s44 offen nt
s_add_u32 s44, s44, 0x2000000
s_mov_b32 s88, s87
s_mov_b32 s87, s46
s_add_u32 s45, s44, s46
v_and_b32_dpp v40, v25, v4 row_newbcast:3 row_mask:0xf bank_mask:0xf
v_and_b32_dpp v41, v25, v5 row_newbcast:3 row_mask:0xf bank_mask:0xf
v_and_b32_dpp v42, v25, v6 row_newbcast:3 row_mask:0xf bank_mask:0xf
v_and_b32_dpp v43, v25, v7 row_newbcast:3 row_mask:0xf bank_mask:0xf
s_nop 1
v_mfma_f32_16x16x32_bf16 v[16:19], v[40:43], a[220:223], v[16:19]
s_mov_b32 s48, s49
s_add_u32 s49, s49, 4096
s_cmp_eq_u32 s49, 12288
s_cselect_b32 s49, 0, s49
s_mov_b32 s65, 3
s_nop 2
L_loop:
s_waitcnt vmcnt(8)
s_add_u32 m0, s47, s48
s_nop 0
buffer_load_dwordx4 v0, s[4:7], s45 offen offset:0 nt lds
v_and_b32_dpp v44, v25, v4 row_newbcast:7 row_mask:0xf bank_mask:0xf
v_and_b32_dpp v45, v25, v5 row_newbcast:7 row_mask:0xf bank_mask:0xf
v_and_b32_dpp v46, v25, v6 row_newbcast:7 row_mask:0xf bank_mask:0xf
v_and_b32_dpp v47, v25, v7 row_newbcast:7 row_mask:0xf bank_mask:0xf
s_nop 1
v_mfma_f32_16x16x32_bf16 v[16:19], v[44:47], a[224:227], v[16:19]
s_waitcnt vmcnt(8)
buffer_load_dwordx4 v0, s[4:7], s45 offen offset:1024 nt lds
v_and_b32_dpp v48, v25, v4 row_newbcast:11 row_mask:0xf bank_mask:0xf
v_and_b32_dpp v49, v25, v5 row_newbcast:11 row_mask:0xf bank_mask:0xf
v_and_b32_dpp v50, v25, v6 row_newbcast:11 row_mask:0xf bank_mask:0xf
v_and_b32_dpp v51, v25, v7 row_newbcast:11 row_mask:0xf bank_mask:0xf
s_nop 1
v_mfma_f32_16x16x32_bf16 v[16:19], v[48:51], a[228:231], v[16:19]
s_waitcnt vmcnt(8)
buffer_load_dwordx4 v0, s[4:7], s45 offen offset:2048 nt lds
v_and_b32_dpp v36, v25, v4 row_newbcast:15 row_mask:0xf bank_mask:0xf
v_and_b32_dpp v37, v25, v5 row_newbcast:15 row_mask:0xf bank_mask:0xf
v_and_b32_dpp v38, v25, v6 row_newbcast:15 row_mask:0xf bank_mask:0xf
v_and_b32_dpp v39, v25, v7 row_newbcast:15 row_mask:0xf bank_mask:0xf
s_nop 1
v_mfma_f32_16x16x32_bf16 v[16:19], v[36:39], a[232:235], v[16:19]
s_waitcnt vmcnt(8)
buffer_load_dwordx4 v0, s[4:7], s45 offen offset:3072 nt lds
s_add_u32 s45, s45, 16384
v_and_b32_dpp v40, v26, v4 row_newbcast:0 row_mask:0xf bank_mask:0xf
v_and_b32_dpp v41, v26, v5 row_newbcast:0 row_mask:0xf bank_mask:0xf
v_and_b32_dpp v42, v26, v6 row_newbcast:0 row_mask:0xf bank_mask:0xf
v_and_b32_dpp v43, v26, v7 row_newbcast:0 row_mask:0xf bank_mask:0xf
s_nop 1
v_mfma_f32_16x16x32_bf16 v[16:19], v[40:43], a[236:239], v[16:19]
s_waitcnt vmcnt(8)
s_nop 6
Lq20:
v_max3_u32 v33, v12, v13, v14
v_max_u32 v33, v33, v15
v_cmp_eq_u32 vcc, -1, v33
s_nop 0
s_cbranch_vccz Lq21
s_sleep 1
buffer_load_dwordx4 v[12:15], v3, s[12:15], s51 offen sc1
s_waitcnt vmcnt(0)
s_sub_u32 s64, s64, 1
s_cmp_gt_i32 s64, 0
s_cbranch_scc1 Lq20
Lq21:
s_add_u32 s51, s51, 256
ds_read_b128 v[36:39], v1 offset:12288
ds_read_b128 v[40:43], v1 offset:13312
ds_read_b128 v[44:47], v1 offset:14336
ds_read_b128 v[48:51], v1 offset:15360
s_waitcnt lgkmcnt(0)
v_dot2_f32_bf16 v52, v36, v12, 0
v_dot2_f32_bf16 v53, v40, v12, 0
v_dot2_f32_bf16 v54, v44, v12, 0
v_dot2_f32_bf16 v55, v48, v12, 0
v_dot2c_f32_bf16 v52, v37, v13
v_dot2c_f32_bf16 v53, v41, v13
v_dot2c_f32_bf16 v54, v45, v13
v_dot2c_f32_bf16 v55, v49, v13
v_dot2c_f32_bf16 v52, v38, v14
v_dot2c_f32_bf16 v53, v42, v14
v_dot2c_f32_bf16 v54, v46, v14
v_dot2c_f32_bf16 v55, v50, v14
v_dot2c_f32_bf16 v52, v39, v15
v_dot2c_f32_bf16 v53, v43, v15
v_dot2c_f32_bf16 v54, v47, v15
v_dot2c_f32_bf16 v55, v51, v15
v_add_f32_dpp v33, v52, v52 row_ror:8 row_mask:0xf bank_mask:0x3
v_add_f32_dpp v34, v53, v53 row_ror:8 row_mask:0xf bank_mask:0x3
v_add_f32_dpp v33, v54, v54 row_ror:8 row_mask:0xf bank_mask:0xc
v_add_f32_dpp v34, v55, v55 row_ror:8 row_mask:0xf bank_mask:0xc
s_nop 0
v_add_f32_dpp v28, v33, v33 row_half_mirror row_mask:0xf bank_mask:0x5
v_add_f32_dpp v28, v34, v34 row_half_mirror row_mask:0xf bank_mask:0xa
s_waitcnt vmcnt(7)
s_add_u32 m0, s47, 12288
s_nop 0
buffer_load_dwordx4 v0, s[4:7], s45 offen offset:0 nt lds
v_and_b32_dpp v44, v26, v4 row_newbcast:4 row_mask:0xf bank_mask:0xf
v_and_b32_dpp v45, v26, v5 row_newbcast:4 row_mask:0xf bank_mask:0xf
v_and_b32_dpp v46, v26, v6 row_newbcast:4 row_mask:0xf bank_mask:0xf
v_and_b32_dpp v47, v26, v7 row_newbcast:4 row_mask:0xf bank_mask:0xf
s_nop 1
v_mfma_f32_16x16x32_bf16 v[16:19], v[44:47], a[240:243], v[16:19]
v_add_u32 v33, s49, v1
ds_read_b128 v[36:39], v33 offset:0
ds_read_b128 v[40:43], v33 offset:1024
ds_read_b128 v[44:47], v33 offset:2048
ds_read_b128 v[48:51], v33 offset:3072
s_waitcnt lgkmcnt(0)
v_dot2_f32_bf16 v52, v36, v12, 0
v_dot2_f32_bf16 v53, v40, v12, 0
v_dot2_f32_bf16 v54, v44, v12, 0
v_dot2_f32_bf16 v55, v48, v12, 0
v_dot2c_f32_bf16 v52, v37, v13
v_dot2c_f32_bf16 v53, v41, v13
v_dot2c_f32_bf16 v54, v45, v13
v_dot2c_f32_bf16 v55, v49, v13
v_dot2c_f32_bf16 v52, v38, v14
v_dot2c_f32_bf16 v53, v42, v14
v_dot2c_f32_bf16 v54, v46, v14
v_dot2c_f32_bf16 v55, v50, v14
v_dot2c_f32_bf16 v52, v39, v15
v_dot2c_f32_bf16 v53, v43, v15
v_dot2c_f32_bf16 v54, v47, v15
v_dot2c_f32_bf16 v55, v51, v15
v_add_f32_dpp v33, v52, v52 row_ror:8 row_mask:0xf bank_mask:0x3
v_add_f32_dpp v34, v53, v53 row_ror:8 row_mask:0xf bank_mask:0x3
v_add_f32_dpp v33, v54, v54 row_ror:8 row_mask:0xf bank_mask:0xc
v_add_f32_dpp v34, v55, v55 row_ror:8 row_mask:0xf bank_mask:0xc
s_nop 0
v_add_f32_dpp v35, v33, v33 row_half_mirror row_mask:0xf bank_mask:0x5
v_add_f32_dpp v35, v34, v34 row_half_mirror row_mask:0xf bank_mask:0xa
v_cndmask_b32 v33, v35, v28, s[54:55]
v_cndmask_b32 v34, v28, v35, s[54:55]
s_nop 1
v_add_f32_dpp v28, v34, v33 quad_perm:[1,0,3,2] row_mask:0xf bank_mask:0xf
s_waitcnt vmcnt(7)
buffer_load_dwordx4 v0, s[4:7], s45 offen offset:1024 nt lds
v_and_b32_dpp v48, v26, v4 row_newbcast:8 row_mask:0xf bank_mask:0xf
v_and_b32_dpp v49, v26, v5 row_newbcast:8 row_mask:0xf bank_mask:0xf
v_and_b32_dpp v50, v26, v6 row_newbcast:8 row_mask:0xf bank_mask:0xf
v_and_b32_dpp v51, v26, v7 row_newbcast:8 row_mask:0xf bank_mask:0xf
s_nop 1
v_mfma_f32_16x16x32_bf16 v[16:19], v[48:51], a[244:247], v[16:19]
ds_read_b128 v[36:39], v1 offset:16384
ds_read_b128 v[40:43], v1 offset:17408
ds_read_b128 v[44:47], v1 offset:18432
ds_read_b128 v[48:51], v1 offset:19456
s_waitcnt lgkmcnt(0)
v_dot2_f32_bf16 v52, v36, v12, 0
v_dot2_f32_bf16 v53, v40, v12, 0
v_dot2_f32_bf16 v54, v44, v12, 0
v_dot2_f32_bf16 v55, v48, v12, 0
v_dot2c_f32_bf16 v52, v37, v13
v_dot2c_f32_bf16 v53, v41, v13
v_dot2c_f32_bf16 v54, v45, v13
v_dot2c_f32_bf16 v55, v49, v13
v_dot2c_f32_bf16 v52, v38, v14
v_dot2c_f32_bf16 v53, v42, v14
v_dot2c_f32_bf16 v54, v46, v14
v_dot2c_f32_bf16 v55, v50, v14
v_dot2c_f32_bf16 v52, v39, v15
v_dot2c_f32_bf16 v53, v43, v15
v_dot2c_f32_bf16 v54, v47, v15
v_dot2c_f32_bf16 v55, v51, v15
v_add_f32_dpp v33, v52, v52 row_ror:8 row_mask:0xf bank_mask:0x3
v_add_f32_dpp v34, v53, v53 row_ror:8 row_mask:0xf bank_mask:0x3
v_add_f32_dpp v33, v54, v54 row_ror:8 row_mask:0xf bank_mask:0xc
v_add_f32_dpp v34, v55, v55 row_ror:8 row_mask:0xf bank_mask:0xc
s_nop 0
v_add_f32_dpp v31, v33, v33 row_half_mirror row_mask:0xf bank_mask:0x5
v_add_f32_dpp v31, v34, v34 row_half_mirror row_mask:0xf bank_mask:0xa
s_waitcnt vmcnt(7)
buffer_load_dwordx4 v0, s[4:7], s45 offen offset:2048 nt lds
v_and_b32_dpp v36, v26, v4 row_newbcast:12 row_mask:0xf bank_mask:0xf
v_and_b32_dpp v37, v26, v5 row_newbcast:12 row_mask:0xf bank_mask:0xf
v_and_b32_dpp v38, v26, v6 row_newbcast:12 row_mask:0xf bank_mask:0xf
v_and_b32_dpp v39, v26, v7 row_newbcast:12 row_mask:0xf bank_mask:0xf
s_nop 1
v_mfma_f32_16x16x32_bf16 v[16:19], v[36:39], a[248:251], v[16:19]
s_waitcnt vmcnt(7)
buffer_load_dwordx4 v0, s[4:7], s45 offen offset:3072 nt lds
s_add_u32 s45, s45, 16384
v_and_b32_dpp v40, v26, v4 row_newbcast:1 row_mask:0xf bank_mask:0xf
v_and_b32_dpp v41, v26, v5 row_newbcast:1 row_mask:0xf bank_mask:0xf
v_and_b32_dpp v42, v26, v6 row_newbcast:1 row_mask:0xf bank_mask:0xf
v_and_b32_dpp v43, v26, v7 row_newbcast:1 row_mask:0xf bank_mask:0xf
s_nop 1
v_mfma_f32_16x16x32_bf16 v[16:19], v[40:43], a[252:255], v[16:19]
v_add_u32 v33, s68, v0
s_nop 6
v_writelane_b32 v16, s60, 32
v_writelane_b32 v17, s61, 32
s_mov_b32 exec_lo, 0xffffffff
s_mov_b32 exec_hi, 0x1
ds_write_b128 v33, v[16:19] offset:0
s_mov_b64 exec, -1
s_add_u32 m0, s47, 16384
s_nop 0
buffer_load_dwordx4 v0, s[4:7], s45 offen offset:0 nt lds
buffer_load_dwordx4 v0, s[4:7], s45 offen offset:1024 nt lds
v_mov_b32 v34, s85
v_add_u32 v33, s85, v0
s_bitcmp1_b32 s40, 1
s_waitcnt lgkmcnt(0)
s_barrier
s_cbranch_scc0 Lp22
ds_read_b64 v[52:53], v34 offset:512
ds_read_b64 v[54:55], v34 offset:1040
ds_read_b64 v[16:17], v34 offset:1568
ds_read_b64 v[18:19], v34 offset:2096
s_mov_b32 exec_lo, 0xffffffff
s_mov_b32 exec_hi, 0x0
ds_read_b128 v[36:39], v33 offset:0
ds_read_b128 v[40:43], v33 offset:528
ds_read_b128 v[44:47], v33 offset:1056
ds_read_b128 v[48:51], v33 offset:1584
s_mov_b64 exec, -1
s_waitcnt lgkmcnt(4)
v_max3_f32 v33, v52, v54, v16
v_max_f32 v33, v33, v18
v_sub_f32 v52, v52, v33
v_sub_f32 v54, v54, v33
v_sub_f32 v16, v16, v33
v_sub_f32 v18, v18, v33
v_exp_f32 v52, v52
v_exp_f32 v54, v54
v_exp_f32 v16, v16
v_exp_f32 v18, v18
v_mul_f32 v35, v52, v53
v_fmac_f32 v35, v54, v55
v_fmac_f32 v35, v16, v17
v_fmac_f32 v35, v18, v19
s_waitcnt lgkmcnt(0)
v_mul_f32 v36, v52, v36
v_mul_f32 v37, v52, v37
v_mul_f32 v38, v52, v38
v_mul_f32 v39, v52, v39
v_fmac_f32 v36, v54, v40
v_fmac_f32 v37, v54, v41
v_fmac_f32 v38, v54, v42
v_fmac_f32 v39, v54, v43
v_fmac_f32 v36, v16, v44
v_fmac_f32 v37, v16, v45
v_fmac_f32 v38, v16, v46
v_fmac_f32 v39, v16, v47
v_fmac_f32 v36, v18, v48
v_fmac_f32 v37, v18, v49
v_fmac_f32 v38, v18, v50
v_fmac_f32 v39, v18, v51
v_cvt_pk_bf16_f32 v36, v36, v37
v_cvt_pk_bf16_f32 v37, v38, v39
s_mov_b32 exec_lo, 0x0
s_mov_b32 exec_hi, 0xff
v_mov_b32 v36, v33
v_or_b32 v37, s83, v35
s_mov_b32 exec_lo, -1
v_and_or_b32 v36, v36, -2, s89
v_and_or_b32 v37, v37, -2, s89
s_cmp_lg_u32 s83, 0
s_cbranch_scc1 Lp23
buffer_store_dwordx2 v[36:37], v32, s[12:15], s52 offen
s_branch Lp24
Lp23:
buffer_store_dwordx2 v[36:37], v32, s[12:15], s52 offen sc1
Lp24:
s_mov_b64 exec, -1
Lp22:
s_xor_b32 s52, s52, 640
s_xor_b32 s89, s89, 1
s_waitcnt vmcnt(9)
s_waitcnt vmcnt(8)
s_waitcnt vmcnt(7)
buffer_load_dwordx4 v0, s[4:7], s45 offen offset:2048 nt lds
ds_read_b128 v[36:39], v1 offset:20480
ds_read_b128 v[40:43], v1 offset:21504
ds_read_b128 v[44:47], v1 offset:22528
ds_read_b128 v[48:51], v1 offset:23552
s_waitcnt lgkmcnt(0)
v_dot2_f32_bf16 v52, v36, v12, 0
v_dot2_f32_bf16 v53, v40, v12, 0
v_dot2_f32_bf16 v54, v44, v12, 0
v_dot2_f32_bf16 v55, v48, v12, 0
v_dot2c_f32_bf16 v52, v37, v13
v_dot2c_f32_bf16 v53, v41, v13
v_dot2c_f32_bf16 v54, v45, v13
v_dot2c_f32_bf16 v55, v49, v13
v_dot2c_f32_bf16 v52, v38, v14
v_dot2c_f32_bf16 v53, v42, v14
v_dot2c_f32_bf16 v54, v46, v14
v_dot2c_f32_bf16 v55, v50, v14
v_dot2c_f32_bf16 v52, v39, v15
v_dot2c_f32_bf16 v53, v43, v15
v_dot2c_f32_bf16 v54, v47, v15
v_dot2c_f32_bf16 v55, v51, v15
v_add_f32_dpp v33, v52, v52 row_ror:8 row_mask:0xf bank_mask:0x3
v_add_f32_dpp v34, v53, v53 row_ror:8 row_mask:0xf bank_mask:0x3
v_add_f32_dpp v33, v54, v54 row_ror:8 row_mask:0xf bank_mask:0xc
v_add_f32_dpp v34, v55, v55 row_ror:8 row_mask:0xf bank_mask:0xc
s_nop 0
v_add_f32_dpp v35, v33, v33 row_half_mirror row_mask:0xf bank_mask:0x5
v_add_f32_dpp v35, v34, v34 row_half_mirror row_mask:0xf bank_mask:0xa
v_cndmask_b32 v33, v31, v35, s[54:55]
v_cndmask_b32 v34, v35, v31, s[54:55]
s_nop 1
v_add_f32_dpp v31, v34, v33 quad_perm:[1,0,3,2] row_mask:0xf bank_mask:0xf
v_cndmask_b32 v33, v28, v31, s[56:57]
v_cndmask_b32 v34, v31, v28, s[56:57]
s_nop 1
v_add_f32_dpp v28, v34, v33 quad_perm:[2,3,0,1] row_mask:0xf bank_mask:0xf
s_waitcnt vmcnt(7)
buffer_load_dwordx4 v0, s[4:7], s45 offen offset:3072 nt lds
s_add_u32 s45, s45, 16384
v_add_u32 v33, s48, v1
ds_read_b128 v[36:39], v33 offset:0
ds_read_b128 v[40:43], v33 offset:1024
ds_read_b128 v[44:47], v33 offset:2048
ds_read_b128 v[48:51], v33 offset:3072
s_waitcnt lgkmcnt(0)
v_dot2_f32_bf16 v52, v36, v8, 0
v_dot2_f32_bf16 v53, v40, v8, 0
v_dot2_f32_bf16 v54, v44, v8, 0
v_dot2_f32_bf16 v55, v48, v8, 0
v_dot2c_f32_bf16 v52, v37, v9
v_dot2c_f32_bf16 v53, v41, v9
v_dot2c_f32_bf16 v54, v45, v9
v_dot2c_f32_bf16 v55, v49, v9
v_dot2c_f32_bf16 v52, v38, v10
v_dot2c_f32_bf16 v53, v42, v10
v_dot2c_f32_bf16 v54, v46, v10
v_dot2c_f32_bf16 v55, v50, v10
v_dot2c_f32_bf16 v52, v39, v11
v_dot2c_f32_bf16 v53, v43, v11
v_dot2c_f32_bf16 v54, v47, v11
v_dot2c_f32_bf16 v55, v51, v11
v_add_f32_dpp v33, v52, v52 row_ror:8 row_mask:0xf bank_mask:0x3
v_add_f32_dpp v34, v53, v53 row_ror:8 row_mask:0xf bank_mask:0x3
v_add_f32_dpp v33, v54, v54 row_ror:8 row_mask:0xf bank_mask:0xc
v_add_f32_dpp v34, v55, v55 row_ror:8 row_mask:0xf bank_mask:0xc
s_nop 0
v_add_f32_dpp v24, v33, v33 row_half_mirror row_mask:0xf bank_mask:0x5
v_add_f32_dpp v24, v34, v34 row_half_mirror row_mask:0xf bank_mask:0xa
s_waitcnt vmcnt(7)
s_add_u32 m0, s47, 20480
s_nop 0
buffer_load_dwordx4 v0, s[4:7], s45 offen offset:0 nt lds
s_waitcnt vmcnt(7)
buffer_load_dwordx4 v0, s[4:7], s45 offen offset:1024 nt lds
s_waitcnt vmcnt(7)
buffer_load_dwordx4 v0, s[4:7], s45 offen offset:2048 nt lds
v_dot2_f32_bf16 v52, v56, v12, 0
v_dot2_f32_bf16 v53, v60, v12, 0
v_dot2_f32_bf16 v54, v64, v12, 0
v_dot2_f32_bf16 v55, v68, v12, 0
v_dot2c_f32_bf16 v52, v57, v13
v_dot2c_f32_bf16 v53, v61, v13
v_dot2c_f32_bf16 v54, v65, v13
v_dot2c_f32_bf16 v55, v69, v13
v_dot2c_f32_bf16 v52, v58, v14
v_dot2c_f32_bf16 v53, v62, v14
v_dot2c_f32_bf16 v54, v66, v14
v_dot2c_f32_bf16 v55, v70, v14
v_dot2c_f32_bf16 v52, v59, v15
v_dot2c_f32_bf16 v53, v63, v15
v_dot2c_f32_bf16 v54, v67, v15
v_dot2c_f32_bf16 v55, v71, v15
v_add_f32_dpp v33, v52, v52 row_ror:8 row_mask:0xf bank_mask:0x3
v_add_f32_dpp v34, v53, v53 row_ror:8 row_mask:0xf bank_mask:0x3
v_add_f32_dpp v33, v54, v54 row_ror:8 row_mask:0xf bank_mask:0xc
v_add_f32_dpp v34, v55, v55 row_ror:8 row_mask:0xf bank_mask:0xc
s_nop 0
v_add_f32_dpp v29, v33, v33 row_half_mirror row_mask:0xf bank_mask:0x5
v_add_f32_dpp v29, v34, v34 row_half_mirror row_mask:0xf bank_mask:0xa
s_waitcnt vmcnt(7)
buffer_load_dwordx4 v0, s[4:7], s45 offen offset:3072 nt lds
s_add_u32 s45, s45, 16384
ds_read_b128 v[36:39], v1 offset:12288
ds_read_b128 v[40:43], v1 offset:13312
ds_read_b128 v[44:47], v1 offset:14336
ds_read_b128 v[48:51], v1 offset:15360
s_waitcnt lgkmcnt(0)
v_dot2_f32_bf16 v52, v36, v8, 0
v_dot2_f32_bf16 v53, v40, v8, 0
v_dot2_f32_bf16 v54, v44, v8, 0
v_dot2_f32_bf16 v55, v48, v8, 0
v_dot2c_f32_bf16 v52, v37, v9
v_dot2c_f32_bf16 v53, v41, v9
v_dot2c_f32_bf16 v54, v45, v9
v_dot2c_f32_bf16 v55, v49, v9
v_dot2c_f32_bf16 v52, v38, v10
v_dot2c_f32_bf16 v53, v42, v10
v_dot2c_f32_bf16 v54, v46, v10
v_dot2c_f32_bf16 v55, v50, v10
v_dot2c_f32_bf16 v52, v39, v11
v_dot2c_f32_bf16 v53, v43, v11
v_dot2c_f32_bf16 v54, v47, v11
v_dot2c_f32_bf16 v55, v51, v11
v_add_f32_dpp v33, v52, v52 row_ror:8 row_mask:0xf bank_mask:0x3
v_add_f32_dpp v34, v53, v53 row_ror:8 row_mask:0xf bank_mask:0x3
v_add_f32_dpp v33, v54, v54 row_ror:8 row_mask:0xf bank_mask:0xc
v_add_f32_dpp v34, v55, v55 row_ror:8 row_mask:0xf bank_mask:0xc
s_nop 0
v_add_f32_dpp v35, v33, v33 row_half_mirror row_mask:0xf bank_mask:0x5
v_add_f32_dpp v35, v34, v34 row_half_mirror row_mask:0xf bank_mask:0xa
v_cndmask_b32 v33, v24, v35, s[54:55]
v_cndmask_b32 v34, v35, v24, s[54:55]
s_nop 1
v_add_f32_dpp v24, v34, v33 quad_perm:[1,0,3,2] row_mask:0xf bank_mask:0xf
s_waitcnt vmcnt(7)
s_barrier
buffer_load_dwordx4 v[56:59], v0, s[4:7], s45 offen offset:0 nt
s_waitcnt vmcnt(7)
buffer_load_dwordx4 v[60:63], v0, s[4:7], s45 offen offset:1024 nt
s_waitcnt vmcnt(7)
buffer_load_dwordx4 v[64:67], v0, s[4:7], s45 offen offset:2048 nt
v_dot2_f32_bf16 v52, v72, v12, 0
v_dot2_f32_bf16 v53, v76, v12, 0
v_dot2_f32_bf16 v54, v80, v12, 0
v_dot2_f32_bf16 v55, v84, v12, 0
v_dot2c_f32_bf16 v52, v73, v13
v_dot2c_f32_bf16 v53, v77, v13
v_dot2c_f32_bf16 v54, v81, v13
v_dot2c_f32_bf16 v55, v85, v13
v_dot2c_f32_bf16 v52, v74, v14
v_dot2c_f32_bf16 v53, v78, v14
v_dot2c_f32_bf16 v54, v82, v14
v_dot2c_f32_bf16 v55, v86, v14
v_dot2c_f32_bf16 v52, v75, v15
v_dot2c_f32_bf16 v53, v79, v15
v_dot2c_f32_bf16 v54, v83, v15
v_dot2c_f32_bf16 v55, v87, v15
v_add_f32_dpp v33, v52, v52 row_ror:8 row_mask:0xf bank_mask:0x3
v_add_f32_dpp v34, v53, v53 row_ror:8 row_mask:0xf bank_mask:0x3
v_add_f32_dpp v33, v54, v54 row_ror:8 row_mask:0xf bank_mask:0xc
v_add_f32_dpp v34, v55, v55 row_ror:8 row_mask:0xf bank_mask:0xc
s_nop 0
v_add_f32_dpp v35, v33, v33 row_half_mirror row_mask:0xf bank_mask:0x5
v_add_f32_dpp v35, v34, v34 row_half_mirror row_mask:0xf bank_mask:0xa
v_cndmask_b32 v33, v29, v35, s[54:55]
v_cndmask_b32 v34, v35, v29, s[54:55]
s_nop 1
v_add_f32_dpp v29, v34, v33 quad_perm:[1,0,3,2] row_mask:0xf bank_mask:0xf
s_waitcnt vmcnt(7)
buffer_load_dwordx4 v[68:71], v0, s[4:7], s45 offen offset:3072 nt
s_add_u32 s45, s45, 16384
ds_read_b128 v[36:39], v1 offset:16384
ds_read_b128 v[40:43], v1 offset:17408
ds_read_b128 v[44:47], v1 offset:18432
ds_read_b128 v[48:51], v1 offset:19456
s_waitcnt lgkmcnt(0)
v_dot2_f32_bf16 v52, v36, v8, 0
v_dot2_f32_bf16 v53, v40, v8, 0
v_dot2_f32_bf16 v54, v44, v8, 0
v_dot2_f32_bf16 v55, v48, v8, 0
v_dot2c_f32_bf16 v52, v37, v9
v_dot2c_f32_bf16 v53, v41, v9
v_dot2c_f32_bf16 v54, v45, v9
v_dot2c_f32_bf16 v55, v49, v9
v_dot2c_f32_bf16 v52, v38, v10
v_dot2c_f32_bf16 v53, v42, v10
v_dot2c_f32_bf16 v54, v46, v10
v_dot2c_f32_bf16 v55, v50, v10
v_dot2c_f32_bf16 v52, v39, v11
v_dot2c_f32_bf16 v53, v43, v11
v_dot2c_f32_bf16 v54, v47, v11
v_dot2c_f32_bf16 v55, v51, v11
v_add_f32_dpp v33, v52, v52 row_ror:8 row_mask:0xf bank_mask:0x3
v_add_f32_dpp v34, v53, v53 row_ror:8 row_mask:0xf bank_mask:0x3
v_add_f32_dpp v33, v54, v54 row_ror:8 row_mask:0xf bank_mask:0xc
v_add_f32_dpp v34, v55, v55 row_ror:8 row_mask:0xf bank_mask:0xc
s_nop 0
v_add_f32_dpp v27, v33, v33 row_half_mirror row_mask:0xf bank_mask:0x5
v_add_f32_dpp v27, v34, v34 row_half_mirror row_mask:0xf bank_mask:0xa
s_waitcnt vmcnt(7)
buffer_load_dwordx4 v[72:75], v0, s[4:7], s45 offen offset:0 nt
s_waitcnt vmcnt(7)
buffer_load_dwordx4 v[76:79], v0, s[4:7], s45 offen offset:1024 nt
s_waitcnt vmcnt(7)
buffer_load_dwordx4 v[80:83], v0, s[4:7], s45 offen offset:2048 nt
v_dot2_f32_bf16 v52, v88, v12, 0
v_dot2_f32_bf16 v53, v92, v12, 0
v_dot2_f32_bf16 v54, v96, v12, 0
v_dot2_f32_bf16 v55, v100, v12, 0
v_dot2c_f32_bf16 v52, v89, v13
v_dot2c_f32_bf16 v53, v93, v13
v_dot2c_f32_bf16 v54, v97, v13
v_dot2c_f32_bf16 v55, v101, v13
v_dot2c_f32_bf16 v52, v90, v14
v_dot2c_f32_bf16 v53, v94, v14
v_dot2c_f32_bf16 v54, v98, v14
v_dot2c_f32_bf16 v55, v102, v14
v_dot2c_f32_bf16 v52, v91, v15
v_dot2c_f32_bf16 v53, v95, v15
v_dot2c_f32_bf16 v54, v99, v15
v_dot2c_f32_bf16 v55, v103, v15
v_add_f32_dpp v33, v52, v52 row_ror:8 row_mask:0xf bank_mask:0x3
v_add_f32_dpp v34, v53, v53 row_ror:8 row_mask:0xf bank_mask:0x3
v_add_f32_dpp v33, v54, v54 row_ror:8 row_mask:0xf bank_mask:0xc
v_add_f32_dpp v34, v55, v55 row_ror:8 row_mask:0xf bank_mask:0xc
s_nop 0
v_add_f32_dpp v31, v33, v33 row_half_mirror row_mask:0xf bank_mask:0x5
v_add_f32_dpp v31, v34, v34 row_half_mirror row_mask:0xf bank_mask:0xa
s_waitcnt vmcnt(7)
buffer_load_dwordx4 v[84:87], v0, s[4:7], s45 offen offset:3072 nt
s_add_u32 s45, s45, 16384
ds_read_b128 v[36:39], v1 offset:20480
ds_read_b128 v[40:43], v1 offset:21504
ds_read_b128 v[44:47], v1 offset:22528
ds_read_b128 v[48:51], v1 offset:23552
s_waitcnt lgkmcnt(0)
v_dot2_f32_bf16 v52, v36, v8, 0
v_dot2_f32_bf16 v53, v40, v8, 0
v_dot2_f32_bf16 v54, v44, v8, 0
v_dot2_f32_bf16 v55, v48, v8, 0
v_dot2c_f32_bf16 v52, v37, v9
v_dot2c_f32_bf16 v53, v41, v9
v_dot2c_f32_bf16 v54, v45, v9
v_dot2c_f32_bf16 v55, v49, v9
v_dot2c_f32_bf16 v52, v38, v10
v_dot2c_f32_bf16 v53, v42, v10
v_dot2c_f32_bf16 v54, v46, v10
v_dot2c_f32_bf16 v55, v50, v10
v_dot2c_f32_bf16 v52, v39, v11
v_dot2c_f32_bf16 v53, v43, v11
v_dot2c_f32_bf16 v54, v47, v11
v_dot2c_f32_bf16 v55, v51, v11
v_add_f32_dpp v33, v52, v52 row_ror:8 row_mask:0xf bank_mask:0x3
v_add_f32_dpp v34, v53, v53 row_ror:8 row_mask:0xf bank_mask:0x3
v_add_f32_dpp v33, v54, v54 row_ror:8 row_mask:0xf bank_mask:0xc
v_add_f32_dpp v34, v55, v55 row_ror:8 row_mask:0xf bank_mask:0xc
s_nop 0
v_add_f32_dpp v35, v33, v33 row_half_mirror row_mask:0xf bank_mask:0x5
v_add_f32_dpp v35, v34, v34 row_half_mirror row_mask:0xf bank_mask:0xa
v_cndmask_b32 v33, v27, v35, s[54:55]
v_cndmask_b32 v34, v35, v27, s[54:55]
s_nop 1
v_add_f32_dpp v27, v34, v33 quad_perm:[1,0,3,2] row_mask:0xf bank_mask:0xf
v_cndmask_b32 v33, v24, v27, s[56:57]
v_cndmask_b32 v34, v27, v24, s[56:57]
s_nop 1
v_add_f32_dpp v24, v34, v33 quad_perm:[2,3,0,1] row_mask:0xf bank_mask:0xf
s_waitcnt vmcnt(7)
s_barrier
buffer_load_dwordx4 v[88:91], v0, s[4:7], s45 offen offset:0 nt
s_waitcnt vmcnt(7)
buffer_load_dwordx4 v[92:95], v0, s[4:7], s45 offen offset:1024 nt
s_waitcnt vmcnt(7)
buffer_load_dwordx4 v[96:99], v0, s[4:7], s45 offen offset:2048 nt
v_dot2_f32_bf16 v52, v104, v12, 0
v_dot2_f32_bf16 v53, v108, v12, 0
v_dot2_f32_bf16 v54, v112, v12, 0
v_dot2_f32_bf16 v55, v116, v12, 0
v_dot2c_f32_bf16 v52, v105, v13
v_dot2c_f32_bf16 v53, v109, v13
v_dot2c_f32_bf16 v54, v113, v13
v_dot2c_f32_bf16 v55, v117, v13
v_dot2c_f32_bf16 v52, v106, v14
v_dot2c_f32_bf16 v53, v110, v14
v_dot2c_f32_bf16 v54, v114, v14
v_dot2c_f32_bf16 v55, v118, v14
v_dot2c_f32_bf16 v52, v107, v15
v_dot2c_f32_bf16 v53, v111, v15
v_dot2c_f32_bf16 v54, v115, v15
v_dot2c_f32_bf16 v55, v119, v15
v_add_f32_dpp v33, v52, v52 row_ror:8 row_mask:0xf bank_mask:0x3
v_add_f32_dpp v34, v53, v53 row_ror:8 row_mask:0xf bank_mask:0x3
v_add_f32_dpp v33, v54, v54 row_ror:8 row_mask:0xf bank_mask:0xc
v_add_f32_dpp v34, v55, v55 row_ror:8 row_mask:0xf bank_mask:0xc
s_nop 0
v_add_f32_dpp v35, v33, v33 row_half_mirror row_mask:0xf bank_mask:0x5
v_add_f32_dpp v35, v34, v34 row_half_mirror row_mask:0xf bank_mask:0xa
v_cndmask_b32 v33, v31, v35, s[54:55]
v_cndmask_b32 v34, v35, v31, s[54:55]
s_nop 1
v_add_f32_dpp v31, v34, v33 quad_perm:[1,0,3,2] row_mask:0xf bank_mask:0xf
v_cndmask_b32 v33, v29, v31, s[56:57]
v_cndmask_b32 v34, v31, v29, s[56:57]
s_nop 1
v_add_f32_dpp v29, v34, v33 quad_perm:[2,3,0,1] row_mask:0xf bank_mask:0xf
s_waitcnt vmcnt(7)
buffer_load_dwordx4 v[100:103], v0, s[4:7], s45 offen offset:3072 nt
s_add_u32 s45, s45, 16384
v_dot2_f32_bf16 v52, v56, v8, 0
v_dot2_f32_bf16 v53, v60, v8, 0
v_dot2_f32_bf16 v54, v64, v8, 0
v_dot2_f32_bf16 v55, v68, v8, 0
v_dot2c_f32_bf16 v52, v57, v9
v_dot2c_f32_bf16 v53, v61, v9
v_dot2c_f32_bf16 v54, v65, v9
v_dot2c_f32_bf16 v55, v69, v9
v_dot2c_f32_bf16 v52, v58, v10
v_dot2c_f32_bf16 v53, v62, v10
v_dot2c_f32_bf16 v54, v66, v10
v_dot2c_f32_bf16 v55, v70, v10
v_dot2c_f32_bf16 v52, v59, v11
v_dot2c_f32_bf16 v53, v63, v11
v_dot2c_f32_bf16 v54, v67, v11
v_dot2c_f32_bf16 v55, v71, v11
v_add_f32_dpp v33, v52, v52 row_ror:8 row_mask:0xf bank_mask:0x3
v_add_f32_dpp v34, v53, v53 row_ror:8 row_mask:0xf bank_mask:0x3
v_add_f32_dpp v33, v54, v54 row_ror:8 row_mask:0xf bank_mask:0xc
v_add_f32_dpp v34, v55, v55 row_ror:8 row_mask:0xf bank_mask:0xc
s_nop 0
v_add_f32_dpp v25, v33, v33 row_half_mirror row_mask:0xf bank_mask:0x5
v_add_f32_dpp v25, v34, v34 row_half_mirror row_mask:0xf bank_mask:0xa
s_waitcnt vmcnt(7)
buffer_load_dwordx4 v[104:107], v0, s[4:7], s45 offen offset:0 nt
s_waitcnt vmcnt(7)
buffer_load_dwordx4 v[108:111], v0, s[4:7], s45 offen offset:1024 nt
s_waitcnt vmcnt(7)
buffer_load_dwordx4 v[112:115], v0, s[4:7], s45 offen offset:2048 nt
v_dot2_f32_bf16 v52, v120, v12, 0
v_dot2_f32_bf16 v53, v124, v12, 0
v_dot2_f32_bf16 v54, v128, v12, 0
v_dot2_f32_bf16 v55, v132, v12, 0
v_dot2c_f32_bf16 v52, v121, v13
v_dot2c_f32_bf16 v53, v125, v13
v_dot2c_f32_bf16 v54, v129, v13
v_dot2c_f32_bf16 v55, v133, v13
v_dot2c_f32_bf16 v52, v122, v14
v_dot2c_f32_bf16 v53, v126, v14
v_dot2c_f32_bf16 v54, v130, v14
v_dot2c_f32_bf16 v55, v134, v14
v_dot2c_f32_bf16 v52, v123, v15
v_dot2c_f32_bf16 v53, v127, v15
v_dot2c_f32_bf16 v54, v131, v15
v_dot2c_f32_bf16 v55, v135, v15
v_add_f32_dpp v33, v52, v52 row_ror:8 row_mask:0xf bank_mask:0x3
v_add_f32_dpp v34, v53, v53 row_ror:8 row_mask:0xf bank_mask:0x3
v_add_f32_dpp v33, v54, v54 row_ror:8 row_mask:0xf bank_mask:0xc
v_add_f32_dpp v34, v55, v55 row_ror:8 row_mask:0xf bank_mask:0xc
s_nop 0
v_add_f32_dpp v30, v33, v33 row_half_mirror row_mask:0xf bank_mask:0x5
v_add_f32_dpp v30, v34, v34 row_half_mirror row_mask:0xf bank_mask:0xa
s_waitcnt vmcnt(7)
buffer_load_dwordx4 v[116:119], v0, s[4:7], s45 offen offset:3072 nt
s_add_u32 s45, s45, 16384
v_dot2_f32_bf16 v52, v72, v8, 0
v_dot2_f32_bf16 v53, v76, v8, 0
v_dot2_f32_bf16 v54, v80, v8, 0
v_dot2_f32_bf16 v55, v84, v8, 0
v_dot2c_f32_bf16 v52, v73, v9
v_dot2c_f32_bf16 v53, v77, v9
v_dot2c_f32_bf16 v54, v81, v9
v_dot2c_f32_bf16 v55, v85, v9
v_dot2c_f32_bf16 v52, v74, v10
v_dot2c_f32_bf16 v53, v78, v10
v_dot2c_f32_bf16 v54, v82, v10
v_dot2c_f32_bf16 v55, v86, v10
v_dot2c_f32_bf16 v52, v75, v11
v_dot2c_f32_bf16 v53, v79, v11
v_dot2c_f32_bf16 v54, v83, v11
v_dot2c_f32_bf16 v55, v87, v11
v_add_f32_dpp v33, v52, v52 row_ror:8 row_mask:0xf bank_mask:0x3
v_add_f32_dpp v34, v53, v53 row_ror:8 row_mask:0xf bank_mask:0x3
v_add_f32_dpp v33, v54, v54 row_ror:8 row_mask:0xf bank_mask:0xc
v_add_f32_dpp v34, v55, v55 row_ror:8 row_mask:0xf bank_mask:0xc
s_nop 0
v_add_f32_dpp v35, v33, v33 row_half_mirror row_mask:0xf bank_mask:0x5
v_add_f32_dpp v35, v34, v34 row_half_mirror row_mask:0xf bank_mask:0xa
v_cndmask_b32 v33, v25, v35, s[54:55]
v_cndmask_b32 v34, v35, v25, s[54:55]
s_nop 1
v_add_f32_dpp v25, v34, v33 quad_perm:[1,0,3,2] row_mask:0xf bank_mask:0xf
s_waitcnt vmcnt(7)
s_barrier
buffer_load_dwordx4 v[120:123], v0, s[4:7], s45 offen offset:0 nt
ds_read_b128 v[36:39], v1 offset:24576
s_waitcnt lgkmcnt(0)
v_dot2_f32_bf16 v52, v36, v12, 0
v_dot2_f32_bf16 v52, v37, v13, v52
v_dot2_f32_bf16 v52, v38, v14, v52
v_dot2_f32_bf16 v52, v39, v15, v52
s_nop 2
v_add_f32_dpp v33, v52, v52 row_ror:8 row_mask:0xf bank_mask:0xf
s_nop 1
v_add_f32_dpp v35, v33, v33 row_half_mirror row_mask:0xf bank_mask:0xf
v_cndmask_b32 v33, v30, v35, s[54:55]
v_cndmask_b32 v34, v35, v30, s[54:55]
s_nop 1
v_add_f32_dpp v30, v34, v33 quad_perm:[1,0,3,2] row_mask:0xf bank_mask:0xf
s_nop 1
v_add_f32_dpp v30, v30, v30 quad_perm:[2,3,0,1] row_mask:0xf bank_mask:0xf
s_waitcnt vmcnt(7)
buffer_load_dwordx4 v[124:127], v0, s[4:7], s45 offen offset:1024 nt
v_mul_f32 v28, 0x3e0293ee, v28
v_mul_f32 v29, 0x3e0293ee, v29
v_mul_f32 v30, 0x3e0293ee, v30
v_mov_b32 v34, 0xff800000
v_cndmask_b32 v30, v34, v30, s[58:59]
v_max3_f32 v33, v28, v29, v30
s_nop 1
v_max_f32_dpp v33, v33, v33 quad_perm:[1,0,3,2] row_mask:0xf bank_mask:0xf
s_nop 1
v_max_f32_dpp v33, v33, v33 quad_perm:[2,3,0,1] row_mask:0xf bank_mask:0xf
s_nop 1
v_max_f32_dpp v33, v33, v33 row_ror:4 row_mask:0xf bank_mask:0xf
s_nop 1
v_max_f32_dpp v33, v33, v33 row_ror:8 row_mask:0xf bank_mask:0xf
s_nop 1
v_max_f32_dpp v33, v33, v33 row_bcast:15 row_mask:0xa bank_mask:0xf
s_nop 1
v_max_f32_dpp v33, v33, v33 row_bcast:31 row_mask:0xc bank_mask:0xf
s_nop 0
v_readlane_b32 s62, v33, 63
s_nop 1
v_subrev_f32 v28, s62, v28
v_subrev_f32 v29, s62, v29
v_subrev_f32 v30, s62, v30
v_exp_f32 v28, v28
v_exp_f32 v29, v29
v_exp_f32 v30, v30
v_add_f32 v33, v28, v29
v_add_f32 v33, v33, v30
v_cvt_pk_bf16_f32 v28, v28, v28
v_cvt_pk_bf16_f32 v29, v29, v29
v_cvt_pk_bf16_f32 v30, v30, v30
v_add_f32_dpp v33, v33, v33 quad_perm:[1,0,3,2] row_mask:0xf bank_mask:0xf
s_nop 1
v_add_f32_dpp v33, v33, v33 quad_perm:[2,3,0,1] row_mask:0xf bank_mask:0xf
s_nop 1
v_add_f32_dpp v33, v33, v33 row_ror:4 row_mask:0xf bank_mask:0xf
s_nop 1
v_add_f32_dpp v33, v33, v33 row_ror:8 row_mask:0xf bank_mask:0xf
s_nop 1
v_add_f32_dpp v33, v33, v33 row_bcast:15 row_mask:0xa bank_mask:0xf
s_nop 1
v_add_f32_dpp v33, v33, v33 row_bcast:31 row_mask:0xc bank_mask:0xf
s_nop 0
v_readlane_b32 s63, v33, 63
s_waitcnt vmcnt(7)
buffer_load_dwordx4 v[128:131], v0, s[4:7], s45 offen offset:2048 nt
s_waitcnt vmcnt(7)
buffer_load_dwordx4 v[132:135], v0, s[4:7], s45 offen offset:3072 nt
s_add_u32 s45, s45, 16384
v_dot2_f32_bf16 v52, v88, v8, 0
v_dot2_f32_bf16 v53, v92, v8, 0
v_dot2_f32_bf16 v54, v96, v8, 0
v_dot2_f32_bf16 v55, v100, v8, 0
v_dot2c_f32_bf16 v52, v89, v9
v_dot2c_f32_bf16 v53, v93, v9
v_dot2c_f32_bf16 v54, v97, v9
v_dot2c_f32_bf16 v55, v101, v9
v_dot2c_f32_bf16 v52, v90, v10
v_dot2c_f32_bf16 v53, v94, v10
v_dot2c_f32_bf16 v54, v98, v10
v_dot2c_f32_bf16 v55, v102, v10
v_dot2c_f32_bf16 v52, v91, v11
v_dot2c_f32_bf16 v53, v95, v11
v_dot2c_f32_bf16 v54, v99, v11
v_dot2c_f32_bf16 v55, v103, v11
v_add_f32_dpp v33, v52, v52 row_ror:8 row_mask:0xf bank_mask:0x3
v_add_f32_dpp v34, v53, v53 row_ror:8 row_mask:0xf bank_mask:0x3
v_add_f32_dpp v33, v54, v54 row_ror:8 row_mask:0xf bank_mask:0xc
v_add_f32_dpp v34, v55, v55 row_ror:8 row_mask:0xf bank_mask:0xc
s_nop 0
v_add_f32_dpp v27, v33, v33 row_half_mirror row_mask:0xf bank_mask:0x5
v_add_f32_dpp v27, v34, v34 row_half_mirror row_mask:0xf bank_mask:0xa
v_and_b32_dpp v44, v28, v4 row_newbcast:0 row_mask:0xf bank_mask:0xf
v_and_b32_dpp v45, v28, v5 row_newbcast:0 row_mask:0xf bank_mask:0xf
v_and_b32_dpp v46, v28, v6 row_newbcast:0 row_mask:0xf bank_mask:0xf
v_and_b32_dpp v47, v28, v7 row_newbcast:0 row_mask:0xf bank_mask:0xf
s_nop 1
v_mfma_f32_16x16x32_bf16 v[20:23], v[44:47], v[136:139], 0
s_waitcnt vmcnt(7)
s_add_u32 m0, s47, 24576
s_nop 0
buffer_load_dwordx4 v2, s[4:7], s44 offen nt lds
s_add_u32 s45, s44, s46
v_and_b32_dpp v48, v28, v4 row_newbcast:4 row_mask:0xf bank_mask:0xf
v_and_b32_dpp v49, v28, v5 row_newbcast:4 row_mask:0xf bank_mask:0xf
v_and_b32_dpp v50, v28, v6 row_newbcast:4 row_mask:0xf bank_mask:0xf
v_and_b32_dpp v51, v28, v7 row_newbcast:4 row_mask:0xf bank_mask:0xf
s_nop 1
v_mfma_f32_16x16x32_bf16 v[20:23], v[48:51], v[140:143], v[20:23]
s_waitcnt vmcnt(7)
s_cmp_lt_u32 s86, 1
s_cbranch_scc1 1
s_waitcnt vmcnt(5)
s_barrier
buffer_load_dwordx4 v[136:139], v0, s[8:11], s45 offen offset:0 nt
v_and_b32_dpp v36, v28, v4 row_newbcast:8 row_mask:0xf bank_mask:0xf
v_and_b32_dpp v37, v28, v5 row_newbcast:8 row_mask:0xf bank_mask:0xf
v_and_b32_dpp v38, v28, v6 row_newbcast:8 row_mask:0xf bank_mask:0xf
v_and_b32_dpp v39, v28, v7 row_newbcast:8 row_mask:0xf bank_mask:0xf
s_nop 1
v_mfma_f32_16x16x32_bf16 v[20:23], v[36:39], v[144:147], v[20:23]
s_waitcnt vmcnt(7)
s_cmp_lt_u32 s86, 1
s_cbranch_scc1 1
s_waitcnt vmcnt(5)
buffer_load_dwordx4 v[140:143], v0, s[8:11], s45 offen offset:1024 nt
v_and_b32_dpp v40, v28, v4 row_newbcast:12 row_mask:0xf bank_mask:0xf
v_and_b32_dpp v41, v28, v5 row_newbcast:12 row_mask:0xf bank_mask:0xf
v_and_b32_dpp v42, v28, v6 row_newbcast:12 row_mask:0xf bank_mask:0xf
v_and_b32_dpp v43, v28, v7 row_newbcast:12 row_mask:0xf bank_mask:0xf
s_nop 1
v_mfma_f32_16x16x32_bf16 v[20:23], v[40:43], v[148:151], v[20:23]
s_waitcnt vmcnt(7)
s_cmp_lt_u32 s86, 1
s_cbranch_scc1 1
s_waitcnt vmcnt(5)
buffer_load_dwordx4 v[144:147], v0, s[8:11], s45 offen offset:2048 nt
v_dot2_f32_bf16 v52, v104, v8, 0
v_dot2_f32_bf16 v53, v108, v8, 0
v_dot2_f32_bf16 v54, v112, v8, 0
v_dot2_f32_bf16 v55, v116, v8, 0
v_dot2c_f32_bf16 v52, v105, v9
v_dot2c_f32_bf16 v53, v109, v9
v_dot2c_f32_bf16 v54, v113, v9
v_dot2c_f32_bf16 v55, v117, v9
v_dot2c_f32_bf16 v52, v106, v10
v_dot2c_f32_bf16 v53, v110, v10
v_dot2c_f32_bf16 v54, v114, v10
v_dot2c_f32_bf16 v55, v118, v10
v_dot2c_f32_bf16 v52, v107, v11
v_dot2c_f32_bf16 v53, v111, v11
v_dot2c_f32_bf16 v54, v115, v11
v_dot2c_f32_bf16 v55, v119, v11
v_add_f32_dpp v33, v52, v52 row_ror:8 row_mask:0xf bank_mask:0x3
v_add_f32_dpp v34, v53, v53 row_ror:8 row_mask:0xf bank_mask:0x3
v_add_f32_dpp v33, v54, v54 row_ror:8 row_mask:0xf bank_mask:0xc
v_add_f32_dpp v34, v55, v55 row_ror:8 row_mask:0xf bank_mask:0xc
s_nop 0
v_add_f32_dpp v35, v33, v33 row_half_mirror row_mask:0xf bank_mask:0x5
v_add_f32_dpp v35, v34, v34 row_half_mirror row_mask:0xf bank_mask:0xa
v_cndmask_b32 v33, v27, v35, s[54:55]
v_cndmask_b32 v34, v35, v27, s[54:55]
s_nop 1
v_add_f32_dpp v27, v34, v33 quad_perm:[1,0,3,2] row_mask:0xf bank_mask:0xf
v_cndmask_b32 v33, v25, v27, s[56:57]
v_cndmask_b32 v34, v27, v25, s[56:57]
s_nop 1
v_add_f32_dpp v25, v34, v33 quad_perm:[2,3,0,1] row_mask:0xf bank_mask:0xf
v_and_b32_dpp v44, v28, v4 row_newbcast:1 row_mask:0xf bank_mask:0xf
v_and_b32_dpp v45, v28, v5 row_newbcast:1 row_mask:0xf bank_mask:0xf
v_and_b32_dpp v46, v28, v6 row_newbcast:1 row_mask:0xf bank_mask:0xf
v_and_b32_dpp v47, v28, v7 row_newbcast:1 row_mask:0xf bank_mask:0xf
s_nop 1
v_mfma_f32_16x16x32_bf16 v[20:23], v[44:47], v[152:155], v[20:23]
s_waitcnt vmcnt(7)
s_cmp_lt_u32 s86, 1
s_cbranch_scc1 1
s_waitcnt vmcnt(5)
buffer_load_dwordx4 v[148:151], v0, s[8:11], s45 offen offset:3072 nt
s_add_u32 s45, s45, 16384
v_and_b32_dpp v48, v28, v4 row_newbcast:5 row_mask:0xf bank_mask:0xf
v_and_b32_dpp v49, v28, v5 row_newbcast:5 row_mask:0xf bank_mask:0xf
v_and_b32_dpp v50, v28, v6 row_newbcast:5 row_mask:0xf bank_mask:0xf
v_and_b32_dpp v51, v28, v7 row_newbcast:5 row_mask:0xf bank_mask:0xf
s_nop 1
v_mfma_f32_16x16x32_bf16 v[20:23], v[48:51], a[0:3], v[20:23]
s_waitcnt vmcnt(7)
s_cmp_lt_u32 s86, 1
s_cbranch_scc1 1
s_waitcnt vmcnt(5)
buffer_load_dwordx4 v[152:155], v0, s[8:11], s45 offen offset:0 nt
v_and_b32_dpp v36, v28, v4 row_newbcast:9 row_mask:0xf bank_mask:0xf
v_and_b32_dpp v37, v28, v5 row_newbcast:9 row_mask:0xf bank_mask:0xf
v_and_b32_dpp v38, v28, v6 row_newbcast:9 row_mask:0xf bank_mask:0xf
v_and_b32_dpp v39, v28, v7 row_newbcast:9 row_mask:0xf bank_mask:0xf
s_nop 1
v_mfma_f32_16x16x32_bf16 v[20:23], v[36:39], a[4:7], v[20:23]
s_waitcnt vmcnt(7)
s_cmp_lt_u32 s86, 1
s_cbranch_scc1 1
s_waitcnt vmcnt(5)
buffer_load_dwordx4 a[0:3], v0, s[8:11], s45 offen offset:1024 nt
v_and_b32_dpp v40, v28, v4 row_newbcast:13 row_mask:0xf bank_mask:0xf
v_and_b32_dpp v41, v28, v5 row_newbcast:13 row_mask:0xf bank_mask:0xf
v_and_b32_dpp v42, v28, v6 row_newbcast:13 row_mask:0xf bank_mask:0xf
v_and_b32_dpp v43, v28, v7 row_newbcast:13 row_mask:0xf bank_mask:0xf
s_nop 1
v_mfma_f32_16x16x32_bf16 v[20:23], v[40:43], a[8:11], v[20:23]
s_waitcnt vmcnt(7)
s_cmp_lt_u32 s86, 1
s_cbranch_scc1 1
s_waitcnt vmcnt(5)
buffer_load_dwordx4 a[4:7], v0, s[8:11], s45 offen offset:2048 nt
v_dot2_f32_bf16 v52, v120, v8, 0
v_dot2_f32_bf16 v53, v124, v8, 0
v_dot2_f32_bf16 v54, v128, v8, 0
v_dot2_f32_bf16 v55, v132, v8, 0
v_dot2c_f32_bf16 v52, v121, v9
v_dot2c_f32_bf16 v53, v125, v9
v_dot2c_f32_bf16 v54, v129, v9
v_dot2c_f32_bf16 v55, v133, v9
v_dot2c_f32_bf16 v52, v122, v10
v_dot2c_f32_bf16 v53, v126, v10
v_dot2c_f32_bf16 v54, v130, v10
v_dot2c_f32_bf16 v55, v134, v10
v_dot2c_f32_bf16 v52, v123, v11
v_dot2c_f32_bf16 v53, v127, v11
v_dot2c_f32_bf16 v54, v131, v11
v_dot2c_f32_bf16 v55, v135, v11
v_add_f32_dpp v33, v52, v52 row_ror:8 row_mask:0xf bank_mask:0x3
v_add_f32_dpp v34, v53, v53 row_ror:8 row_mask:0xf bank_mask:0x3
v_add_f32_dpp v33, v54, v54 row_ror:8 row_mask:0xf bank_mask:0xc
v_add_f32_dpp v34, v55, v55 row_ror:8 row_mask:0xf bank_mask:0xc
s_nop 0
v_add_f32_dpp v26, v33, v33 row_half_mirror row_mask:0xf bank_mask:0x5
v_add_f32_dpp v26, v34, v34 row_half_mirror row_mask:0xf bank_mask:0xa
v_and_b32_dpp v44, v28, v4 row_newbcast:2 row_mask:0xf bank_mask:0xf
v_and_b32_dpp v45, v28, v5 row_newbcast:2 row_mask:0xf bank_mask:0xf
v_and_b32_dpp v46, v28, v6 row_newbcast:2 row_mask:0xf bank_mask:0xf
v_and_b32_dpp v47, v28, v7 row_newbcast:2 row_mask:0xf bank_mask:0xf
s_nop 1
v_mfma_f32_16x16x32_bf16 v[20:23], v[44:47], a[12:15], v[20:23]
s_waitcnt vmcnt(7)
s_cmp_lt_u32 s86, 1
s_cbranch_scc1 1
s_waitcnt vmcnt(5)
buffer_load_dwordx4 a[8:11], v0, s[8:11], s45 offen offset:3072 nt
s_add_u32 s45, s45, 16384
ds_read_b128 v[36:39], v1 offset:24576
s_waitcnt lgkmcnt(0)
v_dot2_f32_bf16 v52, v36, v8, 0
v_dot2_f32_bf16 v52, v37, v9, v52
v_dot2_f32_bf16 v52, v38, v10, v52
v_dot2_f32_bf16 v52, v39, v11, v52
s_nop 2
v_add_f32_dpp v33, v52, v52 row_ror:8 row_mask:0xf bank_mask:0xf
s_nop 1
v_add_f32_dpp v35, v33, v33 row_half_mirror row_mask:0xf bank_mask:0xf
v_cndmask_b32 v33, v26, v35, s[54:55]
v_cndmask_b32 v34, v35, v26, s[54:55]
s_nop 1
v_add_f32_dpp v26, v34, v33 quad_perm:[1,0,3,2] row_mask:0xf bank_mask:0xf
s_nop 1
v_add_f32_dpp v26, v26, v26 quad_perm:[2,3,0,1] row_mask:0xf bank_mask:0xf
v_mul_f32 v24, 0x3e0293ee, v24
v_mul_f32 v25, 0x3e0293ee, v25
v_mul_f32 v26, 0x3e0293ee, v26
v_mov_b32 v34, 0xff800000
v_cndmask_b32 v26, v34, v26, s[58:59]
v_max3_f32 v33, v24, v25, v26
s_nop 1
v_max_f32_dpp v33, v33, v33 quad_perm:[1,0,3,2] row_mask:0xf bank_mask:0xf
s_nop 1
v_max_f32_dpp v33, v33, v33 quad_perm:[2,3,0,1] row_mask:0xf bank_mask:0xf
s_nop 1
v_max_f32_dpp v33, v33, v33 row_ror:4 row_mask:0xf bank_mask:0xf
s_nop 1
v_max_f32_dpp v33, v33, v33 row_ror:8 row_mask:0xf bank_mask:0xf
s_nop 1
v_max_f32_dpp v33, v33, v33 row_bcast:15 row_mask:0xa bank_mask:0xf
s_nop 1
v_max_f32_dpp v33, v33, v33 row_bcast:31 row_mask:0xc bank_mask:0xf
s_nop 0
v_readlane_b32 s60, v33, 63
s_nop 1
v_subrev_f32 v24, s60, v24
v_subrev_f32 v25, s60, v25
v_subrev_f32 v26, s60, v26
v_exp_f32 v24, v24
v_exp_f32 v25, v25
v_exp_f32 v26, v26
v_add_f32 v33, v24, v25
v_add_f32 v33, v33, v26
v_cvt_pk_bf16_f32 v24, v24, v24
v_cvt_pk_bf16_f32 v25, v25, v25
v_cvt_pk_bf16_f32 v26, v26, v26
v_add_f32_dpp v33, v33, v33 quad_perm:[1,0,3,2] row_mask:0xf bank_mask:0xf
s_nop 1
v_add_f32_dpp v33, v33, v33 quad_perm:[2,3,0,1] row_mask:0xf bank_mask:0xf
s_nop 1
v_add_f32_dpp v33, v33, v33 row_ror:4 row_mask:0xf bank_mask:0xf
s_nop 1
v_add_f32_dpp v33, v33, v33 row_ror:8 row_mask:0xf bank_mask:0xf
s_nop 1
v_add_f32_dpp v33, v33, v33 row_bcast:15 row_mask:0xa bank_mask:0xf
s_nop 1
v_add_f32_dpp v33, v33, v33 row_bcast:31 row_mask:0xc bank_mask:0xf
s_nop 0
v_readlane_b32 s61, v33, 63
v_and_b32_dpp v48, v28, v4 row_newbcast:6 row_mask:0xf bank_mask:0xf
v_and_b32_dpp v49, v28, v5 row_newbcast:6 row_mask:0xf bank_mask:0xf
v_and_b32_dpp v50, v28, v6 row_newbcast:6 row_mask:0xf bank_mask:0xf
v_and_b32_dpp v51, v28, v7 row_newbcast:6 row_mask:0xf bank_mask:0xf
s_nop 1
v_mfma_f32_16x16x32_bf16 v[20:23], v[48:51], a[16:19], v[20:23]
s_waitcnt vmcnt(7)
s_cmp_lt_u32 s86, 1
s_cbranch_scc1 1
s_waitcnt vmcnt(5)
s_barrier
buffer_load_dwordx4 a[12:15], v0, s[8:11], s45 offen offset:0 nt
v_and_b32_dpp v36, v24, v4 row_newbcast:0 row_mask:0xf bank_mask:0xf
v_and_b32_dpp v37, v24, v5 row_newbcast:0 row_mask:0xf bank_mask:0xf
v_and_b32_dpp v38, v24, v6 row_newbcast:0 row_mask:0xf bank_mask:0xf
v_and_b32_dpp v39, v24, v7 row_newbcast:0 row_mask:0xf bank_mask:0xf
s_nop 1
v_mfma_f32_16x16x32_bf16 v[16:19], v[36:39], v[136:139], 0
v_and_b32_dpp v40, v28, v4 row_newbcast:10 row_mask:0xf bank_mask:0xf
v_and_b32_dpp v41, v28, v5 row_newbcast:10 row_mask:0xf bank_mask:0xf
v_and_b32_dpp v42, v28, v6 row_newbcast:10 row_mask:0xf bank_mask:0xf
v_and_b32_dpp v43, v28, v7 row_newbcast:10 row_mask:0xf bank_mask:0xf
s_nop 1
v_mfma_f32_16x16x32_bf16 v[20:23], v[40:43], a[20:23], v[20:23]
s_waitcnt vmcnt(7)
s_cmp_lt_u32 s86, 1
s_cbranch_scc1 1
s_waitcnt vmcnt(5)
buffer_load_dwordx4 a[16:19], v0, s[8:11], s45 offen offset:1024 nt
v_and_b32_dpp v44, v24, v4 row_newbcast:4 row_mask:0xf bank_mask:0xf
v_and_b32_dpp v45, v24, v5 row_newbcast:4 row_mask:0xf bank_mask:0xf
v_and_b32_dpp v46, v24, v6 row_newbcast:4 row_mask:0xf bank_mask:0xf
v_and_b32_dpp v47, v24, v7 row_newbcast:4 row_mask:0xf bank_mask:0xf
s_nop 1
v_mfma_f32_16x16x32_bf16 v[16:19], v[44:47], v[140:143], v[16:19]
v_and_b32_dpp v48, v28, v4 row_newbcast:14 row_mask:0xf bank_mask:0xf
v_and_b32_dpp v49, v28, v5 row_newbcast:14 row_mask:0xf bank_mask:0xf
v_and_b32_dpp v50, v28, v6 row_newbcast:14 row_mask:0xf bank_mask:0xf
v_and_b32_dpp v51, v28, v7 row_newbcast:14 row_mask:0xf bank_mask:0xf
s_nop 1
v_mfma_f32_16x16x32_bf16 v[20:23], v[48:51], a[24:27], v[20:23]
s_waitcnt vmcnt(7)
s_cmp_lt_u32 s86, 1
s_cbranch_scc1 1
s_waitcnt vmcnt(5)
buffer_load_dwordx4 a[20:23], v0, s[8:11], s45 offen offset:2048 nt
v_and_b32_dpp v36, v24, v4 row_newbcast:8 row_mask:0xf bank_mask:0xf
v_and_b32_dpp v37, v24, v5 row_newbcast:8 row_mask:0xf bank_mask:0xf
v_and_b32_dpp v38, v24, v6 row_newbcast:8 row_mask:0xf bank_mask:0xf
v_and_b32_dpp v39, v24, v7 row_newbcast:8 row_mask:0xf bank_mask:0xf
s_nop 1
v_mfma_f32_16x16x32_bf16 v[16:19], v[36:39], v[144:147], v[16:19]
v_and_b32_dpp v40, v28, v4 row_newbcast:3 row_mask:0xf bank_mask:0xf
v_and_b32_dpp v41, v28, v5 row_newbcast:3 row_mask:0xf bank_mask:0xf
v_and_b32_dpp v42, v28, v6 row_newbcast:3 row_mask:0xf bank_mask:0xf
v_and_b32_dpp v43, v28, v7 row_newbcast:3 row_mask:0xf bank_mask:0xf
s_nop 1
v_mfma_f32_16x16x32_bf16 v[20:23], v[40:43], a[28:31], v[20:23]
s_waitcnt vmcnt(7)
s_cmp_lt_u32 s86, 1
s_cbranch_scc1 1
s_waitcnt vmcnt(5)
buffer_load_dwordx4 a[24:27], v0, s[8:11], s45 offen offset:3072 nt
s_add_u32 s45, s45, 16384
v_and_b32_dpp v44, v24, v4 row_newbcast:12 row_mask:0xf bank_mask:0xf
v_and_b32_dpp v45, v24, v5 row_newbcast:12 row_mask:0xf bank_mask:0xf
v_and_b32_dpp v46, v24, v6 row_newbcast:12 row_mask:0xf bank_mask:0xf
v_and_b32_dpp v47, v24, v7 row_newbcast:12 row_mask:0xf bank_mask:0xf
s_nop 1
v_mfma_f32_16x16x32_bf16 v[16:19], v[44:47], v[148:151], v[16:19]
v_and_b32_dpp v48, v28, v4 row_newbcast:7 row_mask:0xf bank_mask:0xf
v_and_b32_dpp v49, v28, v5 row_newbcast:7 row_mask:0xf bank_mask:0xf
v_and_b32_dpp v50, v28, v6 row_newbcast:7 row_mask:0xf bank_mask:0xf
v_and_b32_dpp v51, v28, v7 row_newbcast:7 row_mask:0xf bank_mask:0xf
s_nop 1
v_mfma_f32_16x16x32_bf16 v[20:23], v[48:51], a[32:35], v[20:23]
s_waitcnt vmcnt(7)
s_cmp_lt_u32 s86, 1
s_cbranch_scc1 1
s_waitcnt vmcnt(5)
buffer_load_dwordx4 a[28:31], v0, s[8:11], s45 offen offset:0 nt
v_and_b32_dpp v36, v24, v4 row_newbcast:1 row_mask:0xf bank_mask:0xf
v_and_b32_dpp v37, v24, v5 row_newbcast:1 row_mask:0xf bank_mask:0xf
v_and_b32_dpp v38, v24, v6 row_newbcast:1 row_mask:0xf bank_mask:0xf
v_and_b32_dpp v39, v24, v7 row_newbcast:1 row_mask:0xf bank_mask:0xf
s_nop 1
v_mfma_f32_16x16x32_bf16 v[16:19], v[36:39], v[152:155], v[16:19]
v_and_b32_dpp v40, v28, v4 row_newbcast:11 row_mask:0xf bank_mask:0xf
v_and_b32_dpp v41, v28, v5 row_newbcast:11 row_mask:0xf bank_mask:0xf
v_and_b32_dpp v42, v28, v6 row_newbcast:11 row_mask:0xf bank_mask:0xf
v_and_b32_dpp v43, v28, v7 row_newbcast:11 row_mask:0xf bank_mask:0xf
s_nop 1
v_mfma_f32_16x16x32_bf16 v[20:23], v[40:43], a[36:39], v[20:23]
s_waitcnt vmcnt(7)
s_cmp_lt_u32 s86, 1
s_cbranch_scc1 1
s_waitcnt vmcnt(5)
buffer_load_dwordx4 a[32:35], v0, s[8:11], s45 offen offset:1024 nt
v_and_b32_dpp v44, v24, v4 row_newbcast:5 row_mask:0xf bank_mask:0xf
v_and_b32_dpp v45, v24, v5 row_newbcast:5 row_mask:0xf bank_mask:0xf
v_and_b32_dpp v46, v24, v6 row_newbcast:5 row_mask:0xf bank_mask:0xf
v_and_b32_dpp v47, v24, v7 row_newbcast:5 row_mask:0xf bank_mask:0xf
s_nop 1
v_mfma_f32_16x16x32_bf16 v[16:19], v[44:47], a[0:3], v[16:19]
v_and_b32_dpp v48, v28, v4 row_newbcast:15 row_mask:0xf bank_mask:0xf
v_and_b32_dpp v49, v28, v5 row_newbcast:15 row_mask:0xf bank_mask:0xf
v_and_b32_dpp v50, v28, v6 row_newbcast:15 row_mask:0xf bank_mask:0xf
v_and_b32_dpp v51, v28, v7 row_newbcast:15 row_mask:0xf bank_mask:0xf
s_nop 1
v_mfma_f32_16x16x32_bf16 v[20:23], v[48:51], a[40:43], v[20:23]
buffer_load_dwordx4 v[8:11], v3, s[12:15], s50 offen sc1
s_waitcnt vmcnt(8)
s_cmp_lt_u32 s86, 1
s_cbranch_scc1 1
s_waitcnt vmcnt(5)
buffer_load_dwordx4 a[36:39], v0, s[8:11], s45 offen offset:2048 nt
v_and_b32_dpp v36, v24, v4 row_newbcast:9 row_mask:0xf bank_mask:0xf
v_and_b32_dpp v37, v24, v5 row_newbcast:9 row_mask:0xf bank_mask:0xf
v_and_b32_dpp v38, v24, v6 row_newbcast:9 row_mask:0xf bank_mask:0xf
v_and_b32_dpp v39, v24, v7 row_newbcast:9 row_mask:0xf bank_mask:0xf
s_nop 1
v_mfma_f32_16x16x32_bf16 v[16:19], v[36:39], a[4:7], v[16:19]
v_and_b32_dpp v40, v29, v4 row_newbcast:0 row_mask:0xf bank_mask:0xf
v_and_b32_dpp v41, v29, v5 row_newbcast:0 row_mask:0xf bank_mask:0xf
v_and_b32_dpp v42, v29, v6 row_newbcast:0 row_mask:0xf bank_mask:0xf
v_and_b32_dpp v43, v29, v7 row_newbcast:0 row_mask:0xf bank_mask:0xf
s_nop 1
v_mfma_f32_16x16x32_bf16 v[20:23], v[40:43], a[44:47], v[20:23]
s_waitcnt vmcnt(8)
s_cmp_lt_u32 s86, 1
s_cbranch_scc1 1
s_waitcnt vmcnt(5)
buffer_load_dwordx4 a[40:43], v0, s[8:11], s45 offen offset:3072 nt
s_add_u32 s45, s45, 16384
v_and_b32_dpp v44, v24, v4 row_newbcast:13 row_mask:0xf bank_mask:0xf
v_and_b32_dpp v45, v24, v5 row_newbcast:13 row_mask:0xf bank_mask:0xf
v_and_b32_dpp v46, v24, v6 row_newbcast:13 row_mask:0xf bank_mask:0xf
v_and_b32_dpp v47, v24, v7 row_newbcast:13 row_mask:0xf bank_mask:0xf
s_nop 1
v_mfma_f32_16x16x32_bf16 v[16:19], v[44:47], a[8:11], v[16:19]
v_and_b32_dpp v48, v29, v4 row_newbcast:4 row_mask:0xf bank_mask:0xf
v_and_b32_dpp v49, v29, v5 row_newbcast:4 row_mask:0xf bank_mask:0xf
v_and_b32_dpp v50, v29, v6 row_newbcast:4 row_mask:0xf bank_mask:0xf
v_and_b32_dpp v51, v29, v7 row_newbcast:4 row_mask:0xf bank_mask:0xf
s_nop 1
v_mfma_f32_16x16x32_bf16 v[20:23], v[48:51], a[48:51], v[20:23]
s_waitcnt vmcnt(8)
s_cmp_lt_u32 s86, 1
s_cbranch_scc1 1
s_waitcnt vmcnt(5)
s_barrier
buffer_load_dwordx4 a[44:47], v0, s[8:11], s45 offen offset:0 nt
v_and_b32_dpp v36, v24, v4 row_newbcast:2 row_mask:0xf bank_mask:0xf
v_and_b32_dpp v37, v24, v5 row_newbcast:2 row_mask:0xf bank_mask:0xf
v_and_b32_dpp v38, v24, v6 row_newbcast:2 row_mask:0xf bank_mask:0xf
v_and_b32_dpp v39, v24, v7 row_newbcast:2 row_mask:0xf bank_mask:0xf
s_nop 1
v_mfma_f32_16x16x32_bf16 v[16:19], v[36:39], a[12:15], v[16:19]
v_and_b32_dpp v40, v29, v4 row_newbcast:8 row_mask:0xf bank_mask:0xf
v_and_b32_dpp v41, v29, v5 row_newbcast:8 row_mask:0xf bank_mask:0xf
v_and_b32_dpp v42, v29, v6 row_newbcast:8 row_mask:0xf bank_mask:0xf
v_and_b32_dpp v43, v29, v7 row_newbcast:8 row_mask:0xf bank_mask:0xf
s_nop 1
v_mfma_f32_16x16x32_bf16 v[20:23], v[40:43], a[52:55], v[20:23]
s_waitcnt vmcnt(8)
s_cmp_lt_u32 s86, 1
s_cbranch_scc1 1
s_waitcnt vmcnt(5)
buffer_load_dwordx4 a[48:51], v0, s[8:11], s45 offen offset:1024 nt
v_and_b32_dpp v44, v24, v4 row_newbcast:6 row_mask:0xf bank_mask:0xf
v_and_b32_dpp v45, v24, v5 row_newbcast:6 row_mask:0xf bank_mask:0xf
v_and_b32_dpp v46, v24, v6 row_newbcast:6 row_mask:0xf bank_mask:0xf
v_and_b32_dpp v47, v24, v7 row_newbcast:6 row_mask:0xf bank_mask:0xf
s_nop 1
v_mfma_f32_16x16x32_bf16 v[16:19], v[44:47], a[16:19], v[16:19]
v_and_b32_dpp v48, v29, v4 row_newbcast:12 row_mask:0xf bank_mask:0xf
v_and_b32_dpp v49, v29, v5 row_newbcast:12 row_mask:0xf bank_mask:0xf
v_and_b32_dpp v50, v29, v6 row_newbcast:12 row_mask:0xf bank_mask:0xf
v_and_b32_dpp v51, v29, v7 row_newbcast:12 row_mask:0xf bank_mask:0xf
s_nop 1
v_mfma_f32_16x16x32_bf16 v[20:23], v[48:51], a[56:59], v[20:23]
s_waitcnt vmcnt(8)
s_cmp_lt_u32 s86, 1
s_cbranch_scc1 1
s_waitcnt vmcnt(5)
buffer_load_dwordx4 a[52:55], v0, s[8:11], s45 offen offset:2048 nt
v_and_b32_dpp v36, v24, v4 row_newbcast:10 row_mask:0xf bank_mask:0xf
v_and_b32_dpp v37, v24, v5 row_newbcast:10 row_mask:0xf bank_mask:0xf
v_and_b32_dpp v38, v24, v6 row_newbcast:10 row_mask:0xf bank_mask:0xf
v_and_b32_dpp v39, v24, v7 row_newbcast:10 row_mask:0xf bank_mask:0xf
s_nop 1
v_mfma_f32_16x16x32_bf16 v[16:19], v[36:39], a[20:23], v[16:19]
v_and_b32_dpp v40, v29, v4 row_newbcast:1 row_mask:0xf bank_mask:0xf
v_and_b32_dpp v41, v29, v5 row_newbcast:1 row_mask:0xf bank_mask:0xf
v_and_b32_dpp v42, v29, v6 row_newbcast:1 row_mask:0xf bank_mask:0xf
v_and_b32_dpp v43, v29, v7 row_newbcast:1 row_mask:0xf bank_mask:0xf
s_nop 1
v_mfma_f32_16x16x32_bf16 v[20:23], v[40:43], a[60:63], v[20:23]
s_waitcnt vmcnt(8)
s_cmp_lt_u32 s86, 1
s_cbranch_scc1 1
s_waitcnt vmcnt(5)
buffer_load_dwordx4 a[56:59], v0, s[8:11], s45 offen offset:3072 nt
s_add_u32 s45, s45, 16384
v_and_b32_dpp v44, v24, v4 row_newbcast:14 row_mask:0xf bank_mask:0xf
v_and_b32_dpp v45, v24, v5 row_newbcast:14 row_mask:0xf bank_mask:0xf
v_and_b32_dpp v46, v24, v6 row_newbcast:14 row_mask:0xf bank_mask:0xf
v_and_b32_dpp v47, v24, v7 row_newbcast:14 row_mask:0xf bank_mask:0xf
s_nop 1
v_mfma_f32_16x16x32_bf16 v[16:19], v[44:47], a[24:27], v[16:19]
v_and_b32_dpp v48, v29, v4 row_newbcast:5 row_mask:0xf bank_mask:0xf
v_and_b32_dpp v49, v29, v5 row_newbcast:5 row_mask:0xf bank_mask:0xf
v_and_b32_dpp v50, v29, v6 row_newbcast:5 row_mask:0xf bank_mask:0xf
v_and_b32_dpp v51, v29, v7 row_newbcast:5 row_mask:0xf bank_mask:0xf
s_nop 1
v_mfma_f32_16x16x32_bf16 v[20:23], v[48:51], a[64:67], v[20:23]
s_waitcnt vmcnt(8)
s_cmp_lt_u32 s86, 1
s_cbranch_scc1 1
s_waitcnt vmcnt(5)
buffer_load_dwordx4 a[60:63], v0, s[8:11], s45 offen offset:0 nt
v_and_b32_dpp v36, v24, v4 row_newbcast:3 row_mask:0xf bank_mask:0xf
v_and_b32_dpp v37, v24, v5 row_newbcast:3 row_mask:0xf bank_mask:0xf
v_and_b32_dpp v38, v24, v6 row_newbcast:3 row_mask:0xf bank_mask:0xf
v_and_b32_dpp v39, v24, v7 row_newbcast:3 row_mask:0xf bank_mask:0xf
s_nop 1
v_mfma_f32_16x16x32_bf16 v[16:19], v[36:39], a[28:31], v[16:19]
v_and_b32_dpp v40, v29, v4 row_newbcast:9 row_mask:0xf bank_mask:0xf
v_and_b32_dpp v41, v29, v5 row_newbcast:9 row_mask:0xf bank_mask:0xf
v_and_b32_dpp v42, v29, v6 row_newbcast:9 row_mask:0xf bank_mask:0xf
v_and_b32_dpp v43, v29, v7 row_newbcast:9 row_mask:0xf bank_mask:0xf
s_nop 1
v_mfma_f32_16x16x32_bf16 v[20:23], v[40:43], a[68:71], v[20:23]
s_waitcnt vmcnt(8)
s_cmp_lt_u32 s86, 1
s_cbranch_scc1 1
s_waitcnt vmcnt(5)
buffer_load_dwordx4 a[64:67], v0, s[8:11], s45 offen offset:1024 nt
v_and_b32_dpp v44, v24, v4 row_newbcast:7 row_mask:0xf bank_mask:0xf
v_and_b32_dpp v45, v24, v5 row_newbcast:7 row_mask:0xf bank_mask:0xf
v_and_b32_dpp v46, v24, v6 row_newbcast:7 row_mask:0xf bank_mask:0xf
v_and_b32_dpp v47, v24, v7 row_newbcast:7 row_mask:0xf bank_mask:0xf
s_nop 1
v_mfma_f32_16x16x32_bf16 v[16:19], v[44:47], a[32:35], v[16:19]
v_and_b32_dpp v48, v29, v4 row_newbcast:13 row_mask:0xf bank_mask:0xf
v_and_b32_dpp v49, v29, v5 row_newbcast:13 row_mask:0xf bank_mask:0xf
v_and_b32_dpp v50, v29, v6 row_newbcast:13 row_mask:0xf bank_mask:0xf
v_and_b32_dpp v51, v29, v7 row_newbcast:13 row_mask:0xf bank_mask:0xf
s_nop 1
v_mfma_f32_16x16x32_bf16 v[20:23], v[48:51], a[72:75], v[20:23]
s_waitcnt vmcnt(8)
s_nop 6
Lq25:
v_max3_u32 v33, v8, v9, v10
v_max_u32 v33, v33, v11
v_cmp_eq_u32 vcc, -1, v33
s_nop 0
s_cbranch_vccz Lq26
s_sleep 1
buffer_load_dwordx4 v[8:11], v3, s[12:15], s50 offen sc1
s_waitcnt vmcnt(0)
s_sub_u32 s64, s64, 1
s_cmp_gt_i32 s64, 0
s_cbranch_scc1 Lq25
Lq26:
s_add_u32 s50, s50, 256
s_waitcnt vmcnt(7)
s_cmp_lt_u32 s86, 1
s_cbranch_scc1 1
s_waitcnt vmcnt(5)
buffer_load_dwordx4 a[68:71], v0, s[8:11], s45 offen offset:2048 nt
v_and_b32_dpp v36, v24, v4 row_newbcast:11 row_mask:0xf bank_mask:0xf
v_and_b32_dpp v37, v24, v5 row_newbcast:11 row_mask:0xf bank_mask:0xf
v_and_b32_dpp v38, v24, v6 row_newbcast:11 row_mask:0xf bank_mask:0xf
v_and_b32_dpp v39, v24, v7 row_newbcast:11 row_mask:0xf bank_mask:0xf
s_nop 1
v_mfma_f32_16x16x32_bf16 v[16:19], v[36:39], a[36:39], v[16:19]
v_and_b32_dpp v40, v29, v4 row_newbcast:2 row_mask:0xf bank_mask:0xf
v_and_b32_dpp v41, v29, v5 row_newbcast:2 row_mask:0xf bank_mask:0xf
v_and_b32_dpp v42, v29, v6 row_newbcast:2 row_mask:0xf bank_mask:0xf
v_and_b32_dpp v43, v29, v7 row_newbcast:2 row_mask:0xf bank_mask:0xf
s_nop 1
v_mfma_f32_16x16x32_bf16 v[20:23], v[40:43], a[76:79], v[20:23]
s_waitcnt vmcnt(7)
s_cmp_lt_u32 s86, 1
s_cbranch_scc1 1
s_waitcnt vmcnt(5)
buffer_load_dwordx4 a[72:75], v0, s[8:11], s45 offen offset:3072 nt
s_add_u32 s45, s45, 16384
v_and_b32_dpp v44, v24, v4 row_newbcast:15 row_mask:0xf bank_mask:0xf
v_and_b32_dpp v45, v24, v5 row_newbcast:15 row_mask:0xf bank_mask:0xf
v_and_b32_dpp v46, v24, v6 row_newbcast:15 row_mask:0xf bank_mask:0xf
v_and_b32_dpp v47, v24, v7 row_newbcast:15 row_mask:0xf bank_mask:0xf
s_nop 1
v_mfma_f32_16x16x32_bf16 v[16:19], v[44:47], a[40:43], v[16:19]
v_and_b32_dpp v48, v29, v4 row_newbcast:6 row_mask:0xf bank_mask:0xf
v_and_b32_dpp v49, v29, v5 row_newbcast:6 row_mask:0xf bank_mask:0xf
v_and_b32_dpp v50, v29, v6 row_newbcast:6 row_mask:0xf bank_mask:0xf
v_and_b32_dpp v51, v29, v7 row_newbcast:6 row_mask:0xf bank_mask:0xf
s_nop 1
v_mfma_f32_16x16x32_bf16 v[20:23], v[48:51], a[80:83], v[20:23]
buffer_load_dwordx4 v[12:15], v3, s[12:15], s51 offen sc1
s_waitcnt vmcnt(8)
s_cmp_lt_u32 s86, 1
s_cbranch_scc1 1
s_waitcnt vmcnt(5)
s_barrier
buffer_load_dwordx4 a[76:79], v0, s[8:11], s45 offen offset:0 nt
v_and_b32_dpp v36, v25, v4 row_newbcast:0 row_mask:0xf bank_mask:0xf
v_and_b32_dpp v37, v25, v5 row_newbcast:0 row_mask:0xf bank_mask:0xf
v_and_b32_dpp v38, v25, v6 row_newbcast:0 row_mask:0xf bank_mask:0xf
v_and_b32_dpp v39, v25, v7 row_newbcast:0 row_mask:0xf bank_mask:0xf
s_nop 1
v_mfma_f32_16x16x32_bf16 v[16:19], v[36:39], a[44:47], v[16:19]
v_and_b32_dpp v40, v29, v4 row_newbcast:10 row_mask:0xf bank_mask:0xf
v_and_b32_dpp v41, v29, v5 row_newbcast:10 row_mask:0xf bank_mask:0xf
v_and_b32_dpp v42, v29, v6 row_newbcast:10 row_mask:0xf bank_mask:0xf
v_and_b32_dpp v43, v29, v7 row_newbcast:10 row_mask:0xf bank_mask:0xf
s_nop 1
v_mfma_f32_16x16x32_bf16 v[20:23], v[40:43], a[84:87], v[20:23]
s_waitcnt vmcnt(8)
s_cmp_lt_u32 s86, 1
s_cbranch_scc1 1
s_waitcnt vmcnt(5)
buffer_load_dwordx4 a[80:83], v0, s[8:11], s45 offen offset:1024 nt
v_and_b32_dpp v44, v25, v4 row_newbcast:4 row_mask:0xf bank_mask:0xf
v_and_b32_dpp v45, v25, v5 row_newbcast:4 row_mask:0xf bank_mask:0xf
v_and_b32_dpp v46, v25, v6 row_newbcast:4 row_mask:0xf bank_mask:0xf
v_and_b32_dpp v47, v25, v7 row_newbcast:4 row_mask:0xf bank_mask:0xf
s_nop 1
v_mfma_f32_16x16x32_bf16 v[16:19], v[44:47], a[48:51], v[16:19]
v_and_b32_dpp v48, v29, v4 row_newbcast:14 row_mask:0xf bank_mask:0xf
v_and_b32_dpp v49, v29, v5 row_newbcast:14 row_mask:0xf bank_mask:0xf
v_and_b32_dpp v50, v29, v6 row_newbcast:14 row_mask:0xf bank_mask:0xf
v_and_b32_dpp v51, v29, v7 row_newbcast:14 row_mask:0xf bank_mask:0xf
s_nop 1
v_mfma_f32_16x16x32_bf16 v[20:23], v[48:51], a[88:91], v[20:23]
s_waitcnt vmcnt(8)
s_cmp_lt_u32 s86, 1
s_cbranch_scc1 1
s_waitcnt vmcnt(5)
buffer_load_dwordx4 a[84:87], v0, s[8:11], s45 offen offset:2048 nt
v_and_b32_dpp v36, v25, v4 row_newbcast:8 row_mask:0xf bank_mask:0xf
v_and_b32_dpp v37, v25, v5 row_newbcast:8 row_mask:0xf bank_mask:0xf
v_and_b32_dpp v38, v25, v6 row_newbcast:8 row_mask:0xf bank_mask:0xf
v_and_b32_dpp v39, v25, v7 row_newbcast:8 row_mask:0xf bank_mask:0xf
s_nop 1
v_mfma_f32_16x16x32_bf16 v[16:19], v[36:39], a[52:55], v[16:19]
v_and_b32_dpp v40, v29, v4 row_newbcast:3 row_mask:0xf bank_mask:0xf
v_and_b32_dpp v41, v29, v5 row_newbcast:3 row_mask:0xf bank_mask:0xf
v_and_b32_dpp v42, v29, v6 row_newbcast:3 row_mask:0xf bank_mask:0xf
v_and_b32_dpp v43, v29, v7 row_newbcast:3 row_mask:0xf bank_mask:0xf
s_nop 1
v_mfma_f32_16x16x32_bf16 v[20:23], v[40:43], a[92:95], v[20:23]
s_waitcnt vmcnt(8)
s_cmp_lt_u32 s86, 1
s_cbranch_scc1 1
s_waitcnt vmcnt(5)
buffer_load_dwordx4 a[88:91], v0, s[8:11], s45 offen offset:3072 nt
s_add_u32 s45, s45, 16384
v_and_b32_dpp v44, v25, v4 row_newbcast:12 row_mask:0xf bank_mask:0xf
v_and_b32_dpp v45, v25, v5 row_newbcast:12 row_mask:0xf bank_mask:0xf
v_and_b32_dpp v46, v25, v6 row_newbcast:12 row_mask:0xf bank_mask:0xf
v_and_b32_dpp v47, v25, v7 row_newbcast:12 row_mask:0xf bank_mask:0xf
s_nop 1
v_mfma_f32_16x16x32_bf16 v[16:19], v[44:47], a[56:59], v[16:19]
v_and_b32_dpp v48, v29, v4 row_newbcast:7 row_mask:0xf bank_mask:0xf
v_and_b32_dpp v49, v29, v5 row_newbcast:7 row_mask:0xf bank_mask:0xf
v_and_b32_dpp v50, v29, v6 row_newbcast:7 row_mask:0xf bank_mask:0xf
v_and_b32_dpp v51, v29, v7 row_newbcast:7 row_mask:0xf bank_mask:0xf
s_nop 1
v_mfma_f32_16x16x32_bf16 v[20:23], v[48:51], a[96:99], v[20:23]
s_waitcnt vmcnt(8)
s_cmp_lt_u32 s86, 1
s_cbranch_scc1 1
s_waitcnt vmcnt(5)
buffer_load_dwordx4 a[92:95], v0, s[8:11], s45 offen offset:0 nt
v_and_b32_dpp v36, v25, v4 row_newbcast:1 row_mask:0xf bank_mask:0xf
v_and_b32_dpp v37, v25, v5 row_newbcast:1 row_mask:0xf bank_mask:0xf
v_and_b32_dpp v38, v25, v6 row_newbcast:1 row_mask:0xf bank_mask:0xf
v_and_b32_dpp v39, v25, v7 row_newbcast:1 row_mask:0xf bank_mask:0xf
s_nop 1
v_mfma_f32_16x16x32_bf16 v[16:19], v[36:39], a[60:63], v[16:19]
v_and_b32_dpp v40, v29, v4 row_newbcast:11 row_mask:0xf bank_mask:0xf
v_and_b32_dpp v41, v29, v5 row_newbcast:11 row_mask:0xf bank_mask:0xf
v_and_b32_dpp v42, v29, v6 row_newbcast:11 row_mask:0xf bank_mask:0xf
v_and_b32_dpp v43, v29, v7 row_newbcast:11 row_mask:0xf bank_mask:0xf
s_nop 1
v_mfma_f32_16x16x32_bf16 v[20:23], v[40:43], a[100:103], v[20:23]
s_waitcnt vmcnt(8)
s_cmp_lt_u32 s86, 1
s_cbranch_scc1 1
s_waitcnt vmcnt(5)
buffer_load_dwordx4 a[96:99], v0, s[8:11], s45 offen offset:1024 nt
v_and_b32_dpp v44, v25, v4 row_newbcast:5 row_mask:0xf bank_mask:0xf
v_and_b32_dpp v45, v25, v5 row_newbcast:5 row_mask:0xf bank_mask:0xf
v_and_b32_dpp v46, v25, v6 row_newbcast:5 row_mask:0xf bank_mask:0xf
v_and_b32_dpp v47, v25, v7 row_newbcast:5 row_mask:0xf bank_mask:0xf
s_nop 1
v_mfma_f32_16x16x32_bf16 v[16:19], v[44:47], a[64:67], v[16:19]
v_and_b32_dpp v48, v29, v4 row_newbcast:15 row_mask:0xf bank_mask:0xf
v_and_b32_dpp v49, v29, v5 row_newbcast:15 row_mask:0xf bank_mask:0xf
v_and_b32_dpp v50, v29, v6 row_newbcast:15 row_mask:0xf bank_mask:0xf
v_and_b32_dpp v51, v29, v7 row_newbcast:15 row_mask:0xf bank_mask:0xf
s_nop 1
v_mfma_f32_16x16x32_bf16 v[20:23], v[48:51], a[104:107], v[20:23]
s_waitcnt vmcnt(8)
s_cmp_lt_u32 s86, 1
s_cbranch_scc1 1
s_waitcnt vmcnt(5)
buffer_load_dwordx4 a[100:103], v0, s[8:11], s45 offen offset:2048 nt
v_and_b32_dpp v36, v25, v4 row_newbcast:9 row_mask:0xf bank_mask:0xf
v_and_b32_dpp v37, v25, v5 row_newbcast:9 row_mask:0xf bank_mask:0xf
v_and_b32_dpp v38, v25, v6 row_newbcast:9 row_mask:0xf bank_mask:0xf
v_and_b32_dpp v39, v25, v7 row_newbcast:9 row_mask:0xf bank_mask:0xf
s_nop 1
v_mfma_f32_16x16x32_bf16 v[16:19], v[36:39], a[68:71], v[16:19]
v_and_b32_dpp v40, v30, v4 row_newbcast:0 row_mask:0xf bank_mask:0xf
v_and_b32_dpp v41, v30, v5 row_newbcast:0 row_mask:0xf bank_mask:0xf
v_and_b32_dpp v42, v30, v6 row_newbcast:0 row_mask:0xf bank_mask:0xf
v_and_b32_dpp v43, v30, v7 row_newbcast:0 row_mask:0xf bank_mask:0xf
s_nop 1
v_mfma_f32_16x16x32_bf16 v[20:23], v[40:43], a[108:111], v[20:23]
s_waitcnt vmcnt(8)
s_cmp_lt_u32 s86, 1
s_cbranch_scc1 1
s_waitcnt vmcnt(5)
buffer_load_dwordx4 a[104:107], v0, s[8:11], s45 offen offset:3072 nt
s_add_u32 s45, s45, 16384
v_and_b32_dpp v44, v25, v4 row_newbcast:13 row_mask:0xf bank_mask:0xf
v_and_b32_dpp v45, v25, v5 row_newbcast:13 row_mask:0xf bank_mask:0xf
v_and_b32_dpp v46, v25, v6 row_newbcast:13 row_mask:0xf bank_mask:0xf
v_and_b32_dpp v47, v25, v7 row_newbcast:13 row_mask:0xf bank_mask:0xf
s_nop 1
v_mfma_f32_16x16x32_bf16 v[16:19], v[44:47], a[72:75], v[16:19]
s_waitcnt vmcnt(8)
v_cmp_eq_u32 vcc, -1, v12
s_nop 0
s_cmp_lg_u64 vcc, 0
s_cselect_b32 s86, 1, 0
v_and_b32_dpp v48, v30, v4 row_newbcast:4 row_mask:0xf bank_mask:0xf
v_and_b32_dpp v49, v30, v5 row_newbcast:4 row_mask:0xf bank_mask:0xf
v_and_b32_dpp v50, v30, v6 row_newbcast:4 row_mask:0xf bank_mask:0xf
v_and_b32_dpp v51, v30, v7 row_newbcast:4 row_mask:0xf bank_mask:0xf
s_nop 1
v_mfma_f32_16x16x32_bf16 v[20:23], v[48:51], a[112:115], v[20:23]
s_waitcnt vmcnt(7)
s_cmp_lt_u32 s86, 1
s_cbranch_scc1 1
s_waitcnt vmcnt(5)
s_barrier
buffer_load_dwordx4 a[108:111], v0, s[8:11], s45 offen offset:0 nt
v_and_b32_dpp v36, v25, v4 row_newbcast:2 row_mask:0xf bank_mask:0xf
v_and_b32_dpp v37, v25, v5 row_newbcast:2 row_mask:0xf bank_mask:0xf
v_and_b32_dpp v38, v25, v6 row_newbcast:2 row_mask:0xf bank_mask:0xf
v_and_b32_dpp v39, v25, v7 row_newbcast:2 row_mask:0xf bank_mask:0xf
s_nop 1
v_mfma_f32_16x16x32_bf16 v[16:19], v[36:39], a[76:79], v[16:19]
v_and_b32_dpp v40, v30, v4 row_newbcast:8 row_mask:0xf bank_mask:0xf
v_and_b32_dpp v41, v30, v5 row_newbcast:8 row_mask:0xf bank_mask:0xf
v_and_b32_dpp v42, v30, v6 row_newbcast:8 row_mask:0xf bank_mask:0xf
v_and_b32_dpp v43, v30, v7 row_newbcast:8 row_mask:0xf bank_mask:0xf
s_nop 1
v_mfma_f32_16x16x32_bf16 v[20:23], v[40:43], a[116:119], v[20:23]
buffer_load_dwordx4 v[12:15], v3, s[12:15], s51 offen sc1
s_waitcnt vmcnt(8)
s_cmp_lt_u32 s86, 1
s_cbranch_scc1 1
s_waitcnt vmcnt(5)
buffer_load_dwordx4 a[112:115], v0, s[8:11], s45 offen offset:1024 nt
v_and_b32_dpp v44, v25, v4 row_newbcast:6 row_mask:0xf bank_mask:0xf
v_and_b32_dpp v45, v25, v5 row_newbcast:6 row_mask:0xf bank_mask:0xf
v_and_b32_dpp v46, v25, v6 row_newbcast:6 row_mask:0xf bank_mask:0xf
v_and_b32_dpp v47, v25, v7 row_newbcast:6 row_mask:0xf bank_mask:0xf
s_nop 1
v_mfma_f32_16x16x32_bf16 v[16:19], v[44:47], a[80:83], v[16:19]
v_and_b32_dpp v48, v30, v4 row_newbcast:12 row_mask:0xf bank_mask:0xf
v_and_b32_dpp v49, v30, v5 row_newbcast:12 row_mask:0xf bank_mask:0xf
v_and_b32_dpp v50, v30, v6 row_newbcast:12 row_mask:0xf bank_mask:0xf
v_and_b32_dpp v51, v30, v7 row_newbcast:12 row_mask:0xf bank_mask:0xf
s_nop 1
v_mfma_f32_16x16x32_bf16 v[20:23], v[48:51], a[120:123], v[20:23]
s_waitcnt vmcnt(8)
s_cmp_lt_u32 s86, 1
s_cbranch_scc1 1
s_waitcnt vmcnt(5)
buffer_load_dwordx4 a[116:119], v0, s[8:11], s45 offen offset:2048 nt
v_and_b32_dpp v36, v25, v4 row_newbcast:10 row_mask:0xf bank_mask:0xf
v_and_b32_dpp v37, v25, v5 row_newbcast:10 row_mask:0xf bank_mask:0xf
v_and_b32_dpp v38, v25, v6 row_newbcast:10 row_mask:0xf bank_mask:0xf
v_and_b32_dpp v39, v25, v7 row_newbcast:10 row_mask:0xf bank_mask:0xf
s_nop 1
v_mfma_f32_16x16x32_bf16 v[16:19], v[36:39], a[84:87], v[16:19]
v_and_b32_dpp v40, v30, v4 row_newbcast:1 row_mask:0xf bank_mask:0xf
v_and_b32_dpp v41, v30, v5 row_newbcast:1 row_mask:0xf bank_mask:0xf
v_and_b32_dpp v42, v30, v6 row_newbcast:1 row_mask:0xf bank_mask:0xf
v_and_b32_dpp v43, v30, v7 row_newbcast:1 row_mask:0xf bank_mask:0xf
s_nop 1
v_mfma_f32_16x16x32_bf16 v[20:23], v[40:43], a[124:127], v[20:23]
s_waitcnt vmcnt(8)
s_cmp_lt_u32 s86, 1
s_cbranch_scc1 1
s_waitcnt vmcnt(5)
buffer_load_dwordx4 a[120:123], v0, s[8:11], s45 offen offset:3072 nt
s_add_u32 s45, s45, 16384
v_and_b32_dpp v44, v25, v4 row_newbcast:14 row_mask:0xf bank_mask:0xf
v_and_b32_dpp v45, v25, v5 row_newbcast:14 row_mask:0xf bank_mask:0xf
v_and_b32_dpp v46, v25, v6 row_newbcast:14 row_mask:0xf bank_mask:0xf
v_and_b32_dpp v47, v25, v7 row_newbcast:14 row_mask:0xf bank_mask:0xf
s_nop 1
v_mfma_f32_16x16x32_bf16 v[16:19], v[44:47], a[88:91], v[16:19]
v_add_u32 v33, s68, v0
v_writelane_b32 v20, s62, 32
v_writelane_b32 v21, s63, 32
s_mov_b32 exec_lo, 0xffffffff
s_mov_b32 exec_hi, 0x1
ds_write_b128 v33, v[20:23] offset:2112
s_mov_b64 exec, -1
s_waitcnt vmcnt(8)
s_cmp_lt_u32 s86, 1
s_cbranch_scc1 1
s_waitcnt vmcnt(5)
buffer_load_dwordx4 a[124:127], v2, s[8:11], s44 offen nt
s_add_u32 s44, s44, 0x2000000
s_mov_b32 s88, s87
s_mov_b32 s87, s46
s_add_u32 s45, s44, s46
v_and_b32_dpp v48, v25, v4 row_newbcast:3 row_mask:0xf bank_mask:0xf
v_and_b32_dpp v49, v25, v5 row_newbcast:3 row_mask:0xf bank_mask:0xf
v_and_b32_dpp v50, v25, v6 row_newbcast:3 row_mask:0xf bank_mask:0xf
v_and_b32_dpp v51, v25, v7 row_newbcast:3 row_mask:0xf bank_mask:0xf
s_nop 1
v_mfma_f32_16x16x32_bf16 v[16:19], v[48:51], a[92:95], v[16:19]
s_mov_b32 s48, s49
s_add_u32 s49, s49, 4096
s_cmp_eq_u32 s49, 12288
s_cselect_b32 s49, 0, s49
s_waitcnt vmcnt(8)
s_add_u32 m0, s47, s48
s_nop 0
buffer_load_dwordx4 v0, s[4:7], s45 offen offset:0 nt lds
v_and_b32_dpp v36, v25, v4 row_newbcast:7 row_mask:0xf bank_mask:0xf
v_and_b32_dpp v37, v25, v5 row_newbcast:7 row_mask:0xf bank_mask:0xf
v_and_b32_dpp v38, v25, v6 row_newbcast:7 row_mask:0xf bank_mask:0xf
v_and_b32_dpp v39, v25, v7 row_newbcast:7 row_mask:0xf bank_mask:0xf
s_nop 1
v_mfma_f32_16x16x32_bf16 v[16:19], v[36:39], a[96:99], v[16:19]
s_waitcnt vmcnt(8)
buffer_load_dwordx4 v0, s[4:7], s45 offen offset:1024 nt lds
v_and_b32_dpp v40, v25, v4 row_newbcast:11 row_mask:0xf bank_mask:0xf
v_and_b32_dpp v41, v25, v5 row_newbcast:11 row_mask:0xf bank_mask:0xf
v_and_b32_dpp v42, v25, v6 row_newbcast:11 row_mask:0xf bank_mask:0xf
v_and_b32_dpp v43, v25, v7 row_newbcast:11 row_mask:0xf bank_mask:0xf
s_nop 1
v_mfma_f32_16x16x32_bf16 v[16:19], v[40:43], a[100:103], v[16:19]
s_waitcnt vmcnt(8)
buffer_load_dwordx4 v0, s[4:7], s45 offen offset:2048 nt lds
v_and_b32_dpp v44, v25, v4 row_newbcast:15 row_mask:0xf bank_mask:0xf
v_and_b32_dpp v45, v25, v5 row_newbcast:15 row_mask:0xf bank_mask:0xf
v_and_b32_dpp v46, v25, v6 row_newbcast:15 row_mask:0xf bank_mask:0xf
v_and_b32_dpp v47, v25, v7 row_newbcast:15 row_mask:0xf bank_mask:0xf
s_nop 1
v_mfma_f32_16x16x32_bf16 v[16:19], v[44:47], a[104:107], v[16:19]
s_waitcnt vmcnt(8)
buffer_load_dwordx4 v0, s[4:7], s45 offen offset:3072 nt lds
s_add_u32 s45, s45, 16384
v_and_b32_dpp v48, v26, v4 row_newbcast:0 row_mask:0xf bank_mask:0xf
v_and_b32_dpp v49, v26, v5 row_newbcast:0 row_mask:0xf bank_mask:0xf
v_and_b32_dpp v50, v26, v6 row_newbcast:0 row_mask:0xf bank_mask:0xf
v_and_b32_dpp v51, v26, v7 row_newbcast:0 row_mask:0xf bank_mask:0xf
s_nop 1
v_mfma_f32_16x16x32_bf16 v[16:19], v[48:51], a[108:111], v[16:19]
s_waitcnt vmcnt(8)
s_nop 6
Lq27:
v_max3_u32 v33, v12, v13, v14
v_max_u32 v33, v33, v15
v_cmp_eq_u32 vcc, -1, v33
s_nop 0
s_cbranch_vccz Lq28
s_sleep 1
buffer_load_dwordx4 v[12:15], v3, s[12:15], s51 offen sc1
s_waitcnt vmcnt(0)
s_sub_u32 s64, s64, 1
s_cmp_gt_i32 s64, 0
s_cbranch_scc1 Lq27
Lq28:
s_add_u32 s51, s51, 256
ds_read_b128 v[36:39], v1 offset:25600
ds_read_b128 v[40:43], v1 offset:26624
ds_read_b128 v[44:47], v1 offset:27648
ds_read_b128 v[48:51], v1 offset:28672
s_waitcnt lgkmcnt(0)
v_dot2_f32_bf16 v52, v36, v12, 0
v_dot2_f32_bf16 v53, v40, v12, 0
v_dot2_f32_bf16 v54, v44, v12, 0
v_dot2_f32_bf16 v55, v48, v12, 0
v_dot2c_f32_bf16 v52, v37, v13
v_dot2c_f32_bf16 v53, v41, v13
v_dot2c_f32_bf16 v54, v45, v13
v_dot2c_f32_bf16 v55, v49, v13
v_dot2c_f32_bf16 v52, v38, v14
v_dot2c_f32_bf16 v53, v42, v14
v_dot2c_f32_bf16 v54, v46, v14
v_dot2c_f32_bf16 v55, v50, v14
v_dot2c_f32_bf16 v52, v39, v15
v_dot2c_f32_bf16 v53, v43, v15
v_dot2c_f32_bf16 v54, v47, v15
v_dot2c_f32_bf16 v55, v51, v15
v_add_f32_dpp v33, v52, v52 row_ror:8 row_mask:0xf bank_mask:0x3
v_add_f32_dpp v34, v53, v53 row_ror:8 row_mask:0xf bank_mask:0x3
v_add_f32_dpp v33, v54, v54 row_ror:8 row_mask:0xf bank_mask:0xc
v_add_f32_dpp v34, v55, v55 row_ror:8 row_mask:0xf bank_mask:0xc
s_nop 0
v_add_f32_dpp v28, v33, v33 row_half_mirror row_mask:0xf bank_mask:0x5
v_add_f32_dpp v28, v34, v34 row_half_mirror row_mask:0xf bank_mask:0xa
s_waitcnt vmcnt(7)
s_add_u32 m0, s47, 25600
s_nop 0
buffer_load_dwordx4 v0, s[4:7], s45 offen offset:0 nt lds
v_and_b32_dpp v36, v26, v4 row_newbcast:4 row_mask:0xf bank_mask:0xf
v_and_b32_dpp v37, v26, v5 row_newbcast:4 row_mask:0xf bank_mask:0xf
v_and_b32_dpp v38, v26, v6 row_newbcast:4 row_mask:0xf bank_mask:0xf
v_and_b32_dpp v39, v26, v7 row_newbcast:4 row_mask:0xf bank_mask:0xf
s_nop 1
v_mfma_f32_16x16x32_bf16 v[16:19], v[36:39], a[112:115], v[16:19]
v_add_u32 v33, s49, v1
ds_read_b128 v[36:39], v33 offset:0
ds_read_b128 v[40:43], v33 offset:1024
ds_read_b128 v[44:47], v33 offset:2048
ds_read_b128 v[48:51], v33 offset:3072
s_waitcnt lgkmcnt(0)
v_dot2_f32_bf16 v52, v36, v12, 0
v_dot2_f32_bf16 v53, v40, v12, 0
v_dot2_f32_bf16 v54, v44, v12, 0
v_dot2_f32_bf16 v55, v48, v12, 0
v_dot2c_f32_bf16 v52, v37, v13
v_dot2c_f32_bf16 v53, v41, v13
v_dot2c_f32_bf16 v54, v45, v13
v_dot2c_f32_bf16 v55, v49, v13
v_dot2c_f32_bf16 v52, v38, v14
v_dot2c_f32_bf16 v53, v42, v14
v_dot2c_f32_bf16 v54, v46, v14
v_dot2c_f32_bf16 v55, v50, v14
v_dot2c_f32_bf16 v52, v39, v15
v_dot2c_f32_bf16 v53, v43, v15
v_dot2c_f32_bf16 v54, v47, v15
v_dot2c_f32_bf16 v55, v51, v15
v_add_f32_dpp v33, v52, v52 row_ror:8 row_mask:0xf bank_mask:0x3
v_add_f32_dpp v34, v53, v53 row_ror:8 row_mask:0xf bank_mask:0x3
v_add_f32_dpp v33, v54, v54 row_ror:8 row_mask:0xf bank_mask:0xc
v_add_f32_dpp v34, v55, v55 row_ror:8 row_mask:0xf bank_mask:0xc
s_nop 0
v_add_f32_dpp v35, v33, v33 row_half_mirror row_mask:0xf bank_mask:0x5
v_add_f32_dpp v35, v34, v34 row_half_mirror row_mask:0xf bank_mask:0xa
v_cndmask_b32 v33, v35, v28, s[54:55]
v_cndmask_b32 v34, v28, v35, s[54:55]
s_nop 1
v_add_f32_dpp v28, v34, v33 quad_perm:[1,0,3,2] row_mask:0xf bank_mask:0xf
s_waitcnt vmcnt(7)
buffer_load_dwordx4 v0, s[4:7], s45 offen offset:1024 nt lds
v_and_b32_dpp v40, v26, v4 row_newbcast:8 row_mask:0xf bank_mask:0xf
v_and_b32_dpp v41, v26, v5 row_newbcast:8 row_mask:0xf bank_mask:0xf
v_and_b32_dpp v42, v26, v6 row_newbcast:8 row_mask:0xf bank_mask:0xf
v_and_b32_dpp v43, v26, v7 row_newbcast:8 row_mask:0xf bank_mask:0xf
s_nop 1
v_mfma_f32_16x16x32_bf16 v[16:19], v[40:43], a[116:119], v[16:19]
ds_read_b128 v[36:39], v1 offset:29696
ds_read_b128 v[40:43], v1 offset:30720
ds_read_b128 v[44:47], v1 offset:31744
ds_read_b128 v[48:51], v1 offset:32768
s_waitcnt lgkmcnt(0)
v_dot2_f32_bf16 v52, v36, v12, 0
v_dot2_f32_bf16 v53, v40, v12, 0
v_dot2_f32_bf16 v54, v44, v12, 0
v_dot2_f32_bf16 v55, v48, v12, 0
v_dot2c_f32_bf16 v52, v37, v13
v_dot2c_f32_bf16 v53, v41, v13
v_dot2c_f32_bf16 v54, v45, v13
v_dot2c_f32_bf16 v55, v49, v13
v_dot2c_f32_bf16 v52, v38, v14
v_dot2c_f32_bf16 v53, v42, v14
v_dot2c_f32_bf16 v54, v46, v14
v_dot2c_f32_bf16 v55, v50, v14
v_dot2c_f32_bf16 v52, v39, v15
v_dot2c_f32_bf16 v53, v43, v15
v_dot2c_f32_bf16 v54, v47, v15
v_dot2c_f32_bf16 v55, v51, v15
v_add_f32_dpp v33, v52, v52 row_ror:8 row_mask:0xf bank_mask:0x3
v_add_f32_dpp v34, v53, v53 row_ror:8 row_mask:0xf bank_mask:0x3
v_add_f32_dpp v33, v54, v54 row_ror:8 row_mask:0xf bank_mask:0xc
v_add_f32_dpp v34, v55, v55 row_ror:8 row_mask:0xf bank_mask:0xc
s_nop 0
v_add_f32_dpp v31, v33, v33 row_half_mirror row_mask:0xf bank_mask:0x5
v_add_f32_dpp v31, v34, v34 row_half_mirror row_mask:0xf bank_mask:0xa
s_waitcnt vmcnt(7)
buffer_load_dwordx4 v0, s[4:7], s45 offen offset:2048 nt lds
v_and_b32_dpp v44, v26, v4 row_newbcast:12 row_mask:0xf bank_mask:0xf
v_and_b32_dpp v45, v26, v5 row_newbcast:12 row_mask:0xf bank_mask:0xf
v_and_b32_dpp v46, v26, v6 row_newbcast:12 row_mask:0xf bank_mask:0xf
v_and_b32_dpp v47, v26, v7 row_newbcast:12 row_mask:0xf bank_mask:0xf
s_nop 1
v_mfma_f32_16x16x32_bf16 v[16:19], v[44:47], a[120:123], v[16:19]
s_waitcnt vmcnt(7)
buffer_load_dwordx4 v0, s[4:7], s45 offen offset:3072 nt lds
s_add_u32 s45, s45, 16384
v_and_b32_dpp v48, v26, v4 row_newbcast:1 row_mask:0xf bank_mask:0xf
v_and_b32_dpp v49, v26, v5 row_newbcast:1 row_mask:0xf bank_mask:0xf
v_and_b32_dpp v50, v26, v6 row_newbcast:1 row_mask:0xf bank_mask:0xf
v_and_b32_dpp v51, v26, v7 row_newbcast:1 row_mask:0xf bank_mask:0xf
s_nop 1
v_mfma_f32_16x16x32_bf16 v[16:19], v[48:51], a[124:127], v[16:19]
v_add_u32 v33, s68, v0
s_nop 6
v_writelane_b32 v16, s60, 32
v_writelane_b32 v17, s61, 32
s_mov_b32 exec_lo, 0xffffffff
s_mov_b32 exec_hi, 0x1
ds_write_b128 v33, v[16:19] offset:0
s_mov_b64 exec, -1
s_add_u32 m0, s47, 29696
s_nop 0
buffer_load_dwordx4 v0, s[4:7], s45 offen offset:0 nt lds
buffer_load_dwordx4 v0, s[4:7], s45 offen offset:1024 nt lds
v_mov_b32 v34, s85
v_add_u32 v33, s85, v0
s_bitcmp0_b32 s40, 1
s_waitcnt lgkmcnt(0)
s_barrier
s_cbranch_scc0 Lp29
ds_read_b64 v[52:53], v34 offset:512
ds_read_b64 v[54:55], v34 offset:1040
ds_read_b64 v[16:17], v34 offset:1568
ds_read_b64 v[18:19], v34 offset:2096
s_mov_b32 exec_lo, 0xffffffff
s_mov_b32 exec_hi, 0x0
ds_read_b128 v[36:39], v33 offset:0
ds_read_b128 v[40:43], v33 offset:528
ds_read_b128 v[44:47], v33 offset:1056
ds_read_b128 v[48:51], v33 offset:1584
s_mov_b64 exec, -1
s_waitcnt lgkmcnt(4)
v_max3_f32 v33, v52, v54, v16
v_max_f32 v33, v33, v18
v_sub_f32 v52, v52, v33
v_sub_f32 v54, v54, v33
v_sub_f32 v16, v16, v33
v_sub_f32 v18, v18, v33
v_exp_f32 v52, v52
v_exp_f32 v54, v54
v_exp_f32 v16, v16
v_exp_f32 v18, v18
v_mul_f32 v35, v52, v53
v_fmac_f32 v35, v54, v55
v_fmac_f32 v35, v16, v17
v_fmac_f32 v35, v18, v19
s_waitcnt lgkmcnt(0)
v_mul_f32 v36, v52, v36
v_mul_f32 v37, v52, v37
v_mul_f32 v38, v52, v38
v_mul_f32 v39, v52, v39
v_fmac_f32 v36, v54, v40
v_fmac_f32 v37, v54, v41
v_fmac_f32 v38, v54, v42
v_fmac_f32 v39, v54, v43
v_fmac_f32 v36, v16, v44
v_fmac_f32 v37, v16, v45
v_fmac_f32 v38, v16, v46
v_fmac_f32 v39, v16, v47
v_fmac_f32 v36, v18, v48
v_fmac_f32 v37, v18, v49
v_fmac_f32 v38, v18, v50
v_fmac_f32 v39, v18, v51
v_cvt_pk_bf16_f32 v36, v36, v37
v_cvt_pk_bf16_f32 v37, v38, v39
s_mov_b32 exec_lo, 0x0
s_mov_b32 exec_hi, 0xff
v_mov_b32 v36, v33
v_or_b32 v37, s83, v35
s_mov_b32 exec_lo, -1
v_and_or_b32 v36, v36, -2, s89
v_and_or_b32 v37, v37, -2, s89
s_cmp_lg_u32 s83, 0
s_cbranch_scc1 Lp30
buffer_store_dwordx2 v[36:37], v32, s[12:15], s52 offen
s_branch Lp31
Lp30:
buffer_store_dwordx2 v[36:37], v32, s[12:15], s52 offen sc1
Lp31:
s_mov_b64 exec, -1
Lp29:
s_xor_b32 s52, s52, 640
s_waitcnt vmcnt(9)
s_waitcnt vmcnt(8)
s_waitcnt vmcnt(7)
buffer_load_dwordx4 v0, s[4:7], s45 offen offset:2048 nt lds
ds_read_b128 v[36:39], v1 offset:33792
ds_read_b128 v[40:43], v1 offset:34816
ds_read_b128 v[44:47], v1 offset:35840
ds_read_b128 v[48:51], v1 offset:36864
s_waitcnt lgkmcnt(0)
v_dot2_f32_bf16 v52, v36, v12, 0
v_dot2_f32_bf16 v53, v40, v12, 0
v_dot2_f32_bf16 v54, v44, v12, 0
v_dot2_f32_bf16 v55, v48, v12, 0
v_dot2c_f32_bf16 v52, v37, v13
v_dot2c_f32_bf16 v53, v41, v13
v_dot2c_f32_bf16 v54, v45, v13
v_dot2c_f32_bf16 v55, v49, v13
v_dot2c_f32_bf16 v52, v38, v14
v_dot2c_f32_bf16 v53, v42, v14
v_dot2c_f32_bf16 v54, v46, v14
v_dot2c_f32_bf16 v55, v50, v14
v_dot2c_f32_bf16 v52, v39, v15
v_dot2c_f32_bf16 v53, v43, v15
v_dot2c_f32_bf16 v54, v47, v15
v_dot2c_f32_bf16 v55, v51, v15
v_add_f32_dpp v33, v52, v52 row_ror:8 row_mask:0xf bank_mask:0x3
v_add_f32_dpp v34, v53, v53 row_ror:8 row_mask:0xf bank_mask:0x3
v_add_f32_dpp v33, v54, v54 row_ror:8 row_mask:0xf bank_mask:0xc
v_add_f32_dpp v34, v55, v55 row_ror:8 row_mask:0xf bank_mask:0xc
s_nop 0
v_add_f32_dpp v35, v33, v33 row_half_mirror row_mask:0xf bank_mask:0x5
v_add_f32_dpp v35, v34, v34 row_half_mirror row_mask:0xf bank_mask:0xa
v_cndmask_b32 v33, v31, v35, s[54:55]
v_cndmask_b32 v34, v35, v31, s[54:55]
s_nop 1
v_add_f32_dpp v31, v34, v33 quad_perm:[1,0,3,2] row_mask:0xf bank_mask:0xf
v_cndmask_b32 v33, v28, v31, s[56:57]
v_cndmask_b32 v34, v31, v28, s[56:57]
s_nop 1
v_add_f32_dpp v28, v34, v33 quad_perm:[2,3,0,1] row_mask:0xf bank_mask:0xf
s_waitcnt vmcnt(7)
buffer_load_dwordx4 v0, s[4:7], s45 offen offset:3072 nt lds
s_add_u32 s45, s45, 16384
v_add_u32 v33, s48, v1
ds_read_b128 v[36:39], v33 offset:0
ds_read_b128 v[40:43], v33 offset:1024
ds_read_b128 v[44:47], v33 offset:2048
ds_read_b128 v[48:51], v33 offset:3072
s_waitcnt lgkmcnt(0)
v_dot2_f32_bf16 v52, v36, v8, 0
v_dot2_f32_bf16 v53, v40, v8, 0
v_dot2_f32_bf16 v54, v44, v8, 0
v_dot2_f32_bf16 v55, v48, v8, 0
v_dot2c_f32_bf16 v52, v37, v9
v_dot2c_f32_bf16 v53, v41, v9
v_dot2c_f32_bf16 v54, v45, v9
v_dot2c_f32_bf16 v55, v49, v9
v_dot2c_f32_bf16 v52, v38, v10
v_dot2c_f32_bf16 v53, v42, v10
v_dot2c_f32_bf16 v54, v46, v10
v_dot2c_f32_bf16 v55, v50, v10
v_dot2c_f32_bf16 v52, v39, v11
v_dot2c_f32_bf16 v53, v43, v11
v_dot2c_f32_bf16 v54, v47, v11
v_dot2c_f32_bf16 v55, v51, v11
v_add_f32_dpp v33, v52, v52 row_ror:8 row_mask:0xf bank_mask:0x3
v_add_f32_dpp v34, v53, v53 row_ror:8 row_mask:0xf bank_mask:0x3
v_add_f32_dpp v33, v54, v54 row_ror:8 row_mask:0xf bank_mask:0xc
v_add_f32_dpp v34, v55, v55 row_ror:8 row_mask:0xf bank_mask:0xc
s_nop 0
v_add_f32_dpp v24, v33, v33 row_half_mirror row_mask:0xf bank_mask:0x5
v_add_f32_dpp v24, v34, v34 row_half_mirror row_mask:0xf bank_mask:0xa
s_waitcnt vmcnt(7)
s_add_u32 m0, s47, 33792
s_nop 0
buffer_load_dwordx4 v0, s[4:7], s45 offen offset:0 nt lds
s_waitcnt vmcnt(7)
buffer_load_dwordx4 v0, s[4:7], s45 offen offset:1024 nt lds
s_waitcnt vmcnt(7)
buffer_load_dwordx4 v0, s[4:7], s45 offen offset:2048 nt lds
v_dot2_f32_bf16 v52, v156, v12, 0
v_dot2_f32_bf16 v53, v160, v12, 0
v_dot2_f32_bf16 v54, v164, v12, 0
v_dot2_f32_bf16 v55, v168, v12, 0
v_dot2c_f32_bf16 v52, v157, v13
v_dot2c_f32_bf16 v53, v161, v13
v_dot2c_f32_bf16 v54, v165, v13
v_dot2c_f32_bf16 v55, v169, v13
v_dot2c_f32_bf16 v52, v158, v14
v_dot2c_f32_bf16 v53, v162, v14
v_dot2c_f32_bf16 v54, v166, v14
v_dot2c_f32_bf16 v55, v170, v14
v_dot2c_f32_bf16 v52, v159, v15
v_dot2c_f32_bf16 v53, v163, v15
v_dot2c_f32_bf16 v54, v167, v15
v_dot2c_f32_bf16 v55, v171, v15
v_add_f32_dpp v33, v52, v52 row_ror:8 row_mask:0xf bank_mask:0x3
v_add_f32_dpp v34, v53, v53 row_ror:8 row_mask:0xf bank_mask:0x3
v_add_f32_dpp v33, v54, v54 row_ror:8 row_mask:0xf bank_mask:0xc
v_add_f32_dpp v34, v55, v55 row_ror:8 row_mask:0xf bank_mask:0xc
s_nop 0
v_add_f32_dpp v29, v33, v33 row_half_mirror row_mask:0xf bank_mask:0x5
v_add_f32_dpp v29, v34, v34 row_half_mirror row_mask:0xf bank_mask:0xa
s_waitcnt vmcnt(7)
buffer_load_dwordx4 v0, s[4:7], s45 offen offset:3072 nt lds
s_add_u32 s45, s45, 16384
ds_read_b128 v[36:39], v1 offset:25600
ds_read_b128 v[40:43], v1 offset:26624
ds_read_b128 v[44:47], v1 offset:27648
ds_read_b128 v[48:51], v1 offset:28672
s_waitcnt lgkmcnt(0)
v_dot2_f32_bf16 v52, v36, v8, 0
v_dot2_f32_bf16 v53, v40, v8, 0
v_dot2_f32_bf16 v54, v44, v8, 0
v_dot2_f32_bf16 v55, v48, v8, 0
v_dot2c_f32_bf16 v52, v37, v9
v_dot2c_f32_bf16 v53, v41, v9
v_dot2c_f32_bf16 v54, v45, v9
v_dot2c_f32_bf16 v55, v49, v9
v_dot2c_f32_bf16 v52, v38, v10
v_dot2c_f32_bf16 v53, v42, v10
v_dot2c_f32_bf16 v54, v46, v10
v_dot2c_f32_bf16 v55, v50, v10
v_dot2c_f32_bf16 v52, v39, v11
v_dot2c_f32_bf16 v53, v43, v11
v_dot2c_f32_bf16 v54, v47, v11
v_dot2c_f32_bf16 v55, v51, v11
v_add_f32_dpp v33, v52, v52 row_ror:8 row_mask:0xf bank_mask:0x3
v_add_f32_dpp v34, v53, v53 row_ror:8 row_mask:0xf bank_mask:0x3
v_add_f32_dpp v33, v54, v54 row_ror:8 row_mask:0xf bank_mask:0xc
v_add_f32_dpp v34, v55, v55 row_ror:8 row_mask:0xf bank_mask:0xc
s_nop 0
v_add_f32_dpp v35, v33, v33 row_half_mirror row_mask:0xf bank_mask:0x5
v_add_f32_dpp v35, v34, v34 row_half_mirror row_mask:0xf bank_mask:0xa
v_cndmask_b32 v33, v24, v35, s[54:55]
v_cndmask_b32 v34, v35, v24, s[54:55]
s_nop 1
v_add_f32_dpp v24, v34, v33 quad_perm:[1,0,3,2] row_mask:0xf bank_mask:0xf
s_waitcnt vmcnt(7)
s_barrier
buffer_load_dwordx4 v[156:159], v0, s[4:7], s45 offen offset:0 nt
s_waitcnt vmcnt(7)
buffer_load_dwordx4 v[160:163], v0, s[4:7], s45 offen offset:1024 nt
s_waitcnt vmcnt(7)
buffer_load_dwordx4 v[164:167], v0, s[4:7], s45 offen offset:2048 nt
v_dot2_f32_bf16 v52, v172, v12, 0
v_dot2_f32_bf16 v53, v176, v12, 0
v_dot2_f32_bf16 v54, v180, v12, 0
v_dot2_f32_bf16 v55, v184, v12, 0
v_dot2c_f32_bf16 v52, v173, v13
v_dot2c_f32_bf16 v53, v177, v13
v_dot2c_f32_bf16 v54, v181, v13
v_dot2c_f32_bf16 v55, v185, v13
v_dot2c_f32_bf16 v52, v174, v14
v_dot2c_f32_bf16 v53, v178, v14
v_dot2c_f32_bf16 v54, v182, v14
v_dot2c_f32_bf16 v55, v186, v14
v_dot2c_f32_bf16 v52, v175, v15
v_dot2c_f32_bf16 v53, v179, v15
v_dot2c_f32_bf16 v54, v183, v15
v_dot2c_f32_bf16 v55, v187, v15
v_add_f32_dpp v33, v52, v52 row_ror:8 row_mask:0xf bank_mask:0x3
v_add_f32_dpp v34, v53, v53 row_ror:8 row_mask:0xf bank_mask:0x3
v_add_f32_dpp v33, v54, v54 row_ror:8 row_mask:0xf bank_mask:0xc
v_add_f32_dpp v34, v55, v55 row_ror:8 row_mask:0xf bank_mask:0xc
s_nop 0
v_add_f32_dpp v35, v33, v33 row_half_mirror row_mask:0xf bank_mask:0x5
v_add_f32_dpp v35, v34, v34 row_half_mirror row_mask:0xf bank_mask:0xa
v_cndmask_b32 v33, v29, v35, s[54:55]
v_cndmask_b32 v34, v35, v29, s[54:55]
s_nop 1
v_add_f32_dpp v29, v34, v33 quad_perm:[1,0,3,2] row_mask:0xf bank_mask:0xf
s_waitcnt vmcnt(7)
buffer_load_dwordx4 v[168:171], v0, s[4:7], s45 offen offset:3072 nt
s_add_u32 s45, s45, 16384
ds_read_b128 v[36:39], v1 offset:29696
ds_read_b128 v[40:43], v1 offset:30720
ds_read_b128 v[44:47], v1 offset:31744
ds_read_b128 v[48:51], v1 offset:32768
s_waitcnt lgkmcnt(0)
v_dot2_f32_bf16 v52, v36, v8, 0
v_dot2_f32_bf16 v53, v40, v8, 0
v_dot2_f32_bf16 v54, v44, v8, 0
v_dot2_f32_bf16 v55, v48, v8, 0
v_dot2c_f32_bf16 v52, v37, v9
v_dot2c_f32_bf16 v53, v41, v9
v_dot2c_f32_bf16 v54, v45, v9
v_dot2c_f32_bf16 v55, v49, v9
v_dot2c_f32_bf16 v52, v38, v10
v_dot2c_f32_bf16 v53, v42, v10
v_dot2c_f32_bf16 v54, v46, v10
v_dot2c_f32_bf16 v55, v50, v10
v_dot2c_f32_bf16 v52, v39, v11
v_dot2c_f32_bf16 v53, v43, v11
v_dot2c_f32_bf16 v54, v47, v11
v_dot2c_f32_bf16 v55, v51, v11
v_add_f32_dpp v33, v52, v52 row_ror:8 row_mask:0xf bank_mask:0x3
v_add_f32_dpp v34, v53, v53 row_ror:8 row_mask:0xf bank_mask:0x3
v_add_f32_dpp v33, v54, v54 row_ror:8 row_mask:0xf bank_mask:0xc
v_add_f32_dpp v34, v55, v55 row_ror:8 row_mask:0xf bank_mask:0xc
s_nop 0
v_add_f32_dpp v27, v33, v33 row_half_mirror row_mask:0xf bank_mask:0x5
v_add_f32_dpp v27, v34, v34 row_half_mirror row_mask:0xf bank_mask:0xa
s_waitcnt vmcnt(7)
buffer_load_dwordx4 v[172:175], v0, s[4:7], s45 offen offset:0 nt
s_waitcnt vmcnt(7)
buffer_load_dwordx4 v[176:179], v0, s[4:7], s45 offen offset:1024 nt
s_waitcnt vmcnt(7)
buffer_load_dwordx4 v[180:183], v0, s[4:7], s45 offen offset:2048 nt
v_dot2_f32_bf16 v52, v188, v12, 0
v_dot2_f32_bf16 v53, v192, v12, 0
v_dot2_f32_bf16 v54, v196, v12, 0
v_dot2_f32_bf16 v55, v200, v12, 0
v_dot2c_f32_bf16 v52, v189, v13
v_dot2c_f32_bf16 v53, v193, v13
v_dot2c_f32_bf16 v54, v197, v13
v_dot2c_f32_bf16 v55, v201, v13
v_dot2c_f32_bf16 v52, v190, v14
v_dot2c_f32_bf16 v53, v194, v14
v_dot2c_f32_bf16 v54, v198, v14
v_dot2c_f32_bf16 v55, v202, v14
v_dot2c_f32_bf16 v52, v191, v15
v_dot2c_f32_bf16 v53, v195, v15
v_dot2c_f32_bf16 v54, v199, v15
v_dot2c_f32_bf16 v55, v203, v15
v_add_f32_dpp v33, v52, v52 row_ror:8 row_mask:0xf bank_mask:0x3
v_add_f32_dpp v34, v53, v53 row_ror:8 row_mask:0xf bank_mask:0x3
v_add_f32_dpp v33, v54, v54 row_ror:8 row_mask:0xf bank_mask:0xc
v_add_f32_dpp v34, v55, v55 row_ror:8 row_mask:0xf bank_mask:0xc
s_nop 0
v_add_f32_dpp v31, v33, v33 row_half_mirror row_mask:0xf bank_mask:0x5
v_add_f32_dpp v31, v34, v34 row_half_mirror row_mask:0xf bank_mask:0xa
s_waitcnt vmcnt(7)
buffer_load_dwordx4 v[184:187], v0, s[4:7], s45 offen offset:3072 nt
s_add_u32 s45, s45, 16384
ds_read_b128 v[36:39], v1 offset:33792
ds_read_b128 v[40:43], v1 offset:34816
ds_read_b128 v[44:47], v1 offset:35840
ds_read_b128 v[48:51], v1 offset:36864
s_waitcnt lgkmcnt(0)
v_dot2_f32_bf16 v52, v36, v8, 0
v_dot2_f32_bf16 v53, v40, v8, 0
v_dot2_f32_bf16 v54, v44, v8, 0
v_dot2_f32_bf16 v55, v48, v8, 0
v_dot2c_f32_bf16 v52, v37, v9
v_dot2c_f32_bf16 v53, v41, v9
v_dot2c_f32_bf16 v54, v45, v9
v_dot2c_f32_bf16 v55, v49, v9
v_dot2c_f32_bf16 v52, v38, v10
v_dot2c_f32_bf16 v53, v42, v10
v_dot2c_f32_bf16 v54, v46, v10
v_dot2c_f32_bf16 v55, v50, v10
v_dot2c_f32_bf16 v52, v39, v11
v_dot2c_f32_bf16 v53, v43, v11
v_dot2c_f32_bf16 v54, v47, v11
v_dot2c_f32_bf16 v55, v51, v11
v_add_f32_dpp v33, v52, v52 row_ror:8 row_mask:0xf bank_mask:0x3
v_add_f32_dpp v34, v53, v53 row_ror:8 row_mask:0xf bank_mask:0x3
v_add_f32_dpp v33, v54, v54 row_ror:8 row_mask:0xf bank_mask:0xc
v_add_f32_dpp v34, v55, v55 row_ror:8 row_mask:0xf bank_mask:0xc
s_nop 0
v_add_f32_dpp v35, v33, v33 row_half_mirror row_mask:0xf bank_mask:0x5
v_add_f32_dpp v35, v34, v34 row_half_mirror row_mask:0xf bank_mask:0xa
v_cndmask_b32 v33, v27, v35, s[54:55]
v_cndmask_b32 v34, v35, v27, s[54:55]
s_nop 1
v_add_f32_dpp v27, v34, v33 quad_perm:[1,0,3,2] row_mask:0xf bank_mask:0xf
v_cndmask_b32 v33, v24, v27, s[56:57]
v_cndmask_b32 v34, v27, v24, s[56:57]
s_nop 1
v_add_f32_dpp v24, v34, v33 quad_perm:[2,3,0,1] row_mask:0xf bank_mask:0xf
s_waitcnt vmcnt(7)
s_barrier
buffer_load_dwordx4 v[188:191], v0, s[4:7], s45 offen offset:0 nt
s_waitcnt vmcnt(7)
buffer_load_dwordx4 v[192:195], v0, s[4:7], s45 offen offset:1024 nt
s_waitcnt vmcnt(7)
buffer_load_dwordx4 v[196:199], v0, s[4:7], s45 offen offset:2048 nt
v_dot2_f32_bf16 v52, v204, v12, 0
v_dot2_f32_bf16 v53, v208, v12, 0
v_dot2_f32_bf16 v54, v212, v12, 0
v_dot2_f32_bf16 v55, v216, v12, 0
v_dot2c_f32_bf16 v52, v205, v13
v_dot2c_f32_bf16 v53, v209, v13
v_dot2c_f32_bf16 v54, v213, v13
v_dot2c_f32_bf16 v55, v217, v13
v_dot2c_f32_bf16 v52, v206, v14
v_dot2c_f32_bf16 v53, v210, v14
v_dot2c_f32_bf16 v54, v214, v14
v_dot2c_f32_bf16 v55, v218, v14
v_dot2c_f32_bf16 v52, v207, v15
v_dot2c_f32_bf16 v53, v211, v15
v_dot2c_f32_bf16 v54, v215, v15
v_dot2c_f32_bf16 v55, v219, v15
v_add_f32_dpp v33, v52, v52 row_ror:8 row_mask:0xf bank_mask:0x3
v_add_f32_dpp v34, v53, v53 row_ror:8 row_mask:0xf bank_mask:0x3
v_add_f32_dpp v33, v54, v54 row_ror:8 row_mask:0xf bank_mask:0xc
v_add_f32_dpp v34, v55, v55 row_ror:8 row_mask:0xf bank_mask:0xc
s_nop 0
v_add_f32_dpp v35, v33, v33 row_half_mirror row_mask:0xf bank_mask:0x5
v_add_f32_dpp v35, v34, v34 row_half_mirror row_mask:0xf bank_mask:0xa
v_cndmask_b32 v33, v31, v35, s[54:55]
v_cndmask_b32 v34, v35, v31, s[54:55]
s_nop 1
v_add_f32_dpp v31, v34, v33 quad_perm:[1,0,3,2] row_mask:0xf bank_mask:0xf
v_cndmask_b32 v33, v29, v31, s[56:57]
v_cndmask_b32 v34, v31, v29, s[56:57]
s_nop 1
v_add_f32_dpp v29, v34, v33 quad_perm:[2,3,0,1] row_mask:0xf bank_mask:0xf
s_waitcnt vmcnt(7)
buffer_load_dwordx4 v[200:203], v0, s[4:7], s45 offen offset:3072 nt
s_add_u32 s45, s45, 16384
v_dot2_f32_bf16 v52, v156, v8, 0
v_dot2_f32_bf16 v53, v160, v8, 0
v_dot2_f32_bf16 v54, v164, v8, 0
v_dot2_f32_bf16 v55, v168, v8, 0
v_dot2c_f32_bf16 v52, v157, v9
v_dot2c_f32_bf16 v53, v161, v9
v_dot2c_f32_bf16 v54, v165, v9
v_dot2c_f32_bf16 v55, v169, v9
v_dot2c_f32_bf16 v52, v158, v10
v_dot2c_f32_bf16 v53, v162, v10
v_dot2c_f32_bf16 v54, v166, v10
v_dot2c_f32_bf16 v55, v170, v10
v_dot2c_f32_bf16 v52, v159, v11
v_dot2c_f32_bf16 v53, v163, v11
v_dot2c_f32_bf16 v54, v167, v11
v_dot2c_f32_bf16 v55, v171, v11
v_add_f32_dpp v33, v52, v52 row_ror:8 row_mask:0xf bank_mask:0x3
v_add_f32_dpp v34, v53, v53 row_ror:8 row_mask:0xf bank_mask:0x3
v_add_f32_dpp v33, v54, v54 row_ror:8 row_mask:0xf bank_mask:0xc
v_add_f32_dpp v34, v55, v55 row_ror:8 row_mask:0xf bank_mask:0xc
s_nop 0
v_add_f32_dpp v25, v33, v33 row_half_mirror row_mask:0xf bank_mask:0x5
v_add_f32_dpp v25, v34, v34 row_half_mirror row_mask:0xf bank_mask:0xa
s_waitcnt vmcnt(7)
buffer_load_dwordx4 v[204:207], v0, s[4:7], s45 offen offset:0 nt
s_waitcnt vmcnt(7)
buffer_load_dwordx4 v[208:211], v0, s[4:7], s45 offen offset:1024 nt
s_waitcnt vmcnt(7)
buffer_load_dwordx4 v[212:215], v0, s[4:7], s45 offen offset:2048 nt
v_dot2_f32_bf16 v52, v220, v12, 0
v_dot2_f32_bf16 v53, v224, v12, 0
v_dot2_f32_bf16 v54, v228, v12, 0
v_dot2_f32_bf16 v55, v232, v12, 0
v_dot2c_f32_bf16 v52, v221, v13
v_dot2c_f32_bf16 v53, v225, v13
v_dot2c_f32_bf16 v54, v229, v13
v_dot2c_f32_bf16 v55, v233, v13
v_dot2c_f32_bf16 v52, v222, v14
v_dot2c_f32_bf16 v53, v226, v14
v_dot2c_f32_bf16 v54, v230, v14
v_dot2c_f32_bf16 v55, v234, v14
v_dot2c_f32_bf16 v52, v223, v15
v_dot2c_f32_bf16 v53, v227, v15
v_dot2c_f32_bf16 v54, v231, v15
v_dot2c_f32_bf16 v55, v235, v15
v_add_f32_dpp v33, v52, v52 row_ror:8 row_mask:0xf bank_mask:0x3
v_add_f32_dpp v34, v53, v53 row_ror:8 row_mask:0xf bank_mask:0x3
v_add_f32_dpp v33, v54, v54 row_ror:8 row_mask:0xf bank_mask:0xc
v_add_f32_dpp v34, v55, v55 row_ror:8 row_mask:0xf bank_mask:0xc
s_nop 0
v_add_f32_dpp v30, v33, v33 row_half_mirror row_mask:0xf bank_mask:0x5
v_add_f32_dpp v30, v34, v34 row_half_mirror row_mask:0xf bank_mask:0xa
s_waitcnt vmcnt(7)
buffer_load_dwordx4 v[216:219], v0, s[4:7], s45 offen offset:3072 nt
s_add_u32 s45, s45, 16384
v_dot2_f32_bf16 v52, v172, v8, 0
v_dot2_f32_bf16 v53, v176, v8, 0
v_dot2_f32_bf16 v54, v180, v8, 0
v_dot2_f32_bf16 v55, v184, v8, 0
v_dot2c_f32_bf16 v52, v173, v9
v_dot2c_f32_bf16 v53, v177, v9
v_dot2c_f32_bf16 v54, v181, v9
v_dot2c_f32_bf16 v55, v185, v9
v_dot2c_f32_bf16 v52, v174, v10
v_dot2c_f32_bf16 v53, v178, v10
v_dot2c_f32_bf16 v54, v182, v10
v_dot2c_f32_bf16 v55, v186, v10
v_dot2c_f32_bf16 v52, v175, v11
v_dot2c_f32_bf16 v53, v179, v11
v_dot2c_f32_bf16 v54, v183, v11
v_dot2c_f32_bf16 v55, v187, v11
v_add_f32_dpp v33, v52, v52 row_ror:8 row_mask:0xf bank_mask:0x3
v_add_f32_dpp v34, v53, v53 row_ror:8 row_mask:0xf bank_mask:0x3
v_add_f32_dpp v33, v54, v54 row_ror:8 row_mask:0xf bank_mask:0xc
v_add_f32_dpp v34, v55, v55 row_ror:8 row_mask:0xf bank_mask:0xc
s_nop 0
v_add_f32_dpp v35, v33, v33 row_half_mirror row_mask:0xf bank_mask:0x5
v_add_f32_dpp v35, v34, v34 row_half_mirror row_mask:0xf bank_mask:0xa
v_cndmask_b32 v33, v25, v35, s[54:55]
v_cndmask_b32 v34, v35, v25, s[54:55]
s_nop 1
v_add_f32_dpp v25, v34, v33 quad_perm:[1,0,3,2] row_mask:0xf bank_mask:0xf
s_waitcnt vmcnt(7)
s_barrier
buffer_load_dwordx4 v[220:223], v0, s[4:7], s45 offen offset:0 nt
ds_read_b128 v[36:39], v1 offset:37888
s_waitcnt lgkmcnt(0)
v_dot2_f32_bf16 v52, v36, v12, 0
v_dot2_f32_bf16 v52, v37, v13, v52
v_dot2_f32_bf16 v52, v38, v14, v52
v_dot2_f32_bf16 v52, v39, v15, v52
s_nop 2
v_add_f32_dpp v33, v52, v52 row_ror:8 row_mask:0xf bank_mask:0xf
s_nop 1
v_add_f32_dpp v35, v33, v33 row_half_mirror row_mask:0xf bank_mask:0xf
v_cndmask_b32 v33, v30, v35, s[54:55]
v_cndmask_b32 v34, v35, v30, s[54:55]
s_nop 1
v_add_f32_dpp v30, v34, v33 quad_perm:[1,0,3,2] row_mask:0xf bank_mask:0xf
s_nop 1
v_add_f32_dpp v30, v30, v30 quad_perm:[2,3,0,1] row_mask:0xf bank_mask:0xf
s_waitcnt vmcnt(7)
buffer_load_dwordx4 v[224:227], v0, s[4:7], s45 offen offset:1024 nt
v_mul_f32 v28, 0x3e0293ee, v28
v_mul_f32 v29, 0x3e0293ee, v29
v_mul_f32 v30, 0x3e0293ee, v30
v_mov_b32 v34, 0xff800000
v_cndmask_b32 v30, v34, v30, s[58:59]
v_max3_f32 v33, v28, v29, v30
s_nop 1
v_max_f32_dpp v33, v33, v33 quad_perm:[1,0,3,2] row_mask:0xf bank_mask:0xf
s_nop 1
v_max_f32_dpp v33, v33, v33 quad_perm:[2,3,0,1] row_mask:0xf bank_mask:0xf
s_nop 1
v_max_f32_dpp v33, v33, v33 row_ror:4 row_mask:0xf bank_mask:0xf
s_nop 1
v_max_f32_dpp v33, v33, v33 row_ror:8 row_mask:0xf bank_mask:0xf
s_nop 1
v_max_f32_dpp v33, v33, v33 row_bcast:15 row_mask:0xa bank_mask:0xf
s_nop 1
v_max_f32_dpp v33, v33, v33 row_bcast:31 row_mask:0xc bank_mask:0xf
s_nop 0
v_readlane_b32 s62, v33, 63
s_nop 1
v_subrev_f32 v28, s62, v28
v_subrev_f32 v29, s62, v29
v_subrev_f32 v30, s62, v30
v_exp_f32 v28, v28
v_exp_f32 v29, v29
v_exp_f32 v30, v30
v_add_f32 v33, v28, v29
v_add_f32 v33, v33, v30
v_cvt_pk_bf16_f32 v28, v28, v28
v_cvt_pk_bf16_f32 v29, v29, v29
v_cvt_pk_bf16_f32 v30, v30, v30
v_add_f32_dpp v33, v33, v33 quad_perm:[1,0,3,2] row_mask:0xf bank_mask:0xf
s_nop 1
v_add_f32_dpp v33, v33, v33 quad_perm:[2,3,0,1] row_mask:0xf bank_mask:0xf
s_nop 1
v_add_f32_dpp v33, v33, v33 row_ror:4 row_mask:0xf bank_mask:0xf
s_nop 1
v_add_f32_dpp v33, v33, v33 row_ror:8 row_mask:0xf bank_mask:0xf
s_nop 1
v_add_f32_dpp v33, v33, v33 row_bcast:15 row_mask:0xa bank_mask:0xf
s_nop 1
v_add_f32_dpp v33, v33, v33 row_bcast:31 row_mask:0xc bank_mask:0xf
s_nop 0
v_readlane_b32 s63, v33, 63
s_waitcnt vmcnt(7)
buffer_load_dwordx4 v[228:231], v0, s[4:7], s45 offen offset:2048 nt
s_waitcnt vmcnt(7)
buffer_load_dwordx4 v[232:235], v0, s[4:7], s45 offen offset:3072 nt
s_add_u32 s45, s45, 16384
v_dot2_f32_bf16 v52, v188, v8, 0
v_dot2_f32_bf16 v53, v192, v8, 0
v_dot2_f32_bf16 v54, v196, v8, 0
v_dot2_f32_bf16 v55, v200, v8, 0
v_dot2c_f32_bf16 v52, v189, v9
v_dot2c_f32_bf16 v53, v193, v9
v_dot2c_f32_bf16 v54, v197, v9
v_dot2c_f32_bf16 v55, v201, v9
v_dot2c_f32_bf16 v52, v190, v10
v_dot2c_f32_bf16 v53, v194, v10
v_dot2c_f32_bf16 v54, v198, v10
v_dot2c_f32_bf16 v55, v202, v10
v_dot2c_f32_bf16 v52, v191, v11
v_dot2c_f32_bf16 v53, v195, v11
v_dot2c_f32_bf16 v54, v199, v11
v_dot2c_f32_bf16 v55, v203, v11
v_add_f32_dpp v33, v52, v52 row_ror:8 row_mask:0xf bank_mask:0x3
v_add_f32_dpp v34, v53, v53 row_ror:8 row_mask:0xf bank_mask:0x3
v_add_f32_dpp v33, v54, v54 row_ror:8 row_mask:0xf bank_mask:0xc
v_add_f32_dpp v34, v55, v55 row_ror:8 row_mask:0xf bank_mask:0xc
s_nop 0
v_add_f32_dpp v27, v33, v33 row_half_mirror row_mask:0xf bank_mask:0x5
v_add_f32_dpp v27, v34, v34 row_half_mirror row_mask:0xf bank_mask:0xa
v_and_b32_dpp v36, v28, v4 row_newbcast:0 row_mask:0xf bank_mask:0xf
v_and_b32_dpp v37, v28, v5 row_newbcast:0 row_mask:0xf bank_mask:0xf
v_and_b32_dpp v38, v28, v6 row_newbcast:0 row_mask:0xf bank_mask:0xf
v_and_b32_dpp v39, v28, v7 row_newbcast:0 row_mask:0xf bank_mask:0xf
s_nop 1
v_mfma_f32_16x16x32_bf16 v[20:23], v[36:39], v[236:239], 0
s_waitcnt vmcnt(7)
s_add_u32 m0, s47, 37888
s_nop 0
buffer_load_dwordx4 v2, s[4:7], s44 offen nt lds
s_add_u32 s45, s44, s46
v_and_b32_dpp v40, v28, v4 row_newbcast:4 row_mask:0xf bank_mask:0xf
v_and_b32_dpp v41, v28, v5 row_newbcast:4 row_mask:0xf bank_mask:0xf
v_and_b32_dpp v42, v28, v6 row_newbcast:4 row_mask:0xf bank_mask:0xf
v_and_b32_dpp v43, v28, v7 row_newbcast:4 row_mask:0xf bank_mask:0xf
s_nop 1
v_mfma_f32_16x16x32_bf16 v[20:23], v[40:43], v[240:243], v[20:23]
s_waitcnt vmcnt(7)
s_cmp_lt_u32 s86, 1
s_cbranch_scc1 1
s_waitcnt vmcnt(5)
s_barrier
buffer_load_dwordx4 v[236:239], v0, s[8:11], s45 offen offset:0 nt
v_and_b32_dpp v44, v28, v4 row_newbcast:8 row_mask:0xf bank_mask:0xf
v_and_b32_dpp v45, v28, v5 row_newbcast:8 row_mask:0xf bank_mask:0xf
v_and_b32_dpp v46, v28, v6 row_newbcast:8 row_mask:0xf bank_mask:0xf
v_and_b32_dpp v47, v28, v7 row_newbcast:8 row_mask:0xf bank_mask:0xf
s_nop 1
v_mfma_f32_16x16x32_bf16 v[20:23], v[44:47], v[244:247], v[20:23]
s_waitcnt vmcnt(7)
s_cmp_lt_u32 s86, 1
s_cbranch_scc1 1
s_waitcnt vmcnt(5)
buffer_load_dwordx4 v[240:243], v0, s[8:11], s45 offen offset:1024 nt
v_and_b32_dpp v48, v28, v4 row_newbcast:12 row_mask:0xf bank_mask:0xf
v_and_b32_dpp v49, v28, v5 row_newbcast:12 row_mask:0xf bank_mask:0xf
v_and_b32_dpp v50, v28, v6 row_newbcast:12 row_mask:0xf bank_mask:0xf
v_and_b32_dpp v51, v28, v7 row_newbcast:12 row_mask:0xf bank_mask:0xf
s_nop 1
v_mfma_f32_16x16x32_bf16 v[20:23], v[48:51], v[248:251], v[20:23]
s_waitcnt vmcnt(7)
s_cmp_lt_u32 s86, 1
s_cbranch_scc1 1
s_waitcnt vmcnt(5)
buffer_load_dwordx4 v[244:247], v0, s[8:11], s45 offen offset:2048 nt
v_dot2_f32_bf16 v52, v204, v8, 0
v_dot2_f32_bf16 v53, v208, v8, 0
v_dot2_f32_bf16 v54, v212, v8, 0
v_dot2_f32_bf16 v55, v216, v8, 0
v_dot2c_f32_bf16 v52, v205, v9
v_dot2c_f32_bf16 v53, v209, v9
v_dot2c_f32_bf16 v54, v213, v9
v_dot2c_f32_bf16 v55, v217, v9
v_dot2c_f32_bf16 v52, v206, v10
v_dot2c_f32_bf16 v53, v210, v10
v_dot2c_f32_bf16 v54, v214, v10
v_dot2c_f32_bf16 v55, v218, v10
v_dot2c_f32_bf16 v52, v207, v11
v_dot2c_f32_bf16 v53, v211, v11
v_dot2c_f32_bf16 v54, v215, v11
v_dot2c_f32_bf16 v55, v219, v11
v_add_f32_dpp v33, v52, v52 row_ror:8 row_mask:0xf bank_mask:0x3
v_add_f32_dpp v34, v53, v53 row_ror:8 row_mask:0xf bank_mask:0x3
v_add_f32_dpp v33, v54, v54 row_ror:8 row_mask:0xf bank_mask:0xc
v_add_f32_dpp v34, v55, v55 row_ror:8 row_mask:0xf bank_mask:0xc
s_nop 0
v_add_f32_dpp v35, v33, v33 row_half_mirror row_mask:0xf bank_mask:0x5
v_add_f32_dpp v35, v34, v34 row_half_mirror row_mask:0xf bank_mask:0xa
v_cndmask_b32 v33, v27, v35, s[54:55]
v_cndmask_b32 v34, v35, v27, s[54:55]
s_nop 1
v_add_f32_dpp v27, v34, v33 quad_perm:[1,0,3,2] row_mask:0xf bank_mask:0xf
v_cndmask_b32 v33, v25, v27, s[56:57]
v_cndmask_b32 v34, v27, v25, s[56:57]
s_nop 1
v_add_f32_dpp v25, v34, v33 quad_perm:[2,3,0,1] row_mask:0xf bank_mask:0xf
v_and_b32_dpp v36, v28, v4 row_newbcast:1 row_mask:0xf bank_mask:0xf
v_and_b32_dpp v37, v28, v5 row_newbcast:1 row_mask:0xf bank_mask:0xf
v_and_b32_dpp v38, v28, v6 row_newbcast:1 row_mask:0xf bank_mask:0xf
v_and_b32_dpp v39, v28, v7 row_newbcast:1 row_mask:0xf bank_mask:0xf
s_nop 1
v_mfma_f32_16x16x32_bf16 v[20:23], v[36:39], v[252:255], v[20:23]
s_waitcnt vmcnt(7)
s_cmp_lt_u32 s86, 1
s_cbranch_scc1 1
s_waitcnt vmcnt(5)
buffer_load_dwordx4 v[248:251], v0, s[8:11], s45 offen offset:3072 nt
s_add_u32 s45, s45, 16384
v_and_b32_dpp v40, v28, v4 row_newbcast:5 row_mask:0xf bank_mask:0xf
v_and_b32_dpp v41, v28, v5 row_newbcast:5 row_mask:0xf bank_mask:0xf
v_and_b32_dpp v42, v28, v6 row_newbcast:5 row_mask:0xf bank_mask:0xf
v_and_b32_dpp v43, v28, v7 row_newbcast:5 row_mask:0xf bank_mask:0xf
s_nop 1
v_mfma_f32_16x16x32_bf16 v[20:23], v[40:43], a[128:131], v[20:23]
s_waitcnt vmcnt(7)
s_cmp_lt_u32 s86, 1
s_cbranch_scc1 1
s_waitcnt vmcnt(5)
buffer_load_dwordx4 v[252:255], v0, s[8:11], s45 offen offset:0 nt
v_and_b32_dpp v44, v28, v4 row_newbcast:9 row_mask:0xf bank_mask:0xf
v_and_b32_dpp v45, v28, v5 row_newbcast:9 row_mask:0xf bank_mask:0xf
v_and_b32_dpp v46, v28, v6 row_newbcast:9 row_mask:0xf bank_mask:0xf
v_and_b32_dpp v47, v28, v7 row_newbcast:9 row_mask:0xf bank_mask:0xf
s_nop 1
v_mfma_f32_16x16x32_bf16 v[20:23], v[44:47], a[132:135], v[20:23]
s_waitcnt vmcnt(7)
s_cmp_lt_u32 s86, 1
s_cbranch_scc1 1
s_waitcnt vmcnt(5)
buffer_load_dwordx4 a[128:131], v0, s[8:11], s45 offen offset:1024 nt
v_and_b32_dpp v48, v28, v4 row_newbcast:13 row_mask:0xf bank_mask:0xf
v_and_b32_dpp v49, v28, v5 row_newbcast:13 row_mask:0xf bank_mask:0xf
v_and_b32_dpp v50, v28, v6 row_newbcast:13 row_mask:0xf bank_mask:0xf
v_and_b32_dpp v51, v28, v7 row_newbcast:13 row_mask:0xf bank_mask:0xf
s_nop 1
v_mfma_f32_16x16x32_bf16 v[20:23], v[48:51], a[136:139], v[20:23]
s_waitcnt vmcnt(7)
s_cmp_lt_u32 s86, 1
s_cbranch_scc1 1
s_waitcnt vmcnt(5)
buffer_load_dwordx4 a[132:135], v0, s[8:11], s45 offen offset:2048 nt
v_dot2_f32_bf16 v52, v220, v8, 0
v_dot2_f32_bf16 v53, v224, v8, 0
v_dot2_f32_bf16 v54, v228, v8, 0
v_dot2_f32_bf16 v55, v232, v8, 0
v_dot2c_f32_bf16 v52, v221, v9
v_dot2c_f32_bf16 v53, v225, v9
v_dot2c_f32_bf16 v54, v229, v9
v_dot2c_f32_bf16 v55, v233, v9
v_dot2c_f32_bf16 v52, v222, v10
v_dot2c_f32_bf16 v53, v226, v10
v_dot2c_f32_bf16 v54, v230, v10
v_dot2c_f32_bf16 v55, v234, v10
v_dot2c_f32_bf16 v52, v223, v11
v_dot2c_f32_bf16 v53, v227, v11
v_dot2c_f32_bf16 v54, v231, v11
v_dot2c_f32_bf16 v55, v235, v11
v_add_f32_dpp v33, v52, v52 row_ror:8 row_mask:0xf bank_mask:0x3
v_add_f32_dpp v34, v53, v53 row_ror:8 row_mask:0xf bank_mask:0x3
v_add_f32_dpp v33, v54, v54 row_ror:8 row_mask:0xf bank_mask:0xc
v_add_f32_dpp v34, v55, v55 row_ror:8 row_mask:0xf bank_mask:0xc
s_nop 0
v_add_f32_dpp v26, v33, v33 row_half_mirror row_mask:0xf bank_mask:0x5
v_add_f32_dpp v26, v34, v34 row_half_mirror row_mask:0xf bank_mask:0xa
v_and_b32_dpp v36, v28, v4 row_newbcast:2 row_mask:0xf bank_mask:0xf
v_and_b32_dpp v37, v28, v5 row_newbcast:2 row_mask:0xf bank_mask:0xf
v_and_b32_dpp v38, v28, v6 row_newbcast:2 row_mask:0xf bank_mask:0xf
v_and_b32_dpp v39, v28, v7 row_newbcast:2 row_mask:0xf bank_mask:0xf
s_nop 1
v_mfma_f32_16x16x32_bf16 v[20:23], v[36:39], a[140:143], v[20:23]
s_waitcnt vmcnt(7)
s_cmp_lt_u32 s86, 1
s_cbranch_scc1 1
s_waitcnt vmcnt(5)
buffer_load_dwordx4 a[136:139], v0, s[8:11], s45 offen offset:3072 nt
s_add_u32 s45, s45, 16384
ds_read_b128 v[36:39], v1 offset:37888
s_waitcnt lgkmcnt(0)
v_dot2_f32_bf16 v52, v36, v8, 0
v_dot2_f32_bf16 v52, v37, v9, v52
v_dot2_f32_bf16 v52, v38, v10, v52
v_dot2_f32_bf16 v52, v39, v11, v52
s_nop 2
v_add_f32_dpp v33, v52, v52 row_ror:8 row_mask:0xf bank_mask:0xf
s_nop 1
v_add_f32_dpp v35, v33, v33 row_half_mirror row_mask:0xf bank_mask:0xf
v_cndmask_b32 v33, v26, v35, s[54:55]
v_cndmask_b32 v34, v35, v26, s[54:55]
s_nop 1
v_add_f32_dpp v26, v34, v33 quad_perm:[1,0,3,2] row_mask:0xf bank_mask:0xf
s_nop 1
v_add_f32_dpp v26, v26, v26 quad_perm:[2,3,0,1] row_mask:0xf bank_mask:0xf
v_mul_f32 v24, 0x3e0293ee, v24
v_mul_f32 v25, 0x3e0293ee, v25
v_mul_f32 v26, 0x3e0293ee, v26
v_mov_b32 v34, 0xff800000
v_cndmask_b32 v26, v34, v26, s[58:59]
v_max3_f32 v33, v24, v25, v26
s_nop 1
v_max_f32_dpp v33, v33, v33 quad_perm:[1,0,3,2] row_mask:0xf bank_mask:0xf
s_nop 1
v_max_f32_dpp v33, v33, v33 quad_perm:[2,3,0,1] row_mask:0xf bank_mask:0xf
s_nop 1
v_max_f32_dpp v33, v33, v33 row_ror:4 row_mask:0xf bank_mask:0xf
s_nop 1
v_max_f32_dpp v33, v33, v33 row_ror:8 row_mask:0xf bank_mask:0xf
s_nop 1
v_max_f32_dpp v33, v33, v33 row_bcast:15 row_mask:0xa bank_mask:0xf
s_nop 1
v_max_f32_dpp v33, v33, v33 row_bcast:31 row_mask:0xc bank_mask:0xf
s_nop 0
v_readlane_b32 s60, v33, 63
s_nop 1
v_subrev_f32 v24, s60, v24
v_subrev_f32 v25, s60, v25
v_subrev_f32 v26, s60, v26
v_exp_f32 v24, v24
v_exp_f32 v25, v25
v_exp_f32 v26, v26
v_add_f32 v33, v24, v25
v_add_f32 v33, v33, v26
v_cvt_pk_bf16_f32 v24, v24, v24
v_cvt_pk_bf16_f32 v25, v25, v25
v_cvt_pk_bf16_f32 v26, v26, v26
v_add_f32_dpp v33, v33, v33 quad_perm:[1,0,3,2] row_mask:0xf bank_mask:0xf
s_nop 1
v_add_f32_dpp v33, v33, v33 quad_perm:[2,3,0,1] row_mask:0xf bank_mask:0xf
s_nop 1
v_add_f32_dpp v33, v33, v33 row_ror:4 row_mask:0xf bank_mask:0xf
s_nop 1
v_add_f32_dpp v33, v33, v33 row_ror:8 row_mask:0xf bank_mask:0xf
s_nop 1
v_add_f32_dpp v33, v33, v33 row_bcast:15 row_mask:0xa bank_mask:0xf
s_nop 1
v_add_f32_dpp v33, v33, v33 row_bcast:31 row_mask:0xc bank_mask:0xf
s_nop 0
v_readlane_b32 s61, v33, 63
v_and_b32_dpp v40, v28, v4 row_newbcast:6 row_mask:0xf bank_mask:0xf
v_and_b32_dpp v41, v28, v5 row_newbcast:6 row_mask:0xf bank_mask:0xf
v_and_b32_dpp v42, v28, v6 row_newbcast:6 row_mask:0xf bank_mask:0xf
v_and_b32_dpp v43, v28, v7 row_newbcast:6 row_mask:0xf bank_mask:0xf
s_nop 1
v_mfma_f32_16x16x32_bf16 v[20:23], v[40:43], a[144:147], v[20:23]
s_waitcnt vmcnt(7)
s_cmp_lt_u32 s86, 1
s_cbranch_scc1 1
s_waitcnt vmcnt(5)
s_barrier
buffer_load_dwordx4 a[140:143], v0, s[8:11], s45 offen offset:0 nt
v_and_b32_dpp v44, v24, v4 row_newbcast:0 row_mask:0xf bank_mask:0xf
v_and_b32_dpp v45, v24, v5 row_newbcast:0 row_mask:0xf bank_mask:0xf
v_and_b32_dpp v46, v24, v6 row_newbcast:0 row_mask:0xf bank_mask:0xf
v_and_b32_dpp v47, v24, v7 row_newbcast:0 row_mask:0xf bank_mask:0xf
s_nop 1
v_mfma_f32_16x16x32_bf16 v[16:19], v[44:47], v[236:239], 0
v_and_b32_dpp v48, v28, v4 row_newbcast:10 row_mask:0xf bank_mask:0xf
v_and_b32_dpp v49, v28, v5 row_newbcast:10 row_mask:0xf bank_mask:0xf
v_and_b32_dpp v50, v28, v6 row_newbcast:10 row_mask:0xf bank_mask:0xf
v_and_b32_dpp v51, v28, v7 row_newbcast:10 row_mask:0xf bank_mask:0xf
s_nop 1
v_mfma_f32_16x16x32_bf16 v[20:23], v[48:51], a[148:151], v[20:23]
s_waitcnt vmcnt(7)
s_cmp_lt_u32 s86, 1
s_cbranch_scc1 1
s_waitcnt vmcnt(5)
buffer_load_dwordx4 a[144:147], v0, s[8:11], s45 offen offset:1024 nt
v_and_b32_dpp v36, v24, v4 row_newbcast:4 row_mask:0xf bank_mask:0xf
v_and_b32_dpp v37, v24, v5 row_newbcast:4 row_mask:0xf bank_mask:0xf
v_and_b32_dpp v38, v24, v6 row_newbcast:4 row_mask:0xf bank_mask:0xf
v_and_b32_dpp v39, v24, v7 row_newbcast:4 row_mask:0xf bank_mask:0xf
s_nop 1
v_mfma_f32_16x16x32_bf16 v[16:19], v[36:39], v[240:243], v[16:19]
v_and_b32_dpp v40, v28, v4 row_newbcast:14 row_mask:0xf bank_mask:0xf
v_and_b32_dpp v41, v28, v5 row_newbcast:14 row_mask:0xf bank_mask:0xf
v_and_b32_dpp v42, v28, v6 row_newbcast:14 row_mask:0xf bank_mask:0xf
v_and_b32_dpp v43, v28, v7 row_newbcast:14 row_mask:0xf bank_mask:0xf
s_nop 1
v_mfma_f32_16x16x32_bf16 v[20:23], v[40:43], a[152:155], v[20:23]
s_waitcnt vmcnt(7)
s_cmp_lt_u32 s86, 1
s_cbranch_scc1 1
s_waitcnt vmcnt(5)
buffer_load_dwordx4 a[148:151], v0, s[8:11], s45 offen offset:2048 nt
v_and_b32_dpp v44, v24, v4 row_newbcast:8 row_mask:0xf bank_mask:0xf
v_and_b32_dpp v45, v24, v5 row_newbcast:8 row_mask:0xf bank_mask:0xf
v_and_b32_dpp v46, v24, v6 row_newbcast:8 row_mask:0xf bank_mask:0xf
v_and_b32_dpp v47, v24, v7 row_newbcast:8 row_mask:0xf bank_mask:0xf
s_nop 1
v_mfma_f32_16x16x32_bf16 v[16:19], v[44:47], v[244:247], v[16:19]
v_and_b32_dpp v48, v28, v4 row_newbcast:3 row_mask:0xf bank_mask:0xf
v_and_b32_dpp v49, v28, v5 row_newbcast:3 row_mask:0xf bank_mask:0xf
v_and_b32_dpp v50, v28, v6 row_newbcast:3 row_mask:0xf bank_mask:0xf
v_and_b32_dpp v51, v28, v7 row_newbcast:3 row_mask:0xf bank_mask:0xf
s_nop 1
v_mfma_f32_16x16x32_bf16 v[20:23], v[48:51], a[156:159], v[20:23]
s_waitcnt vmcnt(7)
s_cmp_lt_u32 s86, 1
s_cbranch_scc1 1
s_waitcnt vmcnt(5)
buffer_load_dwordx4 a[152:155], v0, s[8:11], s45 offen offset:3072 nt
s_add_u32 s45, s45, 16384
v_and_b32_dpp v36, v24, v4 row_newbcast:12 row_mask:0xf bank_mask:0xf
v_and_b32_dpp v37, v24, v5 row_newbcast:12 row_mask:0xf bank_mask:0xf
v_and_b32_dpp v38, v24, v6 row_newbcast:12 row_mask:0xf bank_mask:0xf
v_and_b32_dpp v39, v24, v7 row_newbcast:12 row_mask:0xf bank_mask:0xf
s_nop 1
v_mfma_f32_16x16x32_bf16 v[16:19], v[36:39], v[248:251], v[16:19]
v_and_b32_dpp v40, v28, v4 row_newbcast:7 row_mask:0xf bank_mask:0xf
v_and_b32_dpp v41, v28, v5 row_newbcast:7 row_mask:0xf bank_mask:0xf
v_and_b32_dpp v42, v28, v6 row_newbcast:7 row_mask:0xf bank_mask:0xf
v_and_b32_dpp v43, v28, v7 row_newbcast:7 row_mask:0xf bank_mask:0xf
s_nop 1
v_mfma_f32_16x16x32_bf16 v[20:23], v[40:43], a[160:163], v[20:23]
s_waitcnt vmcnt(7)
s_cmp_lt_u32 s86, 1
s_cbranch_scc1 1
s_waitcnt vmcnt(5)
buffer_load_dwordx4 a[156:159], v0, s[8:11], s45 offen offset:0 nt
v_and_b32_dpp v44, v24, v4 row_newbcast:1 row_mask:0xf bank_mask:0xf
v_and_b32_dpp v45, v24, v5 row_newbcast:1 row_mask:0xf bank_mask:0xf
v_and_b32_dpp v46, v24, v6 row_newbcast:1 row_mask:0xf bank_mask:0xf
v_and_b32_dpp v47, v24, v7 row_newbcast:1 row_mask:0xf bank_mask:0xf
s_nop 1
v_mfma_f32_16x16x32_bf16 v[16:19], v[44:47], v[252:255], v[16:19]
v_and_b32_dpp v48, v28, v4 row_newbcast:11 row_mask:0xf bank_mask:0xf
v_and_b32_dpp v49, v28, v5 row_newbcast:11 row_mask:0xf bank_mask:0xf
v_and_b32_dpp v50, v28, v6 row_newbcast:11 row_mask:0xf bank_mask:0xf
v_and_b32_dpp v51, v28, v7 row_newbcast:11 row_mask:0xf bank_mask:0xf
s_nop 1
v_mfma_f32_16x16x32_bf16 v[20:23], v[48:51], a[164:167], v[20:23]
s_waitcnt vmcnt(7)
s_cmp_lt_u32 s86, 1
s_cbranch_scc1 1
s_waitcnt vmcnt(5)
buffer_load_dwordx4 a[160:163], v0, s[8:11], s45 offen offset:1024 nt
v_and_b32_dpp v36, v24, v4 row_newbcast:5 row_mask:0xf bank_mask:0xf
v_and_b32_dpp v37, v24, v5 row_newbcast:5 row_mask:0xf bank_mask:0xf
v_and_b32_dpp v38, v24, v6 row_newbcast:5 row_mask:0xf bank_mask:0xf
v_and_b32_dpp v39, v24, v7 row_newbcast:5 row_mask:0xf bank_mask:0xf
s_nop 1
v_mfma_f32_16x16x32_bf16 v[16:19], v[36:39], a[128:131], v[16:19]
v_and_b32_dpp v40, v28, v4 row_newbcast:15 row_mask:0xf bank_mask:0xf
v_and_b32_dpp v41, v28, v5 row_newbcast:15 row_mask:0xf bank_mask:0xf
v_and_b32_dpp v42, v28, v6 row_newbcast:15 row_mask:0xf bank_mask:0xf
v_and_b32_dpp v43, v28, v7 row_newbcast:15 row_mask:0xf bank_mask:0xf
s_nop 1
v_mfma_f32_16x16x32_bf16 v[20:23], v[40:43], a[168:171], v[20:23]
buffer_load_dwordx4 v[8:11], v3, s[12:15], s50 offen sc1
s_waitcnt vmcnt(8)
s_cmp_lt_u32 s86, 1
s_cbranch_scc1 1
s_waitcnt vmcnt(5)
buffer_load_dwordx4 a[164:167], v0, s[8:11], s45 offen offset:2048 nt
v_and_b32_dpp v44, v24, v4 row_newbcast:9 row_mask:0xf bank_mask:0xf
v_and_b32_dpp v45, v24, v5 row_newbcast:9 row_mask:0xf bank_mask:0xf
v_and_b32_dpp v46, v24, v6 row_newbcast:9 row_mask:0xf bank_mask:0xf
v_and_b32_dpp v47, v24, v7 row_newbcast:9 row_mask:0xf bank_mask:0xf
s_nop 1
v_mfma_f32_16x16x32_bf16 v[16:19], v[44:47], a[132:135], v[16:19]
v_and_b32_dpp v48, v29, v4 row_newbcast:0 row_mask:0xf bank_mask:0xf
v_and_b32_dpp v49, v29, v5 row_newbcast:0 row_mask:0xf bank_mask:0xf
v_and_b32_dpp v50, v29, v6 row_newbcast:0 row_mask:0xf bank_mask:0xf
v_and_b32_dpp v51, v29, v7 row_newbcast:0 row_mask:0xf bank_mask:0xf
s_nop 1
v_mfma_f32_16x16x32_bf16 v[20:23], v[48:51], a[172:175], v[20:23]
s_waitcnt vmcnt(8)
s_cmp_lt_u32 s86, 1
s_cbranch_scc1 1
s_waitcnt vmcnt(5)
buffer_load_dwordx4 a[168:171], v0, s[8:11], s45 offen offset:3072 nt
s_add_u32 s45, s45, 16384
v_and_b32_dpp v36, v24, v4 row_newbcast:13 row_mask:0xf bank_mask:0xf
v_and_b32_dpp v37, v24, v5 row_newbcast:13 row_mask:0xf bank_mask:0xf
v_and_b32_dpp v38, v24, v6 row_newbcast:13 row_mask:0xf bank_mask:0xf
v_and_b32_dpp v39, v24, v7 row_newbcast:13 row_mask:0xf bank_mask:0xf
s_nop 1
v_mfma_f32_16x16x32_bf16 v[16:19], v[36:39], a[136:139], v[16:19]
v_and_b32_dpp v40, v29, v4 row_newbcast:4 row_mask:0xf bank_mask:0xf
v_and_b32_dpp v41, v29, v5 row_newbcast:4 row_mask:0xf bank_mask:0xf
v_and_b32_dpp v42, v29, v6 row_newbcast:4 row_mask:0xf bank_mask:0xf
v_and_b32_dpp v43, v29, v7 row_newbcast:4 row_mask:0xf bank_mask:0xf
s_nop 1
v_mfma_f32_16x16x32_bf16 v[20:23], v[40:43], a[176:179], v[20:23]
s_waitcnt vmcnt(8)
s_cmp_lt_u32 s86, 1
s_cbranch_scc1 1
s_waitcnt vmcnt(5)
s_barrier
buffer_load_dwordx4 a[172:175], v0, s[8:11], s45 offen offset:0 nt
v_and_b32_dpp v44, v24, v4 row_newbcast:2 row_mask:0xf bank_mask:0xf
v_and_b32_dpp v45, v24, v5 row_newbcast:2 row_mask:0xf bank_mask:0xf
v_and_b32_dpp v46, v24, v6 row_newbcast:2 row_mask:0xf bank_mask:0xf
v_and_b32_dpp v47, v24, v7 row_newbcast:2 row_mask:0xf bank_mask:0xf
s_nop 1
v_mfma_f32_16x16x32_bf16 v[16:19], v[44:47], a[140:143], v[16:19]
v_and_b32_dpp v48, v29, v4 row_newbcast:8 row_mask:0xf bank_mask:0xf
v_and_b32_dpp v49, v29, v5 row_newbcast:8 row_mask:0xf bank_mask:0xf
v_and_b32_dpp v50, v29, v6 row_newbcast:8 row_mask:0xf bank_mask:0xf
v_and_b32_dpp v51, v29, v7 row_newbcast:8 row_mask:0xf bank_mask:0xf
s_nop 1
v_mfma_f32_16x16x32_bf16 v[20:23], v[48:51], a[180:183], v[20:23]
s_waitcnt vmcnt(8)
s_cmp_lt_u32 s86, 1
s_cbranch_scc1 1
s_waitcnt vmcnt(5)
buffer_load_dwordx4 a[176:179], v0, s[8:11], s45 offen offset:1024 nt
v_and_b32_dpp v36, v24, v4 row_newbcast:6 row_mask:0xf bank_mask:0xf
v_and_b32_dpp v37, v24, v5 row_newbcast:6 row_mask:0xf bank_mask:0xf
v_and_b32_dpp v38, v24, v6 row_newbcast:6 row_mask:0xf bank_mask:0xf
v_and_b32_dpp v39, v24, v7 row_newbcast:6 row_mask:0xf bank_mask:0xf
s_nop 1
v_mfma_f32_16x16x32_bf16 v[16:19], v[36:39], a[144:147], v[16:19]
v_and_b32_dpp v40, v29, v4 row_newbcast:12 row_mask:0xf bank_mask:0xf
v_and_b32_dpp v41, v29, v5 row_newbcast:12 row_mask:0xf bank_mask:0xf
v_and_b32_dpp v42, v29, v6 row_newbcast:12 row_mask:0xf bank_mask:0xf
v_and_b32_dpp v43, v29, v7 row_newbcast:12 row_mask:0xf bank_mask:0xf
s_nop 1
v_mfma_f32_16x16x32_bf16 v[20:23], v[40:43], a[184:187], v[20:23]
s_waitcnt vmcnt(8)
s_cmp_lt_u32 s86, 1
s_cbranch_scc1 1
s_waitcnt vmcnt(5)
buffer_load_dwordx4 a[180:183], v0, s[8:11], s45 offen offset:2048 nt
v_and_b32_dpp v44, v24, v4 row_newbcast:10 row_mask:0xf bank_mask:0xf
v_and_b32_dpp v45, v24, v5 row_newbcast:10 row_mask:0xf bank_mask:0xf
v_and_b32_dpp v46, v24, v6 row_newbcast:10 row_mask:0xf bank_mask:0xf
v_and_b32_dpp v47, v24, v7 row_newbcast:10 row_mask:0xf bank_mask:0xf
s_nop 1
v_mfma_f32_16x16x32_bf16 v[16:19], v[44:47], a[148:151], v[16:19]
v_and_b32_dpp v48, v29, v4 row_newbcast:1 row_mask:0xf bank_mask:0xf
v_and_b32_dpp v49, v29, v5 row_newbcast:1 row_mask:0xf bank_mask:0xf
v_and_b32_dpp v50, v29, v6 row_newbcast:1 row_mask:0xf bank_mask:0xf
v_and_b32_dpp v51, v29, v7 row_newbcast:1 row_mask:0xf bank_mask:0xf
s_nop 1
v_mfma_f32_16x16x32_bf16 v[20:23], v[48:51], a[188:191], v[20:23]
s_waitcnt vmcnt(8)
s_cmp_lt_u32 s86, 1
s_cbranch_scc1 1
s_waitcnt vmcnt(5)
buffer_load_dwordx4 a[184:187], v0, s[8:11], s45 offen offset:3072 nt
s_add_u32 s45, s45, 16384
v_and_b32_dpp v36, v24, v4 row_newbcast:14 row_mask:0xf bank_mask:0xf
v_and_b32_dpp v37, v24, v5 row_newbcast:14 row_mask:0xf bank_mask:0xf
v_and_b32_dpp v38, v24, v6 row_newbcast:14 row_mask:0xf bank_mask:0xf
v_and_b32_dpp v39, v24, v7 row_newbcast:14 row_mask:0xf bank_mask:0xf
s_nop 1
v_mfma_f32_16x16x32_bf16 v[16:19], v[36:39], a[152:155], v[16:19]
v_and_b32_dpp v40, v29, v4 row_newbcast:5 row_mask:0xf bank_mask:0xf
v_and_b32_dpp v41, v29, v5 row_newbcast:5 row_mask:0xf bank_mask:0xf
v_and_b32_dpp v42, v29, v6 row_newbcast:5 row_mask:0xf bank_mask:0xf
v_and_b32_dpp v43, v29, v7 row_newbcast:5 row_mask:0xf bank_mask:0xf
s_nop 1
v_mfma_f32_16x16x32_bf16 v[20:23], v[40:43], a[192:195], v[20:23]
s_waitcnt vmcnt(8)
s_cmp_lt_u32 s86, 1
s_cbranch_scc1 1
s_waitcnt vmcnt(5)
buffer_load_dwordx4 a[188:191], v0, s[8:11], s45 offen offset:0 nt
v_and_b32_dpp v44, v24, v4 row_newbcast:3 row_mask:0xf bank_mask:0xf
v_and_b32_dpp v45, v24, v5 row_newbcast:3 row_mask:0xf bank_mask:0xf
v_and_b32_dpp v46, v24, v6 row_newbcast:3 row_mask:0xf bank_mask:0xf
v_and_b32_dpp v47, v24, v7 row_newbcast:3 row_mask:0xf bank_mask:0xf
s_nop 1
v_mfma_f32_16x16x32_bf16 v[16:19], v[44:47], a[156:159], v[16:19]
v_and_b32_dpp v48, v29, v4 row_newbcast:9 row_mask:0xf bank_mask:0xf
v_and_b32_dpp v49, v29, v5 row_newbcast:9 row_mask:0xf bank_mask:0xf
v_and_b32_dpp v50, v29, v6 row_newbcast:9 row_mask:0xf bank_mask:0xf
v_and_b32_dpp v51, v29, v7 row_newbcast:9 row_mask:0xf bank_mask:0xf
s_nop 1
v_mfma_f32_16x16x32_bf16 v[20:23], v[48:51], a[196:199], v[20:23]
s_waitcnt vmcnt(8)
s_cmp_lt_u32 s86, 1
s_cbranch_scc1 1
s_waitcnt vmcnt(5)
buffer_load_dwordx4 a[192:195], v0, s[8:11], s45 offen offset:1024 nt
v_and_b32_dpp v36, v24, v4 row_newbcast:7 row_mask:0xf bank_mask:0xf
v_and_b32_dpp v37, v24, v5 row_newbcast:7 row_mask:0xf bank_mask:0xf
v_and_b32_dpp v38, v24, v6 row_newbcast:7 row_mask:0xf bank_mask:0xf
v_and_b32_dpp v39, v24, v7 row_newbcast:7 row_mask:0xf bank_mask:0xf
s_nop 1
v_mfma_f32_16x16x32_bf16 v[16:19], v[36:39], a[160:163], v[16:19]
v_and_b32_dpp v40, v29, v4 row_newbcast:13 row_mask:0xf bank_mask:0xf
v_and_b32_dpp v41, v29, v5 row_newbcast:13 row_mask:0xf bank_mask:0xf
v_and_b32_dpp v42, v29, v6 row_newbcast:13 row_mask:0xf bank_mask:0xf
v_and_b32_dpp v43, v29, v7 row_newbcast:13 row_mask:0xf bank_mask:0xf
s_nop 1
v_mfma_f32_16x16x32_bf16 v[20:23], v[40:43], a[200:203], v[20:23]
s_waitcnt vmcnt(8)
s_nop 6
Lq32:
v_max3_u32 v33, v8, v9, v10
v_max_u32 v33, v33, v11
v_cmp_eq_u32 vcc, -1, v33
s_nop 0
s_cbranch_vccz Lq33
s_sleep 1
buffer_load_dwordx4 v[8:11], v3, s[12:15], s50 offen sc1
s_waitcnt vmcnt(0)
s_sub_u32 s64, s64, 1
s_cmp_gt_i32 s64, 0
s_cbranch_scc1 Lq32
Lq33:
s_add_u32 s50, s50, 256
s_waitcnt vmcnt(7)
s_cmp_lt_u32 s86, 1
s_cbranch_scc1 1
s_waitcnt vmcnt(5)
buffer_load_dwordx4 a[196:199], v0, s[8:11], s45 offen offset:2048 nt
v_and_b32_dpp v44, v24, v4 row_newbcast:11 row_mask:0xf bank_mask:0xf
v_and_b32_dpp v45, v24, v5 row_newbcast:11 row_mask:0xf bank_mask:0xf
v_and_b32_dpp v46, v24, v6 row_newbcast:11 row_mask:0xf bank_mask:0xf
v_and_b32_dpp v47, v24, v7 row_newbcast:11 row_mask:0xf bank_mask:0xf
s_nop 1
v_mfma_f32_16x16x32_bf16 v[16:19], v[44:47], a[164:167], v[16:19]
v_and_b32_dpp v48, v29, v4 row_newbcast:2 row_mask:0xf bank_mask:0xf
v_and_b32_dpp v49, v29, v5 row_newbcast:2 row_mask:0xf bank_mask:0xf
v_and_b32_dpp v50, v29, v6 row_newbcast:2 row_mask:0xf bank_mask:0xf
v_and_b32_dpp v51, v29, v7 row_newbcast:2 row_mask:0xf bank_mask:0xf
s_nop 1
v_mfma_f32_16x16x32_bf16 v[20:23], v[48:51], a[204:207], v[20:23]
s_waitcnt vmcnt(7)
s_cmp_lt_u32 s86, 1
s_cbranch_scc1 1
s_waitcnt vmcnt(5)
buffer_load_dwordx4 a[200:203], v0, s[8:11], s45 offen offset:3072 nt
s_add_u32 s45, s45, 16384
v_and_b32_dpp v36, v24, v4 row_newbcast:15 row_mask:0xf bank_mask:0xf
v_and_b32_dpp v37, v24, v5 row_newbcast:15 row_mask:0xf bank_mask:0xf
v_and_b32_dpp v38, v24, v6 row_newbcast:15 row_mask:0xf bank_mask:0xf
v_and_b32_dpp v39, v24, v7 row_newbcast:15 row_mask:0xf bank_mask:0xf
s_nop 1
v_mfma_f32_16x16x32_bf16 v[16:19], v[36:39], a[168:171], v[16:19]
v_and_b32_dpp v40, v29, v4 row_newbcast:6 row_mask:0xf bank_mask:0xf
v_and_b32_dpp v41, v29, v5 row_newbcast:6 row_mask:0xf bank_mask:0xf
v_and_b32_dpp v42, v29, v6 row_newbcast:6 row_mask:0xf bank_mask:0xf
v_and_b32_dpp v43, v29, v7 row_newbcast:6 row_mask:0xf bank_mask:0xf
s_nop 1
v_mfma_f32_16x16x32_bf16 v[20:23], v[40:43], a[208:211], v[20:23]
buffer_load_dwordx4 v[12:15], v3, s[12:15], s51 offen sc1
s_waitcnt vmcnt(8)
s_cmp_lt_u32 s86, 1
s_cbranch_scc1 1
s_waitcnt vmcnt(5)
s_barrier
buffer_load_dwordx4 a[204:207], v0, s[8:11], s45 offen offset:0 nt
v_and_b32_dpp v44, v25, v4 row_newbcast:0 row_mask:0xf bank_mask:0xf
v_and_b32_dpp v45, v25, v5 row_newbcast:0 row_mask:0xf bank_mask:0xf
v_and_b32_dpp v46, v25, v6 row_newbcast:0 row_mask:0xf bank_mask:0xf
v_and_b32_dpp v47, v25, v7 row_newbcast:0 row_mask:0xf bank_mask:0xf
s_nop 1
v_mfma_f32_16x16x32_bf16 v[16:19], v[44:47], a[172:175], v[16:19]
v_and_b32_dpp v48, v29, v4 row_newbcast:10 row_mask:0xf bank_mask:0xf
v_and_b32_dpp v49, v29, v5 row_newbcast:10 row_mask:0xf bank_mask:0xf
v_and_b32_dpp v50, v29, v6 row_newbcast:10 row_mask:0xf bank_mask:0xf
v_and_b32_dpp v51, v29, v7 row_newbcast:10 row_mask:0xf bank_mask:0xf
s_nop 1
v_mfma_f32_16x16x32_bf16 v[20:23], v[48:51], a[212:215], v[20:23]
s_waitcnt vmcnt(8)
s_cmp_lt_u32 s86, 1
s_cbranch_scc1 1
s_waitcnt vmcnt(5)
buffer_load_dwordx4 a[208:211], v0, s[8:11], s45 offen offset:1024 nt
v_and_b32_dpp v36, v25, v4 row_newbcast:4 row_mask:0xf bank_mask:0xf
v_and_b32_dpp v37, v25, v5 row_newbcast:4 row_mask:0xf bank_mask:0xf
v_and_b32_dpp v38, v25, v6 row_newbcast:4 row_mask:0xf bank_mask:0xf
v_and_b32_dpp v39, v25, v7 row_newbcast:4 row_mask:0xf bank_mask:0xf
s_nop 1
v_mfma_f32_16x16x32_bf16 v[16:19], v[36:39], a[176:179], v[16:19]
v_and_b32_dpp v40, v29, v4 row_newbcast:14 row_mask:0xf bank_mask:0xf
v_and_b32_dpp v41, v29, v5 row_newbcast:14 row_mask:0xf bank_mask:0xf
v_and_b32_dpp v42, v29, v6 row_newbcast:14 row_mask:0xf bank_mask:0xf
v_and_b32_dpp v43, v29, v7 row_newbcast:14 row_mask:0xf bank_mask:0xf
s_nop 1
v_mfma_f32_16x16x32_bf16 v[20:23], v[40:43], a[216:219], v[20:23]
s_waitcnt vmcnt(8)
s_cmp_lt_u32 s86, 1
s_cbranch_scc1 1
s_waitcnt vmcnt(5)
buffer_load_dwordx4 a[212:215], v0, s[8:11], s45 offen offset:2048 nt
v_and_b32_dpp v44, v25, v4 row_newbcast:8 row_mask:0xf bank_mask:0xf
v_and_b32_dpp v45, v25, v5 row_newbcast:8 row_mask:0xf bank_mask:0xf
v_and_b32_dpp v46, v25, v6 row_newbcast:8 row_mask:0xf bank_mask:0xf
v_and_b32_dpp v47, v25, v7 row_newbcast:8 row_mask:0xf bank_mask:0xf
s_nop 1
v_mfma_f32_16x16x32_bf16 v[16:19], v[44:47], a[180:183], v[16:19]
v_and_b32_dpp v48, v29, v4 row_newbcast:3 row_mask:0xf bank_mask:0xf
v_and_b32_dpp v49, v29, v5 row_newbcast:3 row_mask:0xf bank_mask:0xf
v_and_b32_dpp v50, v29, v6 row_newbcast:3 row_mask:0xf bank_mask:0xf
v_and_b32_dpp v51, v29, v7 row_newbcast:3 row_mask:0xf bank_mask:0xf
s_nop 1
v_mfma_f32_16x16x32_bf16 v[20:23], v[48:51], a[220:223], v[20:23]
s_waitcnt vmcnt(8)
s_cmp_lt_u32 s86, 1
s_cbranch_scc1 1
s_waitcnt vmcnt(5)
buffer_load_dwordx4 a[216:219], v0, s[8:11], s45 offen offset:3072 nt
s_add_u32 s45, s45, 16384
v_and_b32_dpp v36, v25, v4 row_newbcast:12 row_mask:0xf bank_mask:0xf
v_and_b32_dpp v37, v25, v5 row_newbcast:12 row_mask:0xf bank_mask:0xf
v_and_b32_dpp v38, v25, v6 row_newbcast:12 row_mask:0xf bank_mask:0xf
v_and_b32_dpp v39, v25, v7 row_newbcast:12 row_mask:0xf bank_mask:0xf
s_nop 1
v_mfma_f32_16x16x32_bf16 v[16:19], v[36:39], a[184:187], v[16:19]
v_and_b32_dpp v40, v29, v4 row_newbcast:7 row_mask:0xf bank_mask:0xf
v_and_b32_dpp v41, v29, v5 row_newbcast:7 row_mask:0xf bank_mask:0xf
v_and_b32_dpp v42, v29, v6 row_newbcast:7 row_mask:0xf bank_mask:0xf
v_and_b32_dpp v43, v29, v7 row_newbcast:7 row_mask:0xf bank_mask:0xf
s_nop 1
v_mfma_f32_16x16x32_bf16 v[20:23], v[40:43], a[224:227], v[20:23]
s_waitcnt vmcnt(8)
s_cmp_lt_u32 s86, 1
s_cbranch_scc1 1
s_waitcnt vmcnt(5)
buffer_load_dwordx4 a[220:223], v0, s[8:11], s45 offen offset:0 nt
v_and_b32_dpp v44, v25, v4 row_newbcast:1 row_mask:0xf bank_mask:0xf
v_and_b32_dpp v45, v25, v5 row_newbcast:1 row_mask:0xf bank_mask:0xf
v_and_b32_dpp v46, v25, v6 row_newbcast:1 row_mask:0xf bank_mask:0xf
v_and_b32_dpp v47, v25, v7 row_newbcast:1 row_mask:0xf bank_mask:0xf
s_nop 1
v_mfma_f32_16x16x32_bf16 v[16:19], v[44:47], a[188:191], v[16:19]
v_and_b32_dpp v48, v29, v4 row_newbcast:11 row_mask:0xf bank_mask:0xf
v_and_b32_dpp v49, v29, v5 row_newbcast:11 row_mask:0xf bank_mask:0xf
v_and_b32_dpp v50, v29, v6 row_newbcast:11 row_mask:0xf bank_mask:0xf
v_and_b32_dpp v51, v29, v7 row_newbcast:11 row_mask:0xf bank_mask:0xf
s_nop 1
v_mfma_f32_16x16x32_bf16 v[20:23], v[48:51], a[228:231], v[20:23]
s_waitcnt vmcnt(8)
s_cmp_lt_u32 s86, 1
s_cbranch_scc1 1
s_waitcnt vmcnt(5)
buffer_load_dwordx4 a[224:227], v0, s[8:11], s45 offen offset:1024 nt
v_and_b32_dpp v36, v25, v4 row_newbcast:5 row_mask:0xf bank_mask:0xf
v_and_b32_dpp v37, v25, v5 row_newbcast:5 row_mask:0xf bank_mask:0xf
v_and_b32_dpp v38, v25, v6 row_newbcast:5 row_mask:0xf bank_mask:0xf
v_and_b32_dpp v39, v25, v7 row_newbcast:5 row_mask:0xf bank_mask:0xf
s_nop 1
v_mfma_f32_16x16x32_bf16 v[16:19], v[36:39], a[192:195], v[16:19]
v_and_b32_dpp v40, v29, v4 row_newbcast:15 row_mask:0xf bank_mask:0xf
v_and_b32_dpp v41, v29, v5 row_newbcast:15 row_mask:0xf bank_mask:0xf
v_and_b32_dpp v42, v29, v6 row_newbcast:15 row_mask:0xf bank_mask:0xf
v_and_b32_dpp v43, v29, v7 row_newbcast:15 row_mask:0xf bank_mask:0xf
s_nop 1
v_mfma_f32_16x16x32_bf16 v[20:23], v[40:43], a[232:235], v[20:23]
s_waitcnt vmcnt(8)
s_cmp_lt_u32 s86, 1
s_cbranch_scc1 1
s_waitcnt vmcnt(5)
buffer_load_dwordx4 a[228:231], v0, s[8:11], s45 offen offset:2048 nt
v_and_b32_dpp v44, v25, v4 row_newbcast:9 row_mask:0xf bank_mask:0xf
v_and_b32_dpp v45, v25, v5 row_newbcast:9 row_mask:0xf bank_mask:0xf
v_and_b32_dpp v46, v25, v6 row_newbcast:9 row_mask:0xf bank_mask:0xf
v_and_b32_dpp v47, v25, v7 row_newbcast:9 row_mask:0xf bank_mask:0xf
s_nop 1
v_mfma_f32_16x16x32_bf16 v[16:19], v[44:47], a[196:199], v[16:19]
v_and_b32_dpp v48, v30, v4 row_newbcast:0 row_mask:0xf bank_mask:0xf
v_and_b32_dpp v49, v30, v5 row_newbcast:0 row_mask:0xf bank_mask:0xf
v_and_b32_dpp v50, v30, v6 row_newbcast:0 row_mask:0xf bank_mask:0xf
v_and_b32_dpp v51, v30, v7 row_newbcast:0 row_mask:0xf bank_mask:0xf
s_nop 1
v_mfma_f32_16x16x32_bf16 v[20:23], v[48:51], a[236:239], v[20:23]
s_waitcnt vmcnt(8)
s_cmp_lt_u32 s86, 1
s_cbranch_scc1 1
s_waitcnt vmcnt(5)
buffer_load_dwordx4 a[232:235], v0, s[8:11], s45 offen offset:3072 nt
s_add_u32 s45, s45, 16384
v_and_b32_dpp v36, v25, v4 row_newbcast:13 row_mask:0xf bank_mask:0xf
v_and_b32_dpp v37, v25, v5 row_newbcast:13 row_mask:0xf bank_mask:0xf
v_and_b32_dpp v38, v25, v6 row_newbcast:13 row_mask:0xf bank_mask:0xf
v_and_b32_dpp v39, v25, v7 row_newbcast:13 row_mask:0xf bank_mask:0xf
s_nop 1
v_mfma_f32_16x16x32_bf16 v[16:19], v[36:39], a[200:203], v[16:19]
s_waitcnt vmcnt(8)
v_cmp_eq_u32 vcc, -1, v12
s_nop 0
s_cmp_lg_u64 vcc, 0
s_cselect_b32 s86, 1, 0
v_and_b32_dpp v40, v30, v4 row_newbcast:4 row_mask:0xf bank_mask:0xf
v_and_b32_dpp v41, v30, v5 row_newbcast:4 row_mask:0xf bank_mask:0xf
v_and_b32_dpp v42, v30, v6 row_newbcast:4 row_mask:0xf bank_mask:0xf
v_and_b32_dpp v43, v30, v7 row_newbcast:4 row_mask:0xf bank_mask:0xf
s_nop 1
v_mfma_f32_16x16x32_bf16 v[20:23], v[40:43], a[240:243], v[20:23]
s_waitcnt vmcnt(7)
s_cmp_lt_u32 s86, 1
s_cbranch_scc1 1
s_waitcnt vmcnt(5)
s_barrier
buffer_load_dwordx4 a[236:239], v0, s[8:11], s45 offen offset:0 nt
v_and_b32_dpp v44, v25, v4 row_newbcast:2 row_mask:0xf bank_mask:0xf
v_and_b32_dpp v45, v25, v5 row_newbcast:2 row_mask:0xf bank_mask:0xf
v_and_b32_dpp v46, v25, v6 row_newbcast:2 row_mask:0xf bank_mask:0xf
v_and_b32_dpp v47, v25, v7 row_newbcast:2 row_mask:0xf bank_mask:0xf
s_nop 1
v_mfma_f32_16x16x32_bf16 v[16:19], v[44:47], a[204:207], v[16:19]
v_and_b32_dpp v48, v30, v4 row_newbcast:8 row_mask:0xf bank_mask:0xf
v_and_b32_dpp v49, v30, v5 row_newbcast:8 row_mask:0xf bank_mask:0xf
v_and_b32_dpp v50, v30, v6 row_newbcast:8 row_mask:0xf bank_mask:0xf
v_and_b32_dpp v51, v30, v7 row_newbcast:8 row_mask:0xf bank_mask:0xf
s_nop 1
v_mfma_f32_16x16x32_bf16 v[20:23], v[48:51], a[244:247], v[20:23]
buffer_load_dwordx4 v[12:15], v3, s[12:15], s51 offen sc1
s_waitcnt vmcnt(8)
s_cmp_lt_u32 s86, 1
s_cbranch_scc1 1
s_waitcnt vmcnt(5)
buffer_load_dwordx4 a[240:243], v0, s[8:11], s45 offen offset:1024 nt
v_and_b32_dpp v36, v25, v4 row_newbcast:6 row_mask:0xf bank_mask:0xf
v_and_b32_dpp v37, v25, v5 row_newbcast:6 row_mask:0xf bank_mask:0xf
v_and_b32_dpp v38, v25, v6 row_newbcast:6 row_mask:0xf bank_mask:0xf
v_and_b32_dpp v39, v25, v7 row_newbcast:6 row_mask:0xf bank_mask:0xf
s_nop 1
v_mfma_f32_16x16x32_bf16 v[16:19], v[36:39], a[208:211], v[16:19]
v_and_b32_dpp v40, v30, v4 row_newbcast:12 row_mask:0xf bank_mask:0xf
v_and_b32_dpp v41, v30, v5 row_newbcast:12 row_mask:0xf bank_mask:0xf
v_and_b32_dpp v42, v30, v6 row_newbcast:12 row_mask:0xf bank_mask:0xf
v_and_b32_dpp v43, v30, v7 row_newbcast:12 row_mask:0xf bank_mask:0xf
s_nop 1
v_mfma_f32_16x16x32_bf16 v[20:23], v[40:43], a[248:251], v[20:23]
s_waitcnt vmcnt(8)
s_cmp_lt_u32 s86, 1
s_cbranch_scc1 1
s_waitcnt vmcnt(5)
buffer_load_dwordx4 a[244:247], v0, s[8:11], s45 offen offset:2048 nt
v_and_b32_dpp v44, v25, v4 row_newbcast:10 row_mask:0xf bank_mask:0xf
v_and_b32_dpp v45, v25, v5 row_newbcast:10 row_mask:0xf bank_mask:0xf
v_and_b32_dpp v46, v25, v6 row_newbcast:10 row_mask:0xf bank_mask:0xf
v_and_b32_dpp v47, v25, v7 row_newbcast:10 row_mask:0xf bank_mask:0xf
s_nop 1
v_mfma_f32_16x16x32_bf16 v[16:19], v[44:47], a[212:215], v[16:19]
v_and_b32_dpp v48, v30, v4 row_newbcast:1 row_mask:0xf bank_mask:0xf
v_and_b32_dpp v49, v30, v5 row_newbcast:1 row_mask:0xf bank_mask:0xf
v_and_b32_dpp v50, v30, v6 row_newbcast:1 row_mask:0xf bank_mask:0xf
v_and_b32_dpp v51, v30, v7 row_newbcast:1 row_mask:0xf bank_mask:0xf
s_nop 1
v_mfma_f32_16x16x32_bf16 v[20:23], v[48:51], a[252:255], v[20:23]
s_waitcnt vmcnt(8)
s_cmp_lt_u32 s86, 1
s_cbranch_scc1 1
s_waitcnt vmcnt(5)
buffer_load_dwordx4 a[248:251], v0, s[8:11], s45 offen offset:3072 nt
s_add_u32 s45, s45, 16384
v_and_b32_dpp v36, v25, v4 row_newbcast:14 row_mask:0xf bank_mask:0xf
v_and_b32_dpp v37, v25, v5 row_newbcast:14 row_mask:0xf bank_mask:0xf
v_and_b32_dpp v38, v25, v6 row_newbcast:14 row_mask:0xf bank_mask:0xf
v_and_b32_dpp v39, v25, v7 row_newbcast:14 row_mask:0xf bank_mask:0xf
s_nop 1
v_mfma_f32_16x16x32_bf16 v[16:19], v[36:39], a[216:219], v[16:19]
v_add_u32 v33, s68, v0
v_writelane_b32 v20, s62, 32
v_writelane_b32 v21, s63, 32
s_mov_b32 exec_lo, 0xffffffff
s_mov_b32 exec_hi, 0x1
ds_write_b128 v33, v[20:23] offset:2112
s_mov_b64 exec, -1
s_waitcnt vmcnt(8)
s_cmp_lt_u32 s86, 1
s_cbranch_scc1 1
s_waitcnt vmcnt(5)
buffer_load_dwordx4 a[252:255], v2, s[8:11], s44 offen nt
s_add_u32 s44, s44, 0x2000000
s_mov_b32 s88, s87
s_mov_b32 s87, s46
s_add_u32 s45, s44, s46
v_and_b32_dpp v40, v25, v4 row_newbcast:3 row_mask:0xf bank_mask:0xf
v_and_b32_dpp v41, v25, v5 row_newbcast:3 row_mask:0xf bank_mask:0xf
v_and_b32_dpp v42, v25, v6 row_newbcast:3 row_mask:0xf bank_mask:0xf
v_and_b32_dpp v43, v25, v7 row_newbcast:3 row_mask:0xf bank_mask:0xf
s_nop 1
v_mfma_f32_16x16x32_bf16 v[16:19], v[40:43], a[220:223], v[16:19]
s_mov_b32 s48, s49
s_add_u32 s49, s49, 4096
s_cmp_eq_u32 s49, 12288
s_cselect_b32 s49, 0, s49
s_sub_u32 s65, s65, 1
s_cmp_lg_u32 s65, 0
s_nop 0
s_cbranch_scc1 L_loop
buffer_load_dwordx4 v[12:15], v3, s[12:15], s51 offen sc1
s_waitcnt vmcnt(9)
v_and_b32_dpp v44, v25, v4 row_newbcast:7 row_mask:0xf bank_mask:0xf
v_and_b32_dpp v45, v25, v5 row_newbcast:7 row_mask:0xf bank_mask:0xf
v_and_b32_dpp v46, v25, v6 row_newbcast:7 row_mask:0xf bank_mask:0xf
v_and_b32_dpp v47, v25, v7 row_newbcast:7 row_mask:0xf bank_mask:0xf
s_nop 1
v_mfma_f32_16x16x32_bf16 v[16:19], v[44:47], a[224:227], v[16:19]
s_waitcnt vmcnt(8)
v_and_b32_dpp v48, v25, v4 row_newbcast:11 row_mask:0xf bank_mask:0xf
v_and_b32_dpp v49, v25, v5 row_newbcast:11 row_mask:0xf bank_mask:0xf
v_and_b32_dpp v50, v25, v6 row_newbcast:11 row_mask:0xf bank_mask:0xf
v_and_b32_dpp v51, v25, v7 row_newbcast:11 row_mask:0xf bank_mask:0xf
s_nop 1
v_mfma_f32_16x16x32_bf16 v[16:19], v[48:51], a[228:231], v[16:19]
s_waitcnt vmcnt(7)
v_and_b32_dpp v36, v25, v4 row_newbcast:15 row_mask:0xf bank_mask:0xf
v_and_b32_dpp v37, v25, v5 row_newbcast:15 row_mask:0xf bank_mask:0xf
v_and_b32_dpp v38, v25, v6 row_newbcast:15 row_mask:0xf bank_mask:0xf
v_and_b32_dpp v39, v25, v7 row_newbcast:15 row_mask:0xf bank_mask:0xf
s_nop 1
v_mfma_f32_16x16x32_bf16 v[16:19], v[36:39], a[232:235], v[16:19]
s_waitcnt vmcnt(6)
v_and_b32_dpp v40, v26, v4 row_newbcast:0 row_mask:0xf bank_mask:0xf
v_and_b32_dpp v41, v26, v5 row_newbcast:0 row_mask:0xf bank_mask:0xf
v_and_b32_dpp v42, v26, v6 row_newbcast:0 row_mask:0xf bank_mask:0xf
v_and_b32_dpp v43, v26, v7 row_newbcast:0 row_mask:0xf bank_mask:0xf
s_nop 1
v_mfma_f32_16x16x32_bf16 v[16:19], v[40:43], a[236:239], v[16:19]
s_waitcnt vmcnt(4)
v_and_b32_dpp v44, v26, v4 row_newbcast:4 row_mask:0xf bank_mask:0xf
v_and_b32_dpp v45, v26, v5 row_newbcast:4 row_mask:0xf bank_mask:0xf
v_and_b32_dpp v46, v26, v6 row_newbcast:4 row_mask:0xf bank_mask:0xf
v_and_b32_dpp v47, v26, v7 row_newbcast:4 row_mask:0xf bank_mask:0xf
s_nop 1
v_mfma_f32_16x16x32_bf16 v[16:19], v[44:47], a[240:243], v[16:19]
s_waitcnt vmcnt(3)
v_and_b32_dpp v48, v26, v4 row_newbcast:8 row_mask:0xf bank_mask:0xf
v_and_b32_dpp v49, v26, v5 row_newbcast:8 row_mask:0xf bank_mask:0xf
v_and_b32_dpp v50, v26, v6 row_newbcast:8 row_mask:0xf bank_mask:0xf
v_and_b32_dpp v51, v26, v7 row_newbcast:8 row_mask:0xf bank_mask:0xf
s_nop 1
v_mfma_f32_16x16x32_bf16 v[16:19], v[48:51], a[244:247], v[16:19]
s_waitcnt vmcnt(2)
v_and_b32_dpp v36, v26, v4 row_newbcast:12 row_mask:0xf bank_mask:0xf
v_and_b32_dpp v37, v26, v5 row_newbcast:12 row_mask:0xf bank_mask:0xf
v_and_b32_dpp v38, v26, v6 row_newbcast:12 row_mask:0xf bank_mask:0xf
v_and_b32_dpp v39, v26, v7 row_newbcast:12 row_mask:0xf bank_mask:0xf
s_nop 1
v_mfma_f32_16x16x32_bf16 v[16:19], v[36:39], a[248:251], v[16:19]
s_waitcnt vmcnt(1)
v_and_b32_dpp v40, v26, v4 row_newbcast:1 row_mask:0xf bank_mask:0xf
v_and_b32_dpp v41, v26, v5 row_newbcast:1 row_mask:0xf bank_mask:0xf
v_and_b32_dpp v42, v26, v6 row_newbcast:1 row_mask:0xf bank_mask:0xf
v_and_b32_dpp v43, v26, v7 row_newbcast:1 row_mask:0xf bank_mask:0xf
s_nop 1
v_mfma_f32_16x16x32_bf16 v[16:19], v[40:43], a[252:255], v[16:19]
v_add_u32 v33, s68, v0
s_nop 6
v_writelane_b32 v16, s60, 32
v_writelane_b32 v17, s61, 32
s_mov_b32 exec_lo, 0xffffffff
s_mov_b32 exec_hi, 0x1
ds_write_b128 v33, v[16:19] offset:0
s_mov_b64 exec, -1
v_mov_b32 v34, s85
v_add_u32 v33, s85, v0
s_bitcmp1_b32 s40, 1
s_waitcnt lgkmcnt(0)
s_barrier
s_cbranch_scc0 Lp34
ds_read_b64 v[52:53], v34 offset:512
ds_read_b64 v[54:55], v34 offset:1040
ds_read_b64 v[16:17], v34 offset:1568
ds_read_b64 v[18:19], v34 offset:2096
s_mov_b32 exec_lo, 0xffffffff
s_mov_b32 exec_hi, 0x0
ds_read_b128 v[36:39], v33 offset:0
ds_read_b128 v[40:43], v33 offset:528
ds_read_b128 v[44:47], v33 offset:1056
ds_read_b128 v[48:51], v33 offset:1584
s_mov_b64 exec, -1
s_waitcnt lgkmcnt(4)
v_max3_f32 v33, v52, v54, v16
v_max_f32 v33, v33, v18
v_sub_f32 v52, v52, v33
v_sub_f32 v54, v54, v33
v_sub_f32 v16, v16, v33
v_sub_f32 v18, v18, v33
v_exp_f32 v52, v52
v_exp_f32 v54, v54
v_exp_f32 v16, v16
v_exp_f32 v18, v18
v_mul_f32 v35, v52, v53
v_fmac_f32 v35, v54, v55
v_fmac_f32 v35, v16, v17
v_fmac_f32 v35, v18, v19
s_waitcnt lgkmcnt(0)
v_mul_f32 v36, v52, v36
v_mul_f32 v37, v52, v37
v_mul_f32 v38, v52, v38
v_mul_f32 v39, v52, v39
v_fmac_f32 v36, v54, v40
v_fmac_f32 v37, v54, v41
v_fmac_f32 v38, v54, v42
v_fmac_f32 v39, v54, v43
v_fmac_f32 v36, v16, v44
v_fmac_f32 v37, v16, v45
v_fmac_f32 v38, v16, v46
v_fmac_f32 v39, v16, v47
v_fmac_f32 v36, v18, v48
v_fmac_f32 v37, v18, v49
v_fmac_f32 v38, v18, v50
v_fmac_f32 v39, v18, v51
v_cvt_pk_bf16_f32 v36, v36, v37
v_cvt_pk_bf16_f32 v37, v38, v39
s_mov_b32 exec_lo, 0x0
s_mov_b32 exec_hi, 0xff
v_mov_b32 v36, v33
v_or_b32 v37, s83, v35
s_mov_b32 exec_lo, -1
v_and_or_b32 v36, v36, -2, s89
v_and_or_b32 v37, v37, -2, s89
s_cmp_lg_u32 s83, 0
s_cbranch_scc1 Lp35
buffer_store_dwordx2 v[36:37], v32, s[12:15], s52 offen
s_branch Lp36
Lp35:
buffer_store_dwordx2 v[36:37], v32, s[12:15], s52 offen sc1
Lp36:
s_mov_b64 exec, -1
Lp34:
s_xor_b32 s52, s52, 640
s_xor_b32 s89, s89, 1
s_waitcnt vmcnt(0)
Lq37:
v_max3_u32 v33, v12, v13, v14
v_max_u32 v33, v33, v15
v_cmp_eq_u32 vcc, -1, v33
s_nop 0
s_cbranch_vccz Lq38
s_sleep 1
buffer_load_dwordx4 v[12:15], v3, s[12:15], s51 offen sc1
s_waitcnt vmcnt(0)
s_sub_u32 s64, s64, 1
s_cmp_gt_i32 s64, 0
s_cbranch_scc1 Lq37
Lq38:
s_add_u32 s51, s51, 256
v_add_u32 v33, s49, v1
ds_read_b128 v[36:39], v33 offset:0
ds_read_b128 v[40:43], v33 offset:1024
ds_read_b128 v[44:47], v33 offset:2048
ds_read_b128 v[48:51], v33 offset:3072
s_waitcnt lgkmcnt(0)
v_dot2_f32_bf16 v52, v36, v12, 0
v_dot2_f32_bf16 v53, v40, v12, 0
v_dot2_f32_bf16 v54, v44, v12, 0
v_dot2_f32_bf16 v55, v48, v12, 0
v_dot2c_f32_bf16 v52, v37, v13
v_dot2c_f32_bf16 v53, v41, v13
v_dot2c_f32_bf16 v54, v45, v13
v_dot2c_f32_bf16 v55, v49, v13
v_dot2c_f32_bf16 v52, v38, v14
v_dot2c_f32_bf16 v53, v42, v14
v_dot2c_f32_bf16 v54, v46, v14
v_dot2c_f32_bf16 v55, v50, v14
v_dot2c_f32_bf16 v52, v39, v15
v_dot2c_f32_bf16 v53, v43, v15
v_dot2c_f32_bf16 v54, v47, v15
v_dot2c_f32_bf16 v55, v51, v15
v_add_f32_dpp v33, v52, v52 row_ror:8 row_mask:0xf bank_mask:0x3
v_add_f32_dpp v34, v53, v53 row_ror:8 row_mask:0xf bank_mask:0x3
v_add_f32_dpp v33, v54, v54 row_ror:8 row_mask:0xf bank_mask:0xc
v_add_f32_dpp v34, v55, v55 row_ror:8 row_mask:0xf bank_mask:0xc
s_nop 0
v_add_f32_dpp v28, v33, v33 row_half_mirror row_mask:0xf bank_mask:0x5
v_add_f32_dpp v28, v34, v34 row_half_mirror row_mask:0xf bank_mask:0xa
ds_read_b128 v[36:39], v1 offset:12288
ds_read_b128 v[40:43], v1 offset:13312
ds_read_b128 v[44:47], v1 offset:14336
ds_read_b128 v[48:51], v1 offset:15360
s_waitcnt lgkmcnt(0)
v_dot2_f32_bf16 v52, v36, v12, 0
v_dot2_f32_bf16 v53, v40, v12, 0
v_dot2_f32_bf16 v54, v44, v12, 0
v_dot2_f32_bf16 v55, v48, v12, 0
v_dot2c_f32_bf16 v52, v37, v13
v_dot2c_f32_bf16 v53, v41, v13
v_dot2c_f32_bf16 v54, v45, v13
v_dot2c_f32_bf16 v55, v49, v13
v_dot2c_f32_bf16 v52, v38, v14
v_dot2c_f32_bf16 v53, v42, v14
v_dot2c_f32_bf16 v54, v46, v14
v_dot2c_f32_bf16 v55, v50, v14
v_dot2c_f32_bf16 v52, v39, v15
v_dot2c_f32_bf16 v53, v43, v15
v_dot2c_f32_bf16 v54, v47, v15
v_dot2c_f32_bf16 v55, v51, v15
v_add_f32_dpp v33, v52, v52 row_ror:8 row_mask:0xf bank_mask:0x3
v_add_f32_dpp v34, v53, v53 row_ror:8 row_mask:0xf bank_mask:0x3
v_add_f32_dpp v33, v54, v54 row_ror:8 row_mask:0xf bank_mask:0xc
v_add_f32_dpp v34, v55, v55 row_ror:8 row_mask:0xf bank_mask:0xc
s_nop 0
v_add_f32_dpp v35, v33, v33 row_half_mirror row_mask:0xf bank_mask:0x5
v_add_f32_dpp v35, v34, v34 row_half_mirror row_mask:0xf bank_mask:0xa
v_cndmask_b32 v33, v28, v35, s[54:55]
v_cndmask_b32 v34, v35, v28, s[54:55]
s_nop 1
v_add_f32_dpp v28, v34, v33 quad_perm:[1,0,3,2] row_mask:0xf bank_mask:0xf
ds_read_b128 v[36:39], v1 offset:16384
ds_read_b128 v[40:43], v1 offset:17408
ds_read_b128 v[44:47], v1 offset:18432
ds_read_b128 v[48:51], v1 offset:19456
s_waitcnt lgkmcnt(0)
v_dot2_f32_bf16 v52, v36, v12, 0
v_dot2_f32_bf16 v53, v40, v12, 0
v_dot2_f32_bf16 v54, v44, v12, 0
v_dot2_f32_bf16 v55, v48, v12, 0
v_dot2c_f32_bf16 v52, v37, v13
v_dot2c_f32_bf16 v53, v41, v13
v_dot2c_f32_bf16 v54, v45, v13
v_dot2c_f32_bf16 v55, v49, v13
v_dot2c_f32_bf16 v52, v38, v14
v_dot2c_f32_bf16 v53, v42, v14
v_dot2c_f32_bf16 v54, v46, v14
v_dot2c_f32_bf16 v55, v50, v14
v_dot2c_f32_bf16 v52, v39, v15
v_dot2c_f32_bf16 v53, v43, v15
v_dot2c_f32_bf16 v54, v47, v15
v_dot2c_f32_bf16 v55, v51, v15
v_add_f32_dpp v33, v52, v52 row_ror:8 row_mask:0xf bank_mask:0x3
v_add_f32_dpp v34, v53, v53 row_ror:8 row_mask:0xf bank_mask:0x3
v_add_f32_dpp v33, v54, v54 row_ror:8 row_mask:0xf bank_mask:0xc
v_add_f32_dpp v34, v55, v55 row_ror:8 row_mask:0xf bank_mask:0xc
s_nop 0
v_add_f32_dpp v31, v33, v33 row_half_mirror row_mask:0xf bank_mask:0x5
v_add_f32_dpp v31, v34, v34 row_half_mirror row_mask:0xf bank_mask:0xa
ds_read_b128 v[36:39], v1 offset:20480
ds_read_b128 v[40:43], v1 offset:21504
ds_read_b128 v[44:47], v1 offset:22528
ds_read_b128 v[48:51], v1 offset:23552
s_waitcnt lgkmcnt(0)
v_dot2_f32_bf16 v52, v36, v12, 0
v_dot2_f32_bf16 v53, v40, v12, 0
v_dot2_f32_bf16 v54, v44, v12, 0
v_dot2_f32_bf16 v55, v48, v12, 0
v_dot2c_f32_bf16 v52, v37, v13
v_dot2c_f32_bf16 v53, v41, v13
v_dot2c_f32_bf16 v54, v45, v13
v_dot2c_f32_bf16 v55, v49, v13
v_dot2c_f32_bf16 v52, v38, v14
v_dot2c_f32_bf16 v53, v42, v14
v_dot2c_f32_bf16 v54, v46, v14
v_dot2c_f32_bf16 v55, v50, v14
v_dot2c_f32_bf16 v52, v39, v15
v_dot2c_f32_bf16 v53, v43, v15
v_dot2c_f32_bf16 v54, v47, v15
v_dot2c_f32_bf16 v55, v51, v15
v_add_f32_dpp v33, v52, v52 row_ror:8 row_mask:0xf bank_mask:0x3
v_add_f32_dpp v34, v53, v53 row_ror:8 row_mask:0xf bank_mask:0x3
v_add_f32_dpp v33, v54, v54 row_ror:8 row_mask:0xf bank_mask:0xc
v_add_f32_dpp v34, v55, v55 row_ror:8 row_mask:0xf bank_mask:0xc
s_nop 0
v_add_f32_dpp v35, v33, v33 row_half_mirror row_mask:0xf bank_mask:0x5
v_add_f32_dpp v35, v34, v34 row_half_mirror row_mask:0xf bank_mask:0xa
v_cndmask_b32 v33, v31, v35, s[54:55]
v_cndmask_b32 v34, v35, v31, s[54:55]
s_nop 1
v_add_f32_dpp v31, v34, v33 quad_perm:[1,0,3,2] row_mask:0xf bank_mask:0xf
v_cndmask_b32 v33, v28, v31, s[56:57]
v_cndmask_b32 v34, v31, v28, s[56:57]
s_nop 1
v_add_f32_dpp v28, v34, v33 quad_perm:[2,3,0,1] row_mask:0xf bank_mask:0xf
v_dot2_f32_bf16 v52, v56, v12, 0
v_dot2_f32_bf16 v53, v60, v12, 0
v_dot2_f32_bf16 v54, v64, v12, 0
v_dot2_f32_bf16 v55, v68, v12, 0
v_dot2c_f32_bf16 v52, v57, v13
v_dot2c_f32_bf16 v53, v61, v13
v_dot2c_f32_bf16 v54, v65, v13
v_dot2c_f32_bf16 v55, v69, v13
v_dot2c_f32_bf16 v52, v58, v14
v_dot2c_f32_bf16 v53, v62, v14
v_dot2c_f32_bf16 v54, v66, v14
v_dot2c_f32_bf16 v55, v70, v14
v_dot2c_f32_bf16 v52, v59, v15
v_dot2c_f32_bf16 v53, v63, v15
v_dot2c_f32_bf16 v54, v67, v15
v_dot2c_f32_bf16 v55, v71, v15
v_add_f32_dpp v33, v52, v52 row_ror:8 row_mask:0xf bank_mask:0x3
v_add_f32_dpp v34, v53, v53 row_ror:8 row_mask:0xf bank_mask:0x3
v_add_f32_dpp v33, v54, v54 row_ror:8 row_mask:0xf bank_mask:0xc
v_add_f32_dpp v34, v55, v55 row_ror:8 row_mask:0xf bank_mask:0xc
s_nop 0
v_add_f32_dpp v29, v33, v33 row_half_mirror row_mask:0xf bank_mask:0x5
v_add_f32_dpp v29, v34, v34 row_half_mirror row_mask:0xf bank_mask:0xa
v_dot2_f32_bf16 v52, v72, v12, 0
v_dot2_f32_bf16 v53, v76, v12, 0
v_dot2_f32_bf16 v54, v80, v12, 0
v_dot2_f32_bf16 v55, v84, v12, 0
v_dot2c_f32_bf16 v52, v73, v13
v_dot2c_f32_bf16 v53, v77, v13
v_dot2c_f32_bf16 v54, v81, v13
v_dot2c_f32_bf16 v55, v85, v13
v_dot2c_f32_bf16 v52, v74, v14
v_dot2c_f32_bf16 v53, v78, v14
v_dot2c_f32_bf16 v54, v82, v14
v_dot2c_f32_bf16 v55, v86, v14
v_dot2c_f32_bf16 v52, v75, v15
v_dot2c_f32_bf16 v53, v79, v15
v_dot2c_f32_bf16 v54, v83, v15
v_dot2c_f32_bf16 v55, v87, v15
v_add_f32_dpp v33, v52, v52 row_ror:8 row_mask:0xf bank_mask:0x3
v_add_f32_dpp v34, v53, v53 row_ror:8 row_mask:0xf bank_mask:0x3
v_add_f32_dpp v33, v54, v54 row_ror:8 row_mask:0xf bank_mask:0xc
v_add_f32_dpp v34, v55, v55 row_ror:8 row_mask:0xf bank_mask:0xc
s_nop 0
v_add_f32_dpp v35, v33, v33 row_half_mirror row_mask:0xf bank_mask:0x5
v_add_f32_dpp v35, v34, v34 row_half_mirror row_mask:0xf bank_mask:0xa
v_cndmask_b32 v33, v29, v35, s[54:55]
v_cndmask_b32 v34, v35, v29, s[54:55]
s_nop 1
v_add_f32_dpp v29, v34, v33 quad_perm:[1,0,3,2] row_mask:0xf bank_mask:0xf
v_dot2_f32_bf16 v52, v88, v12, 0
v_dot2_f32_bf16 v53, v92, v12, 0
v_dot2_f32_bf16 v54, v96, v12, 0
v_dot2_f32_bf16 v55, v100, v12, 0
v_dot2c_f32_bf16 v52, v89, v13
v_dot2c_f32_bf16 v53, v93, v13
v_dot2c_f32_bf16 v54, v97, v13
v_dot2c_f32_bf16 v55, v101, v13
v_dot2c_f32_bf16 v52, v90, v14
v_dot2c_f32_bf16 v53, v94, v14
v_dot2c_f32_bf16 v54, v98, v14
v_dot2c_f32_bf16 v55, v102, v14
v_dot2c_f32_bf16 v52, v91, v15
v_dot2c_f32_bf16 v53, v95, v15
v_dot2c_f32_bf16 v54, v99, v15
v_dot2c_f32_bf16 v55, v103, v15
v_add_f32_dpp v33, v52, v52 row_ror:8 row_mask:0xf bank_mask:0x3
v_add_f32_dpp v34, v53, v53 row_ror:8 row_mask:0xf bank_mask:0x3
v_add_f32_dpp v33, v54, v54 row_ror:8 row_mask:0xf bank_mask:0xc
v_add_f32_dpp v34, v55, v55 row_ror:8 row_mask:0xf bank_mask:0xc
s_nop 0
v_add_f32_dpp v31, v33, v33 row_half_mirror row_mask:0xf bank_mask:0x5
v_add_f32_dpp v31, v34, v34 row_half_mirror row_mask:0xf bank_mask:0xa
v_dot2_f32_bf16 v52, v104, v12, 0
v_dot2_f32_bf16 v53, v108, v12, 0
v_dot2_f32_bf16 v54, v112, v12, 0
v_dot2_f32_bf16 v55, v116, v12, 0
v_dot2c_f32_bf16 v52, v105, v13
v_dot2c_f32_bf16 v53, v109, v13
v_dot2c_f32_bf16 v54, v113, v13
v_dot2c_f32_bf16 v55, v117, v13
v_dot2c_f32_bf16 v52, v106, v14
v_dot2c_f32_bf16 v53, v110, v14
v_dot2c_f32_bf16 v54, v114, v14
v_dot2c_f32_bf16 v55, v118, v14
v_dot2c_f32_bf16 v52, v107, v15
v_dot2c_f32_bf16 v53, v111, v15
v_dot2c_f32_bf16 v54, v115, v15
v_dot2c_f32_bf16 v55, v119, v15
v_add_f32_dpp v33, v52, v52 row_ror:8 row_mask:0xf bank_mask:0x3
v_add_f32_dpp v34, v53, v53 row_ror:8 row_mask:0xf bank_mask:0x3
v_add_f32_dpp v33, v54, v54 row_ror:8 row_mask:0xf bank_mask:0xc
v_add_f32_dpp v34, v55, v55 row_ror:8 row_mask:0xf bank_mask:0xc
s_nop 0
v_add_f32_dpp v35, v33, v33 row_half_mirror row_mask:0xf bank_mask:0x5
v_add_f32_dpp v35, v34, v34 row_half_mirror row_mask:0xf bank_mask:0xa
v_cndmask_b32 v33, v31, v35, s[54:55]
v_cndmask_b32 v34, v35, v31, s[54:55]
s_nop 1
v_add_f32_dpp v31, v34, v33 quad_perm:[1,0,3,2] row_mask:0xf bank_mask:0xf
v_cndmask_b32 v33, v29, v31, s[56:57]
v_cndmask_b32 v34, v31, v29, s[56:57]
s_nop 1
v_add_f32_dpp v29, v34, v33 quad_perm:[2,3,0,1] row_mask:0xf bank_mask:0xf
v_dot2_f32_bf16 v52, v120, v12, 0
v_dot2_f32_bf16 v53, v124, v12, 0
v_dot2_f32_bf16 v54, v128, v12, 0
v_dot2_f32_bf16 v55, v132, v12, 0
v_dot2c_f32_bf16 v52, v121, v13
v_dot2c_f32_bf16 v53, v125, v13
v_dot2c_f32_bf16 v54, v129, v13
v_dot2c_f32_bf16 v55, v133, v13
v_dot2c_f32_bf16 v52, v122, v14
v_dot2c_f32_bf16 v53, v126, v14
v_dot2c_f32_bf16 v54, v130, v14
v_dot2c_f32_bf16 v55, v134, v14
v_dot2c_f32_bf16 v52, v123, v15
v_dot2c_f32_bf16 v53, v127, v15
v_dot2c_f32_bf16 v54, v131, v15
v_dot2c_f32_bf16 v55, v135, v15
v_add_f32_dpp v33, v52, v52 row_ror:8 row_mask:0xf bank_mask:0x3
v_add_f32_dpp v34, v53, v53 row_ror:8 row_mask:0xf bank_mask:0x3
v_add_f32_dpp v33, v54, v54 row_ror:8 row_mask:0xf bank_mask:0xc
v_add_f32_dpp v34, v55, v55 row_ror:8 row_mask:0xf bank_mask:0xc
s_nop 0
v_add_f32_dpp v30, v33, v33 row_half_mirror row_mask:0xf bank_mask:0x5
v_add_f32_dpp v30, v34, v34 row_half_mirror row_mask:0xf bank_mask:0xa
ds_read_b128 v[36:39], v1 offset:24576
s_waitcnt lgkmcnt(0)
v_dot2_f32_bf16 v52, v36, v12, 0
v_dot2_f32_bf16 v52, v37, v13, v52
v_dot2_f32_bf16 v52, v38, v14, v52
v_dot2_f32_bf16 v52, v39, v15, v52
s_nop 2
v_add_f32_dpp v33, v52, v52 row_ror:8 row_mask:0xf bank_mask:0xf
s_nop 1
v_add_f32_dpp v35, v33, v33 row_half_mirror row_mask:0xf bank_mask:0xf
v_cndmask_b32 v33, v30, v35, s[54:55]
v_cndmask_b32 v34, v35, v30, s[54:55]
s_nop 1
v_add_f32_dpp v30, v34, v33 quad_perm:[1,0,3,2] row_mask:0xf bank_mask:0xf
s_nop 1
v_add_f32_dpp v30, v30, v30 quad_perm:[2,3,0,1] row_mask:0xf bank_mask:0xf
buffer_load_dwordx4 v[12:15], v3, s[12:15], s51 offen sc1
v_mul_f32 v28, 0x3e0293ee, v28
v_mul_f32 v29, 0x3e0293ee, v29
v_mul_f32 v30, 0x3e0293ee, v30
v_mov_b32 v34, 0xff800000
v_cndmask_b32 v30, v34, v30, s[58:59]
v_max3_f32 v33, v28, v29, v30
s_nop 1
v_max_f32_dpp v33, v33, v33 quad_perm:[1,0,3,2] row_mask:0xf bank_mask:0xf
s_nop 1
v_max_f32_dpp v33, v33, v33 quad_perm:[2,3,0,1] row_mask:0xf bank_mask:0xf
s_nop 1
v_max_f32_dpp v33, v33, v33 row_ror:4 row_mask:0xf bank_mask:0xf
s_nop 1
v_max_f32_dpp v33, v33, v33 row_ror:8 row_mask:0xf bank_mask:0xf
s_nop 1
v_max_f32_dpp v33, v33, v33 row_bcast:15 row_mask:0xa bank_mask:0xf
s_nop 1
v_max_f32_dpp v33, v33, v33 row_bcast:31 row_mask:0xc bank_mask:0xf
s_nop 0
v_readlane_b32 s62, v33, 63
s_nop 1
v_subrev_f32 v28, s62, v28
v_subrev_f32 v29, s62, v29
v_subrev_f32 v30, s62, v30
v_exp_f32 v28, v28
v_exp_f32 v29, v29
v_exp_f32 v30, v30
v_add_f32 v33, v28, v29
v_add_f32 v33, v33, v30
v_cvt_pk_bf16_f32 v28, v28, v28
v_cvt_pk_bf16_f32 v29, v29, v29
v_cvt_pk_bf16_f32 v30, v30, v30
v_add_f32_dpp v33, v33, v33 quad_perm:[1,0,3,2] row_mask:0xf bank_mask:0xf
s_nop 1
v_add_f32_dpp v33, v33, v33 quad_perm:[2,3,0,1] row_mask:0xf bank_mask:0xf
s_nop 1
v_add_f32_dpp v33, v33, v33 row_ror:4 row_mask:0xf bank_mask:0xf
s_nop 1
v_add_f32_dpp v33, v33, v33 row_ror:8 row_mask:0xf bank_mask:0xf
s_nop 1
v_add_f32_dpp v33, v33, v33 row_bcast:15 row_mask:0xa bank_mask:0xf
s_nop 1
v_add_f32_dpp v33, v33, v33 row_bcast:31 row_mask:0xc bank_mask:0xf
s_nop 0
v_readlane_b32 s63, v33, 63
v_and_b32_dpp v44, v28, v4 row_newbcast:0 row_mask:0xf bank_mask:0xf
v_and_b32_dpp v45, v28, v5 row_newbcast:0 row_mask:0xf bank_mask:0xf
v_and_b32_dpp v46, v28, v6 row_newbcast:0 row_mask:0xf bank_mask:0xf
v_and_b32_dpp v47, v28, v7 row_newbcast:0 row_mask:0xf bank_mask:0xf
v_and_b32_dpp v48, v28, v4 row_newbcast:4 row_mask:0xf bank_mask:0xf
v_and_b32_dpp v49, v28, v5 row_newbcast:4 row_mask:0xf bank_mask:0xf
v_and_b32_dpp v50, v28, v6 row_newbcast:4 row_mask:0xf bank_mask:0xf
v_and_b32_dpp v51, v28, v7 row_newbcast:4 row_mask:0xf bank_mask:0xf
v_mfma_f32_16x16x32_bf16 v[20:23], v[44:47], v[136:139], 0
v_and_b32_dpp v36, v28, v4 row_newbcast:8 row_mask:0xf bank_mask:0xf
v_and_b32_dpp v37, v28, v5 row_newbcast:8 row_mask:0xf bank_mask:0xf
v_and_b32_dpp v38, v28, v6 row_newbcast:8 row_mask:0xf bank_mask:0xf
v_and_b32_dpp v39, v28, v7 row_newbcast:8 row_mask:0xf bank_mask:0xf
v_mfma_f32_16x16x32_bf16 v[20:23], v[48:51], v[140:143], v[20:23]
v_and_b32_dpp v40, v28, v4 row_newbcast:12 row_mask:0xf bank_mask:0xf
v_and_b32_dpp v41, v28, v5 row_newbcast:12 row_mask:0xf bank_mask:0xf
v_and_b32_dpp v42, v28, v6 row_newbcast:12 row_mask:0xf bank_mask:0xf
v_and_b32_dpp v43, v28, v7 row_newbcast:12 row_mask:0xf bank_mask:0xf
v_mfma_f32_16x16x32_bf16 v[20:23], v[36:39], v[144:147], v[20:23]
v_and_b32_dpp v44, v28, v4 row_newbcast:1 row_mask:0xf bank_mask:0xf
v_and_b32_dpp v45, v28, v5 row_newbcast:1 row_mask:0xf bank_mask:0xf
v_and_b32_dpp v46, v28, v6 row_newbcast:1 row_mask:0xf bank_mask:0xf
v_and_b32_dpp v47, v28, v7 row_newbcast:1 row_mask:0xf bank_mask:0xf
v_mfma_f32_16x16x32_bf16 v[20:23], v[40:43], v[148:151], v[20:23]
v_and_b32_dpp v48, v28, v4 row_newbcast:5 row_mask:0xf bank_mask:0xf
v_and_b32_dpp v49, v28, v5 row_newbcast:5 row_mask:0xf bank_mask:0xf
v_and_b32_dpp v50, v28, v6 row_newbcast:5 row_mask:0xf bank_mask:0xf
v_and_b32_dpp v51, v28, v7 row_newbcast:5 row_mask:0xf bank_mask:0xf
v_mfma_f32_16x16x32_bf16 v[20:23], v[44:47], v[152:155], v[20:23]
v_and_b32_dpp v36, v28, v4 row_newbcast:9 row_mask:0xf bank_mask:0xf
v_and_b32_dpp v37, v28, v5 row_newbcast:9 row_mask:0xf bank_mask:0xf
v_and_b32_dpp v38, v28, v6 row_newbcast:9 row_mask:0xf bank_mask:0xf
v_and_b32_dpp v39, v28, v7 row_newbcast:9 row_mask:0xf bank_mask:0xf
v_mfma_f32_16x16x32_bf16 v[20:23], v[48:51], a[0:3], v[20:23]
v_and_b32_dpp v40, v28, v4 row_newbcast:13 row_mask:0xf bank_mask:0xf
v_and_b32_dpp v41, v28, v5 row_newbcast:13 row_mask:0xf bank_mask:0xf
v_and_b32_dpp v42, v28, v6 row_newbcast:13 row_mask:0xf bank_mask:0xf
v_and_b32_dpp v43, v28, v7 row_newbcast:13 row_mask:0xf bank_mask:0xf
v_mfma_f32_16x16x32_bf16 v[20:23], v[36:39], a[4:7], v[20:23]
v_and_b32_dpp v44, v28, v4 row_newbcast:2 row_mask:0xf bank_mask:0xf
v_and_b32_dpp v45, v28, v5 row_newbcast:2 row_mask:0xf bank_mask:0xf
v_and_b32_dpp v46, v28, v6 row_newbcast:2 row_mask:0xf bank_mask:0xf
v_and_b32_dpp v47, v28, v7 row_newbcast:2 row_mask:0xf bank_mask:0xf
v_mfma_f32_16x16x32_bf16 v[20:23], v[40:43], a[8:11], v[20:23]
v_and_b32_dpp v48, v28, v4 row_newbcast:6 row_mask:0xf bank_mask:0xf
v_and_b32_dpp v49, v28, v5 row_newbcast:6 row_mask:0xf bank_mask:0xf
v_and_b32_dpp v50, v28, v6 row_newbcast:6 row_mask:0xf bank_mask:0xf
v_and_b32_dpp v51, v28, v7 row_newbcast:6 row_mask:0xf bank_mask:0xf
v_mfma_f32_16x16x32_bf16 v[20:23], v[44:47], a[12:15], v[20:23]
v_and_b32_dpp v36, v28, v4 row_newbcast:10 row_mask:0xf bank_mask:0xf
v_and_b32_dpp v37, v28, v5 row_newbcast:10 row_mask:0xf bank_mask:0xf
v_and_b32_dpp v38, v28, v6 row_newbcast:10 row_mask:0xf bank_mask:0xf
v_and_b32_dpp v39, v28, v7 row_newbcast:10 row_mask:0xf bank_mask:0xf
v_mfma_f32_16x16x32_bf16 v[20:23], v[48:51], a[16:19], v[20:23]
v_and_b32_dpp v40, v28, v4 row_newbcast:14 row_mask:0xf bank_mask:0xf
v_and_b32_dpp v41, v28, v5 row_newbcast:14 row_mask:0xf bank_mask:0xf
v_and_b32_dpp v42, v28, v6 row_newbcast:14 row_mask:0xf bank_mask:0xf
v_and_b32_dpp v43, v28, v7 row_newbcast:14 row_mask:0xf bank_mask:0xf
v_mfma_f32_16x16x32_bf16 v[20:23], v[36:39], a[20:23], v[20:23]
v_and_b32_dpp v44, v28, v4 row_newbcast:3 row_mask:0xf bank_mask:0xf
v_and_b32_dpp v45, v28, v5 row_newbcast:3 row_mask:0xf bank_mask:0xf
v_and_b32_dpp v46, v28, v6 row_newbcast:3 row_mask:0xf bank_mask:0xf
v_and_b32_dpp v47, v28, v7 row_newbcast:3 row_mask:0xf bank_mask:0xf
v_mfma_f32_16x16x32_bf16 v[20:23], v[40:43], a[24:27], v[20:23]
v_and_b32_dpp v48, v28, v4 row_newbcast:7 row_mask:0xf bank_mask:0xf
v_and_b32_dpp v49, v28, v5 row_newbcast:7 row_mask:0xf bank_mask:0xf
v_and_b32_dpp v50, v28, v6 row_newbcast:7 row_mask:0xf bank_mask:0xf
v_and_b32_dpp v51, v28, v7 row_newbcast:7 row_mask:0xf bank_mask:0xf
v_mfma_f32_16x16x32_bf16 v[20:23], v[44:47], a[28:31], v[20:23]
v_and_b32_dpp v36, v28, v4 row_newbcast:11 row_mask:0xf bank_mask:0xf
v_and_b32_dpp v37, v28, v5 row_newbcast:11 row_mask:0xf bank_mask:0xf
v_and_b32_dpp v38, v28, v6 row_newbcast:11 row_mask:0xf bank_mask:0xf
v_and_b32_dpp v39, v28, v7 row_newbcast:11 row_mask:0xf bank_mask:0xf
v_mfma_f32_16x16x32_bf16 v[20:23], v[48:51], a[32:35], v[20:23]
v_and_b32_dpp v40, v28, v4 row_newbcast:15 row_mask:0xf bank_mask:0xf
v_and_b32_dpp v41, v28, v5 row_newbcast:15 row_mask:0xf bank_mask:0xf
v_and_b32_dpp v42, v28, v6 row_newbcast:15 row_mask:0xf bank_mask:0xf
v_and_b32_dpp v43, v28, v7 row_newbcast:15 row_mask:0xf bank_mask:0xf
v_mfma_f32_16x16x32_bf16 v[20:23], v[36:39], a[36:39], v[20:23]
v_and_b32_dpp v44, v29, v4 row_newbcast:0 row_mask:0xf bank_mask:0xf
v_and_b32_dpp v45, v29, v5 row_newbcast:0 row_mask:0xf bank_mask:0xf
v_and_b32_dpp v46, v29, v6 row_newbcast:0 row_mask:0xf bank_mask:0xf
v_and_b32_dpp v47, v29, v7 row_newbcast:0 row_mask:0xf bank_mask:0xf
v_mfma_f32_16x16x32_bf16 v[20:23], v[40:43], a[40:43], v[20:23]
v_and_b32_dpp v48, v29, v4 row_newbcast:4 row_mask:0xf bank_mask:0xf
v_and_b32_dpp v49, v29, v5 row_newbcast:4 row_mask:0xf bank_mask:0xf
v_and_b32_dpp v50, v29, v6 row_newbcast:4 row_mask:0xf bank_mask:0xf
v_and_b32_dpp v51, v29, v7 row_newbcast:4 row_mask:0xf bank_mask:0xf
v_mfma_f32_16x16x32_bf16 v[20:23], v[44:47], a[44:47], v[20:23]
v_and_b32_dpp v36, v29, v4 row_newbcast:8 row_mask:0xf bank_mask:0xf
v_and_b32_dpp v37, v29, v5 row_newbcast:8 row_mask:0xf bank_mask:0xf
v_and_b32_dpp v38, v29, v6 row_newbcast:8 row_mask:0xf bank_mask:0xf
v_and_b32_dpp v39, v29, v7 row_newbcast:8 row_mask:0xf bank_mask:0xf
v_mfma_f32_16x16x32_bf16 v[20:23], v[48:51], a[48:51], v[20:23]
v_and_b32_dpp v40, v29, v4 row_newbcast:12 row_mask:0xf bank_mask:0xf
v_and_b32_dpp v41, v29, v5 row_newbcast:12 row_mask:0xf bank_mask:0xf
v_and_b32_dpp v42, v29, v6 row_newbcast:12 row_mask:0xf bank_mask:0xf
v_and_b32_dpp v43, v29, v7 row_newbcast:12 row_mask:0xf bank_mask:0xf
v_mfma_f32_16x16x32_bf16 v[20:23], v[36:39], a[52:55], v[20:23]
v_and_b32_dpp v44, v29, v4 row_newbcast:1 row_mask:0xf bank_mask:0xf
v_and_b32_dpp v45, v29, v5 row_newbcast:1 row_mask:0xf bank_mask:0xf
v_and_b32_dpp v46, v29, v6 row_newbcast:1 row_mask:0xf bank_mask:0xf
v_and_b32_dpp v47, v29, v7 row_newbcast:1 row_mask:0xf bank_mask:0xf
v_mfma_f32_16x16x32_bf16 v[20:23], v[40:43], a[56:59], v[20:23]
v_and_b32_dpp v48, v29, v4 row_newbcast:5 row_mask:0xf bank_mask:0xf
v_and_b32_dpp v49, v29, v5 row_newbcast:5 row_mask:0xf bank_mask:0xf
v_and_b32_dpp v50, v29, v6 row_newbcast:5 row_mask:0xf bank_mask:0xf
v_and_b32_dpp v51, v29, v7 row_newbcast:5 row_mask:0xf bank_mask:0xf
v_mfma_f32_16x16x32_bf16 v[20:23], v[44:47], a[60:63], v[20:23]
v_and_b32_dpp v36, v29, v4 row_newbcast:9 row_mask:0xf bank_mask:0xf
v_and_b32_dpp v37, v29, v5 row_newbcast:9 row_mask:0xf bank_mask:0xf
v_and_b32_dpp v38, v29, v6 row_newbcast:9 row_mask:0xf bank_mask:0xf
v_and_b32_dpp v39, v29, v7 row_newbcast:9 row_mask:0xf bank_mask:0xf
v_mfma_f32_16x16x32_bf16 v[20:23], v[48:51], a[64:67], v[20:23]
v_and_b32_dpp v40, v29, v4 row_newbcast:13 row_mask:0xf bank_mask:0xf
v_and_b32_dpp v41, v29, v5 row_newbcast:13 row_mask:0xf bank_mask:0xf
v_and_b32_dpp v42, v29, v6 row_newbcast:13 row_mask:0xf bank_mask:0xf
v_and_b32_dpp v43, v29, v7 row_newbcast:13 row_mask:0xf bank_mask:0xf
v_mfma_f32_16x16x32_bf16 v[20:23], v[36:39], a[68:71], v[20:23]
v_and_b32_dpp v44, v29, v4 row_newbcast:2 row_mask:0xf bank_mask:0xf
v_and_b32_dpp v45, v29, v5 row_newbcast:2 row_mask:0xf bank_mask:0xf
v_and_b32_dpp v46, v29, v6 row_newbcast:2 row_mask:0xf bank_mask:0xf
v_and_b32_dpp v47, v29, v7 row_newbcast:2 row_mask:0xf bank_mask:0xf
v_mfma_f32_16x16x32_bf16 v[20:23], v[40:43], a[72:75], v[20:23]
v_and_b32_dpp v48, v29, v4 row_newbcast:6 row_mask:0xf bank_mask:0xf
v_and_b32_dpp v49, v29, v5 row_newbcast:6 row_mask:0xf bank_mask:0xf
v_and_b32_dpp v50, v29, v6 row_newbcast:6 row_mask:0xf bank_mask:0xf
v_and_b32_dpp v51, v29, v7 row_newbcast:6 row_mask:0xf bank_mask:0xf
v_mfma_f32_16x16x32_bf16 v[20:23], v[44:47], a[76:79], v[20:23]
v_and_b32_dpp v36, v29, v4 row_newbcast:10 row_mask:0xf bank_mask:0xf
v_and_b32_dpp v37, v29, v5 row_newbcast:10 row_mask:0xf bank_mask:0xf
v_and_b32_dpp v38, v29, v6 row_newbcast:10 row_mask:0xf bank_mask:0xf
v_and_b32_dpp v39, v29, v7 row_newbcast:10 row_mask:0xf bank_mask:0xf
v_mfma_f32_16x16x32_bf16 v[20:23], v[48:51], a[80:83], v[20:23]
v_and_b32_dpp v40, v29, v4 row_newbcast:14 row_mask:0xf bank_mask:0xf
v_and_b32_dpp v41, v29, v5 row_newbcast:14 row_mask:0xf bank_mask:0xf
v_and_b32_dpp v42, v29, v6 row_newbcast:14 row_mask:0xf bank_mask:0xf
v_and_b32_dpp v43, v29, v7 row_newbcast:14 row_mask:0xf bank_mask:0xf
v_mfma_f32_16x16x32_bf16 v[20:23], v[36:39], a[84:87], v[20:23]
v_and_b32_dpp v44, v29, v4 row_newbcast:3 row_mask:0xf bank_mask:0xf
v_and_b32_dpp v45, v29, v5 row_newbcast:3 row_mask:0xf bank_mask:0xf
v_and_b32_dpp v46, v29, v6 row_newbcast:3 row_mask:0xf bank_mask:0xf
v_and_b32_dpp v47, v29, v7 row_newbcast:3 row_mask:0xf bank_mask:0xf
v_mfma_f32_16x16x32_bf16 v[20:23], v[40:43], a[88:91], v[20:23]
v_and_b32_dpp v48, v29, v4 row_newbcast:7 row_mask:0xf bank_mask:0xf
v_and_b32_dpp v49, v29, v5 row_newbcast:7 row_mask:0xf bank_mask:0xf
v_and_b32_dpp v50, v29, v6 row_newbcast:7 row_mask:0xf bank_mask:0xf
v_and_b32_dpp v51, v29, v7 row_newbcast:7 row_mask:0xf bank_mask:0xf
v_mfma_f32_16x16x32_bf16 v[20:23], v[44:47], a[92:95], v[20:23]
v_and_b32_dpp v36, v29, v4 row_newbcast:11 row_mask:0xf bank_mask:0xf
v_and_b32_dpp v37, v29, v5 row_newbcast:11 row_mask:0xf bank_mask:0xf
v_and_b32_dpp v38, v29, v6 row_newbcast:11 row_mask:0xf bank_mask:0xf
v_and_b32_dpp v39, v29, v7 row_newbcast:11 row_mask:0xf bank_mask:0xf
v_mfma_f32_16x16x32_bf16 v[20:23], v[48:51], a[96:99], v[20:23]
v_and_b32_dpp v40, v29, v4 row_newbcast:15 row_mask:0xf bank_mask:0xf
v_and_b32_dpp v41, v29, v5 row_newbcast:15 row_mask:0xf bank_mask:0xf
v_and_b32_dpp v42, v29, v6 row_newbcast:15 row_mask:0xf bank_mask:0xf
v_and_b32_dpp v43, v29, v7 row_newbcast:15 row_mask:0xf bank_mask:0xf
v_mfma_f32_16x16x32_bf16 v[20:23], v[36:39], a[100:103], v[20:23]
v_and_b32_dpp v44, v30, v4 row_newbcast:0 row_mask:0xf bank_mask:0xf
v_and_b32_dpp v45, v30, v5 row_newbcast:0 row_mask:0xf bank_mask:0xf
v_and_b32_dpp v46, v30, v6 row_newbcast:0 row_mask:0xf bank_mask:0xf
v_and_b32_dpp v47, v30, v7 row_newbcast:0 row_mask:0xf bank_mask:0xf
v_mfma_f32_16x16x32_bf16 v[20:23], v[40:43], a[104:107], v[20:23]
v_and_b32_dpp v48, v30, v4 row_newbcast:4 row_mask:0xf bank_mask:0xf
v_and_b32_dpp v49, v30, v5 row_newbcast:4 row_mask:0xf bank_mask:0xf
v_and_b32_dpp v50, v30, v6 row_newbcast:4 row_mask:0xf bank_mask:0xf
v_and_b32_dpp v51, v30, v7 row_newbcast:4 row_mask:0xf bank_mask:0xf
v_mfma_f32_16x16x32_bf16 v[20:23], v[44:47], a[108:111], v[20:23]
v_and_b32_dpp v36, v30, v4 row_newbcast:8 row_mask:0xf bank_mask:0xf
v_and_b32_dpp v37, v30, v5 row_newbcast:8 row_mask:0xf bank_mask:0xf
v_and_b32_dpp v38, v30, v6 row_newbcast:8 row_mask:0xf bank_mask:0xf
v_and_b32_dpp v39, v30, v7 row_newbcast:8 row_mask:0xf bank_mask:0xf
v_mfma_f32_16x16x32_bf16 v[20:23], v[48:51], a[112:115], v[20:23]
v_and_b32_dpp v40, v30, v4 row_newbcast:12 row_mask:0xf bank_mask:0xf
v_and_b32_dpp v41, v30, v5 row_newbcast:12 row_mask:0xf bank_mask:0xf
v_and_b32_dpp v42, v30, v6 row_newbcast:12 row_mask:0xf bank_mask:0xf
v_and_b32_dpp v43, v30, v7 row_newbcast:12 row_mask:0xf bank_mask:0xf
v_mfma_f32_16x16x32_bf16 v[20:23], v[36:39], a[116:119], v[20:23]
v_and_b32_dpp v44, v30, v4 row_newbcast:1 row_mask:0xf bank_mask:0xf
v_and_b32_dpp v45, v30, v5 row_newbcast:1 row_mask:0xf bank_mask:0xf
v_and_b32_dpp v46, v30, v6 row_newbcast:1 row_mask:0xf bank_mask:0xf
v_and_b32_dpp v47, v30, v7 row_newbcast:1 row_mask:0xf bank_mask:0xf
v_mfma_f32_16x16x32_bf16 v[20:23], v[40:43], a[120:123], v[20:23]
s_nop 0
v_mfma_f32_16x16x32_bf16 v[20:23], v[44:47], a[124:127], v[20:23]
s_barrier
v_add_u32 v33, s68, v0
s_nop 5
v_writelane_b32 v20, s62, 32
v_writelane_b32 v21, s63, 32
s_mov_b32 exec_lo, 0xffffffff
s_mov_b32 exec_hi, 0x1
ds_write_b128 v33, v[20:23] offset:2112
s_mov_b64 exec, -1
s_mov_b32 s48, s49
s_add_u32 s49, s49, 4096
s_cmp_eq_u32 s49, 12288
s_cselect_b32 s49, 0, s49
v_add_u32 v33, s49, v1
ds_read_b128 v[56:59], v33 offset:0
ds_read_b128 v[60:63], v33 offset:1024
ds_read_b128 v[64:67], v33 offset:2048
ds_read_b128 v[68:71], v33 offset:3072
ds_read_b128 v[72:75], v1 offset:25600
ds_read_b128 v[76:79], v1 offset:26624
ds_read_b128 v[80:83], v1 offset:27648
ds_read_b128 v[84:87], v1 offset:28672
s_waitcnt lgkmcnt(0)
ds_read_b128 v[88:91], v1 offset:29696
ds_read_b128 v[92:95], v1 offset:30720
ds_read_b128 v[96:99], v1 offset:31744
ds_read_b128 v[100:103], v1 offset:32768
ds_read_b128 v[104:107], v1 offset:33792
ds_read_b128 v[108:111], v1 offset:34816
ds_read_b128 v[112:115], v1 offset:35840
ds_read_b128 v[116:119], v1 offset:36864
s_waitcnt lgkmcnt(0)
ds_read_b128 v[120:123], v1 offset:37888
s_waitcnt lgkmcnt(0)
s_waitcnt vmcnt(0)
Lq39:
v_max3_u32 v33, v12, v13, v14
v_max_u32 v33, v33, v15
v_cmp_eq_u32 vcc, -1, v33
s_nop 0
s_cbranch_vccz Lq40
buffer_load_dwordx4 v[12:15], v3, s[12:15], s51 offen sc1
s_waitcnt vmcnt(0)
s_sub_u32 s64, s64, 1
s_cmp_gt_i32 s64, 0
s_cbranch_scc1 Lq39
Lq40:
s_add_u32 s51, s51, 256
v_dot2_f32_bf16 v52, v56, v12, 0
v_dot2_f32_bf16 v53, v60, v12, 0
v_dot2_f32_bf16 v54, v64, v12, 0
v_dot2_f32_bf16 v55, v68, v12, 0
v_dot2c_f32_bf16 v52, v57, v13
v_dot2c_f32_bf16 v53, v61, v13
v_dot2c_f32_bf16 v54, v65, v13
v_dot2c_f32_bf16 v55, v69, v13
v_dot2c_f32_bf16 v52, v58, v14
v_dot2c_f32_bf16 v53, v62, v14
v_dot2c_f32_bf16 v54, v66, v14
v_dot2c_f32_bf16 v55, v70, v14
v_dot2c_f32_bf16 v52, v59, v15
v_dot2c_f32_bf16 v53, v63, v15
v_dot2c_f32_bf16 v54, v67, v15
v_dot2c_f32_bf16 v55, v71, v15
v_add_f32_dpp v33, v52, v52 row_ror:8 row_mask:0xf bank_mask:0x3
v_add_f32_dpp v34, v53, v53 row_ror:8 row_mask:0xf bank_mask:0x3
v_add_f32_dpp v33, v54, v54 row_ror:8 row_mask:0xf bank_mask:0xc
v_add_f32_dpp v34, v55, v55 row_ror:8 row_mask:0xf bank_mask:0xc
s_nop 0
v_add_f32_dpp v28, v33, v33 row_half_mirror row_mask:0xf bank_mask:0x5
v_add_f32_dpp v28, v34, v34 row_half_mirror row_mask:0xf bank_mask:0xa
v_dot2_f32_bf16 v52, v72, v12, 0
v_dot2_f32_bf16 v53, v76, v12, 0
v_dot2_f32_bf16 v54, v80, v12, 0
v_dot2_f32_bf16 v55, v84, v12, 0
v_dot2c_f32_bf16 v52, v73, v13
v_dot2c_f32_bf16 v53, v77, v13
v_dot2c_f32_bf16 v54, v81, v13
v_dot2c_f32_bf16 v55, v85, v13
v_dot2c_f32_bf16 v52, v74, v14
v_dot2c_f32_bf16 v53, v78, v14
v_dot2c_f32_bf16 v54, v82, v14
v_dot2c_f32_bf16 v55, v86, v14
v_dot2c_f32_bf16 v52, v75, v15
v_dot2c_f32_bf16 v53, v79, v15
v_dot2c_f32_bf16 v54, v83, v15
v_dot2c_f32_bf16 v55, v87, v15
v_add_f32_dpp v33, v52, v52 row_ror:8 row_mask:0xf bank_mask:0x3
v_add_f32_dpp v34, v53, v53 row_ror:8 row_mask:0xf bank_mask:0x3
v_add_f32_dpp v33, v54, v54 row_ror:8 row_mask:0xf bank_mask:0xc
v_add_f32_dpp v34, v55, v55 row_ror:8 row_mask:0xf bank_mask:0xc
s_nop 0
v_add_f32_dpp v35, v33, v33 row_half_mirror row_mask:0xf bank_mask:0x5
v_add_f32_dpp v35, v34, v34 row_half_mirror row_mask:0xf bank_mask:0xa
v_cndmask_b32 v33, v28, v35, s[54:55]
v_cndmask_b32 v34, v35, v28, s[54:55]
s_nop 1
v_add_f32_dpp v28, v34, v33 quad_perm:[1,0,3,2] row_mask:0xf bank_mask:0xf
v_dot2_f32_bf16 v52, v88, v12, 0
v_dot2_f32_bf16 v53, v92, v12, 0
v_dot2_f32_bf16 v54, v96, v12, 0
v_dot2_f32_bf16 v55, v100, v12, 0
v_dot2c_f32_bf16 v52, v89, v13
v_dot2c_f32_bf16 v53, v93, v13
v_dot2c_f32_bf16 v54, v97, v13
v_dot2c_f32_bf16 v55, v101, v13
v_dot2c_f32_bf16 v52, v90, v14
v_dot2c_f32_bf16 v53, v94, v14
v_dot2c_f32_bf16 v54, v98, v14
v_dot2c_f32_bf16 v55, v102, v14
v_dot2c_f32_bf16 v52, v91, v15
v_dot2c_f32_bf16 v53, v95, v15
v_dot2c_f32_bf16 v54, v99, v15
v_dot2c_f32_bf16 v55, v103, v15
v_add_f32_dpp v33, v52, v52 row_ror:8 row_mask:0xf bank_mask:0x3
v_add_f32_dpp v34, v53, v53 row_ror:8 row_mask:0xf bank_mask:0x3
v_add_f32_dpp v33, v54, v54 row_ror:8 row_mask:0xf bank_mask:0xc
v_add_f32_dpp v34, v55, v55 row_ror:8 row_mask:0xf bank_mask:0xc
s_nop 0
v_add_f32_dpp v31, v33, v33 row_half_mirror row_mask:0xf bank_mask:0x5
v_add_f32_dpp v31, v34, v34 row_half_mirror row_mask:0xf bank_mask:0xa
v_dot2_f32_bf16 v52, v104, v12, 0
v_dot2_f32_bf16 v53, v108, v12, 0
v_dot2_f32_bf16 v54, v112, v12, 0
v_dot2_f32_bf16 v55, v116, v12, 0
v_dot2c_f32_bf16 v52, v105, v13
v_dot2c_f32_bf16 v53, v109, v13
v_dot2c_f32_bf16 v54, v113, v13
v_dot2c_f32_bf16 v55, v117, v13
v_dot2c_f32_bf16 v52, v106, v14
v_dot2c_f32_bf16 v53, v110, v14
v_dot2c_f32_bf16 v54, v114, v14
v_dot2c_f32_bf16 v55, v118, v14
v_dot2c_f32_bf16 v52, v107, v15
v_dot2c_f32_bf16 v53, v111, v15
v_dot2c_f32_bf16 v54, v115, v15
v_dot2c_f32_bf16 v55, v119, v15
v_add_f32_dpp v33, v52, v52 row_ror:8 row_mask:0xf bank_mask:0x3
v_add_f32_dpp v34, v53, v53 row_ror:8 row_mask:0xf bank_mask:0x3
v_add_f32_dpp v33, v54, v54 row_ror:8 row_mask:0xf bank_mask:0xc
v_add_f32_dpp v34, v55, v55 row_ror:8 row_mask:0xf bank_mask:0xc
s_nop 0
v_add_f32_dpp v35, v33, v33 row_half_mirror row_mask:0xf bank_mask:0x5
v_add_f32_dpp v35, v34, v34 row_half_mirror row_mask:0xf bank_mask:0xa
v_cndmask_b32 v33, v31, v35, s[54:55]
v_cndmask_b32 v34, v35, v31, s[54:55]
s_nop 1
v_add_f32_dpp v31, v34, v33 quad_perm:[1,0,3,2] row_mask:0xf bank_mask:0xf
v_cndmask_b32 v33, v28, v31, s[56:57]
v_cndmask_b32 v34, v31, v28, s[56:57]
s_nop 1
v_add_f32_dpp v28, v34, v33 quad_perm:[2,3,0,1] row_mask:0xf bank_mask:0xf
v_dot2_f32_bf16 v52, v156, v12, 0
v_dot2_f32_bf16 v53, v160, v12, 0
v_dot2_f32_bf16 v54, v164, v12, 0
v_dot2_f32_bf16 v55, v168, v12, 0
v_dot2c_f32_bf16 v52, v157, v13
v_dot2c_f32_bf16 v53, v161, v13
v_dot2c_f32_bf16 v54, v165, v13
v_dot2c_f32_bf16 v55, v169, v13
v_dot2c_f32_bf16 v52, v158, v14
v_dot2c_f32_bf16 v53, v162, v14
v_dot2c_f32_bf16 v54, v166, v14
v_dot2c_f32_bf16 v55, v170, v14
v_dot2c_f32_bf16 v52, v159, v15
v_dot2c_f32_bf16 v53, v163, v15
v_dot2c_f32_bf16 v54, v167, v15
v_dot2c_f32_bf16 v55, v171, v15
v_add_f32_dpp v33, v52, v52 row_ror:8 row_mask:0xf bank_mask:0x3
v_add_f32_dpp v34, v53, v53 row_ror:8 row_mask:0xf bank_mask:0x3
v_add_f32_dpp v33, v54, v54 row_ror:8 row_mask:0xf bank_mask:0xc
v_add_f32_dpp v34, v55, v55 row_ror:8 row_mask:0xf bank_mask:0xc
s_nop 0
v_add_f32_dpp v29, v33, v33 row_half_mirror row_mask:0xf bank_mask:0x5
v_add_f32_dpp v29, v34, v34 row_half_mirror row_mask:0xf bank_mask:0xa
v_dot2_f32_bf16 v52, v172, v12, 0
v_dot2_f32_bf16 v53, v176, v12, 0
v_dot2_f32_bf16 v54, v180, v12, 0
v_dot2_f32_bf16 v55, v184, v12, 0
v_dot2c_f32_bf16 v52, v173, v13
v_dot2c_f32_bf16 v53, v177, v13
v_dot2c_f32_bf16 v54, v181, v13
v_dot2c_f32_bf16 v55, v185, v13
v_dot2c_f32_bf16 v52, v174, v14
v_dot2c_f32_bf16 v53, v178, v14
v_dot2c_f32_bf16 v54, v182, v14
v_dot2c_f32_bf16 v55, v186, v14
v_dot2c_f32_bf16 v52, v175, v15
v_dot2c_f32_bf16 v53, v179, v15
v_dot2c_f32_bf16 v54, v183, v15
v_dot2c_f32_bf16 v55, v187, v15
v_add_f32_dpp v33, v52, v52 row_ror:8 row_mask:0xf bank_mask:0x3
v_add_f32_dpp v34, v53, v53 row_ror:8 row_mask:0xf bank_mask:0x3
v_add_f32_dpp v33, v54, v54 row_ror:8 row_mask:0xf bank_mask:0xc
v_add_f32_dpp v34, v55, v55 row_ror:8 row_mask:0xf bank_mask:0xc
s_nop 0
v_add_f32_dpp v35, v33, v33 row_half_mirror row_mask:0xf bank_mask:0x5
v_add_f32_dpp v35, v34, v34 row_half_mirror row_mask:0xf bank_mask:0xa
v_cndmask_b32 v33, v29, v35, s[54:55]
v_cndmask_b32 v34, v35, v29, s[54:55]
s_nop 1
v_add_f32_dpp v29, v34, v33 quad_perm:[1,0,3,2] row_mask:0xf bank_mask:0xf
v_dot2_f32_bf16 v52, v188, v12, 0
v_dot2_f32_bf16 v53, v192, v12, 0
v_dot2_f32_bf16 v54, v196, v12, 0
v_dot2_f32_bf16 v55, v200, v12, 0
v_dot2c_f32_bf16 v52, v189, v13
v_dot2c_f32_bf16 v53, v193, v13
v_dot2c_f32_bf16 v54, v197, v13
v_dot2c_f32_bf16 v55, v201, v13
v_dot2c_f32_bf16 v52, v190, v14
v_dot2c_f32_bf16 v53, v194, v14
v_dot2c_f32_bf16 v54, v198, v14
v_dot2c_f32_bf16 v55, v202, v14
v_dot2c_f32_bf16 v52, v191, v15
v_dot2c_f32_bf16 v53, v195, v15
v_dot2c_f32_bf16 v54, v199, v15
v_dot2c_f32_bf16 v55, v203, v15
v_add_f32_dpp v33, v52, v52 row_ror:8 row_mask:0xf bank_mask:0x3
v_add_f32_dpp v34, v53, v53 row_ror:8 row_mask:0xf bank_mask:0x3
v_add_f32_dpp v33, v54, v54 row_ror:8 row_mask:0xf bank_mask:0xc
v_add_f32_dpp v34, v55, v55 row_ror:8 row_mask:0xf bank_mask:0xc
s_nop 0
v_add_f32_dpp v31, v33, v33 row_half_mirror row_mask:0xf bank_mask:0x5
v_add_f32_dpp v31, v34, v34 row_half_mirror row_mask:0xf bank_mask:0xa
v_dot2_f32_bf16 v52, v204, v12, 0
v_dot2_f32_bf16 v53, v208, v12, 0
v_dot2_f32_bf16 v54, v212, v12, 0
v_dot2_f32_bf16 v55, v216, v12, 0
v_dot2c_f32_bf16 v52, v205, v13
v_dot2c_f32_bf16 v53, v209, v13
v_dot2c_f32_bf16 v54, v213, v13
v_dot2c_f32_bf16 v55, v217, v13
v_dot2c_f32_bf16 v52, v206, v14
v_dot2c_f32_bf16 v53, v210, v14
v_dot2c_f32_bf16 v54, v214, v14
v_dot2c_f32_bf16 v55, v218, v14
v_dot2c_f32_bf16 v52, v207, v15
v_dot2c_f32_bf16 v53, v211, v15
v_dot2c_f32_bf16 v54, v215, v15
v_dot2c_f32_bf16 v55, v219, v15
v_add_f32_dpp v33, v52, v52 row_ror:8 row_mask:0xf bank_mask:0x3
v_add_f32_dpp v34, v53, v53 row_ror:8 row_mask:0xf bank_mask:0x3
v_add_f32_dpp v33, v54, v54 row_ror:8 row_mask:0xf bank_mask:0xc
v_add_f32_dpp v34, v55, v55 row_ror:8 row_mask:0xf bank_mask:0xc
s_nop 0
v_add_f32_dpp v35, v33, v33 row_half_mirror row_mask:0xf bank_mask:0x5
v_add_f32_dpp v35, v34, v34 row_half_mirror row_mask:0xf bank_mask:0xa
v_cndmask_b32 v33, v31, v35, s[54:55]
v_cndmask_b32 v34, v35, v31, s[54:55]
s_nop 1
v_add_f32_dpp v31, v34, v33 quad_perm:[1,0,3,2] row_mask:0xf bank_mask:0xf
v_cndmask_b32 v33, v29, v31, s[56:57]
v_cndmask_b32 v34, v31, v29, s[56:57]
s_nop 1
v_add_f32_dpp v29, v34, v33 quad_perm:[2,3,0,1] row_mask:0xf bank_mask:0xf
v_dot2_f32_bf16 v52, v220, v12, 0
v_dot2_f32_bf16 v53, v224, v12, 0
v_dot2_f32_bf16 v54, v228, v12, 0
v_dot2_f32_bf16 v55, v232, v12, 0
v_dot2c_f32_bf16 v52, v221, v13
v_dot2c_f32_bf16 v53, v225, v13
v_dot2c_f32_bf16 v54, v229, v13
v_dot2c_f32_bf16 v55, v233, v13
v_dot2c_f32_bf16 v52, v222, v14
v_dot2c_f32_bf16 v53, v226, v14
v_dot2c_f32_bf16 v54, v230, v14
v_dot2c_f32_bf16 v55, v234, v14
v_dot2c_f32_bf16 v52, v223, v15
v_dot2c_f32_bf16 v53, v227, v15
v_dot2c_f32_bf16 v54, v231, v15
v_dot2c_f32_bf16 v55, v235, v15
v_add_f32_dpp v33, v52, v52 row_ror:8 row_mask:0xf bank_mask:0x3
v_add_f32_dpp v34, v53, v53 row_ror:8 row_mask:0xf bank_mask:0x3
v_add_f32_dpp v33, v54, v54 row_ror:8 row_mask:0xf bank_mask:0xc
v_add_f32_dpp v34, v55, v55 row_ror:8 row_mask:0xf bank_mask:0xc
s_nop 0
v_add_f32_dpp v30, v33, v33 row_half_mirror row_mask:0xf bank_mask:0x5
v_add_f32_dpp v30, v34, v34 row_half_mirror row_mask:0xf bank_mask:0xa
v_dot2_f32_bf16 v52, v120, v12, 0
v_dot2_f32_bf16 v52, v121, v13, v52
v_dot2_f32_bf16 v52, v122, v14, v52
v_dot2_f32_bf16 v52, v123, v15, v52
s_nop 2
v_add_f32_dpp v33, v52, v52 row_ror:8 row_mask:0xf bank_mask:0xf
s_nop 1
v_add_f32_dpp v35, v33, v33 row_half_mirror row_mask:0xf bank_mask:0xf
v_cndmask_b32 v33, v30, v35, s[54:55]
v_cndmask_b32 v34, v35, v30, s[54:55]
s_nop 1
v_add_f32_dpp v30, v34, v33 quad_perm:[1,0,3,2] row_mask:0xf bank_mask:0xf
s_nop 1
v_add_f32_dpp v30, v30, v30 quad_perm:[2,3,0,1] row_mask:0xf bank_mask:0xf
v_mul_f32 v28, 0x3e0293ee, v28
v_mul_f32 v29, 0x3e0293ee, v29
v_mul_f32 v30, 0x3e0293ee, v30
v_mov_b32 v34, 0xff800000
v_cndmask_b32 v30, v34, v30, s[58:59]
v_max3_f32 v33, v28, v29, v30
s_nop 1
v_max_f32_dpp v33, v33, v33 quad_perm:[1,0,3,2] row_mask:0xf bank_mask:0xf
s_nop 1
v_max_f32_dpp v33, v33, v33 quad_perm:[2,3,0,1] row_mask:0xf bank_mask:0xf
s_nop 1
v_max_f32_dpp v33, v33, v33 row_ror:4 row_mask:0xf bank_mask:0xf
s_nop 1
v_max_f32_dpp v33, v33, v33 row_ror:8 row_mask:0xf bank_mask:0xf
s_nop 1
v_max_f32_dpp v33, v33, v33 row_bcast:15 row_mask:0xa bank_mask:0xf
s_nop 1
v_max_f32_dpp v33, v33, v33 row_bcast:31 row_mask:0xc bank_mask:0xf
s_nop 0
v_readlane_b32 s62, v33, 63
s_nop 1
v_subrev_f32 v28, s62, v28
v_subrev_f32 v29, s62, v29
v_subrev_f32 v30, s62, v30
v_exp_f32 v28, v28
v_exp_f32 v29, v29
v_exp_f32 v30, v30
v_add_f32 v33, v28, v29
v_add_f32 v33, v33, v30
v_cvt_pk_bf16_f32 v28, v28, v28
v_cvt_pk_bf16_f32 v29, v29, v29
v_cvt_pk_bf16_f32 v30, v30, v30
v_add_f32_dpp v33, v33, v33 quad_perm:[1,0,3,2] row_mask:0xf bank_mask:0xf
s_nop 1
v_add_f32_dpp v33, v33, v33 quad_perm:[2,3,0,1] row_mask:0xf bank_mask:0xf
s_nop 1
v_add_f32_dpp v33, v33, v33 row_ror:4 row_mask:0xf bank_mask:0xf
s_nop 1
v_add_f32_dpp v33, v33, v33 row_ror:8 row_mask:0xf bank_mask:0xf
s_nop 1
v_add_f32_dpp v33, v33, v33 row_bcast:15 row_mask:0xa bank_mask:0xf
s_nop 1
v_add_f32_dpp v33, v33, v33 row_bcast:31 row_mask:0xc bank_mask:0xf
s_nop 0
v_readlane_b32 s63, v33, 63
v_and_b32_dpp v48, v28, v4 row_newbcast:0 row_mask:0xf bank_mask:0xf
v_and_b32_dpp v49, v28, v5 row_newbcast:0 row_mask:0xf bank_mask:0xf
v_and_b32_dpp v50, v28, v6 row_newbcast:0 row_mask:0xf bank_mask:0xf
v_and_b32_dpp v51, v28, v7 row_newbcast:0 row_mask:0xf bank_mask:0xf
v_and_b32_dpp v36, v28, v4 row_newbcast:4 row_mask:0xf bank_mask:0xf
v_and_b32_dpp v37, v28, v5 row_newbcast:4 row_mask:0xf bank_mask:0xf
v_and_b32_dpp v38, v28, v6 row_newbcast:4 row_mask:0xf bank_mask:0xf
v_and_b32_dpp v39, v28, v7 row_newbcast:4 row_mask:0xf bank_mask:0xf
v_mfma_f32_16x16x32_bf16 v[20:23], v[48:51], v[236:239], 0
v_and_b32_dpp v40, v28, v4 row_newbcast:8 row_mask:0xf bank_mask:0xf
v_and_b32_dpp v41, v28, v5 row_newbcast:8 row_mask:0xf bank_mask:0xf
v_and_b32_dpp v42, v28, v6 row_newbcast:8 row_mask:0xf bank_mask:0xf
v_and_b32_dpp v43, v28, v7 row_newbcast:8 row_mask:0xf bank_mask:0xf
v_mfma_f32_16x16x32_bf16 v[20:23], v[36:39], v[240:243], v[20:23]
v_and_b32_dpp v44, v28, v4 row_newbcast:12 row_mask:0xf bank_mask:0xf
v_and_b32_dpp v45, v28, v5 row_newbcast:12 row_mask:0xf bank_mask:0xf
v_and_b32_dpp v46, v28, v6 row_newbcast:12 row_mask:0xf bank_mask:0xf
v_and_b32_dpp v47, v28, v7 row_newbcast:12 row_mask:0xf bank_mask:0xf
v_mfma_f32_16x16x32_bf16 v[20:23], v[40:43], v[244:247], v[20:23]
v_and_b32_dpp v48, v28, v4 row_newbcast:1 row_mask:0xf bank_mask:0xf
v_and_b32_dpp v49, v28, v5 row_newbcast:1 row_mask:0xf bank_mask:0xf
v_and_b32_dpp v50, v28, v6 row_newbcast:1 row_mask:0xf bank_mask:0xf
v_and_b32_dpp v51, v28, v7 row_newbcast:1 row_mask:0xf bank_mask:0xf
v_mfma_f32_16x16x32_bf16 v[20:23], v[44:47], v[248:251], v[20:23]
v_and_b32_dpp v36, v28, v4 row_newbcast:5 row_mask:0xf bank_mask:0xf
v_and_b32_dpp v37, v28, v5 row_newbcast:5 row_mask:0xf bank_mask:0xf
v_and_b32_dpp v38, v28, v6 row_newbcast:5 row_mask:0xf bank_mask:0xf
v_and_b32_dpp v39, v28, v7 row_newbcast:5 row_mask:0xf bank_mask:0xf
v_mfma_f32_16x16x32_bf16 v[20:23], v[48:51], v[252:255], v[20:23]
v_and_b32_dpp v40, v28, v4 row_newbcast:9 row_mask:0xf bank_mask:0xf
v_and_b32_dpp v41, v28, v5 row_newbcast:9 row_mask:0xf bank_mask:0xf
v_and_b32_dpp v42, v28, v6 row_newbcast:9 row_mask:0xf bank_mask:0xf
v_and_b32_dpp v43, v28, v7 row_newbcast:9 row_mask:0xf bank_mask:0xf
v_mfma_f32_16x16x32_bf16 v[20:23], v[36:39], a[128:131], v[20:23]
v_and_b32_dpp v44, v28, v4 row_newbcast:13 row_mask:0xf bank_mask:0xf
v_and_b32_dpp v45, v28, v5 row_newbcast:13 row_mask:0xf bank_mask:0xf
v_and_b32_dpp v46, v28, v6 row_newbcast:13 row_mask:0xf bank_mask:0xf
v_and_b32_dpp v47, v28, v7 row_newbcast:13 row_mask:0xf bank_mask:0xf
v_mfma_f32_16x16x32_bf16 v[20:23], v[40:43], a[132:135], v[20:23]
v_and_b32_dpp v48, v28, v4 row_newbcast:2 row_mask:0xf bank_mask:0xf
v_and_b32_dpp v49, v28, v5 row_newbcast:2 row_mask:0xf bank_mask:0xf
v_and_b32_dpp v50, v28, v6 row_newbcast:2 row_mask:0xf bank_mask:0xf
v_and_b32_dpp v51, v28, v7 row_newbcast:2 row_mask:0xf bank_mask:0xf
v_mfma_f32_16x16x32_bf16 v[20:23], v[44:47], a[136:139], v[20:23]
v_and_b32_dpp v36, v28, v4 row_newbcast:6 row_mask:0xf bank_mask:0xf
v_and_b32_dpp v37, v28, v5 row_newbcast:6 row_mask:0xf bank_mask:0xf
v_and_b32_dpp v38, v28, v6 row_newbcast:6 row_mask:0xf bank_mask:0xf
v_and_b32_dpp v39, v28, v7 row_newbcast:6 row_mask:0xf bank_mask:0xf
v_mfma_f32_16x16x32_bf16 v[20:23], v[48:51], a[140:143], v[20:23]
v_and_b32_dpp v40, v28, v4 row_newbcast:10 row_mask:0xf bank_mask:0xf
v_and_b32_dpp v41, v28, v5 row_newbcast:10 row_mask:0xf bank_mask:0xf
v_and_b32_dpp v42, v28, v6 row_newbcast:10 row_mask:0xf bank_mask:0xf
v_and_b32_dpp v43, v28, v7 row_newbcast:10 row_mask:0xf bank_mask:0xf
v_mfma_f32_16x16x32_bf16 v[20:23], v[36:39], a[144:147], v[20:23]
v_and_b32_dpp v44, v28, v4 row_newbcast:14 row_mask:0xf bank_mask:0xf
v_and_b32_dpp v45, v28, v5 row_newbcast:14 row_mask:0xf bank_mask:0xf
v_and_b32_dpp v46, v28, v6 row_newbcast:14 row_mask:0xf bank_mask:0xf
v_and_b32_dpp v47, v28, v7 row_newbcast:14 row_mask:0xf bank_mask:0xf
v_mfma_f32_16x16x32_bf16 v[20:23], v[40:43], a[148:151], v[20:23]
v_and_b32_dpp v48, v28, v4 row_newbcast:3 row_mask:0xf bank_mask:0xf
v_and_b32_dpp v49, v28, v5 row_newbcast:3 row_mask:0xf bank_mask:0xf
v_and_b32_dpp v50, v28, v6 row_newbcast:3 row_mask:0xf bank_mask:0xf
v_and_b32_dpp v51, v28, v7 row_newbcast:3 row_mask:0xf bank_mask:0xf
v_mfma_f32_16x16x32_bf16 v[20:23], v[44:47], a[152:155], v[20:23]
v_and_b32_dpp v36, v28, v4 row_newbcast:7 row_mask:0xf bank_mask:0xf
v_and_b32_dpp v37, v28, v5 row_newbcast:7 row_mask:0xf bank_mask:0xf
v_and_b32_dpp v38, v28, v6 row_newbcast:7 row_mask:0xf bank_mask:0xf
v_and_b32_dpp v39, v28, v7 row_newbcast:7 row_mask:0xf bank_mask:0xf
v_mfma_f32_16x16x32_bf16 v[20:23], v[48:51], a[156:159], v[20:23]
v_and_b32_dpp v40, v28, v4 row_newbcast:11 row_mask:0xf bank_mask:0xf
v_and_b32_dpp v41, v28, v5 row_newbcast:11 row_mask:0xf bank_mask:0xf
v_and_b32_dpp v42, v28, v6 row_newbcast:11 row_mask:0xf bank_mask:0xf
v_and_b32_dpp v43, v28, v7 row_newbcast:11 row_mask:0xf bank_mask:0xf
v_mfma_f32_16x16x32_bf16 v[20:23], v[36:39], a[160:163], v[20:23]
v_and_b32_dpp v44, v28, v4 row_newbcast:15 row_mask:0xf bank_mask:0xf
v_and_b32_dpp v45, v28, v5 row_newbcast:15 row_mask:0xf bank_mask:0xf
v_and_b32_dpp v46, v28, v6 row_newbcast:15 row_mask:0xf bank_mask:0xf
v_and_b32_dpp v47, v28, v7 row_newbcast:15 row_mask:0xf bank_mask:0xf
v_mfma_f32_16x16x32_bf16 v[20:23], v[40:43], a[164:167], v[20:23]
v_and_b32_dpp v48, v29, v4 row_newbcast:0 row_mask:0xf bank_mask:0xf
v_and_b32_dpp v49, v29, v5 row_newbcast:0 row_mask:0xf bank_mask:0xf
v_and_b32_dpp v50, v29, v6 row_newbcast:0 row_mask:0xf bank_mask:0xf
v_and_b32_dpp v51, v29, v7 row_newbcast:0 row_mask:0xf bank_mask:0xf
v_mfma_f32_16x16x32_bf16 v[20:23], v[44:47], a[168:171], v[20:23]
v_and_b32_dpp v36, v29, v4 row_newbcast:4 row_mask:0xf bank_mask:0xf
v_and_b32_dpp v37, v29, v5 row_newbcast:4 row_mask:0xf bank_mask:0xf
v_and_b32_dpp v38, v29, v6 row_newbcast:4 row_mask:0xf bank_mask:0xf
v_and_b32_dpp v39, v29, v7 row_newbcast:4 row_mask:0xf bank_mask:0xf
v_mfma_f32_16x16x32_bf16 v[20:23], v[48:51], a[172:175], v[20:23]
v_and_b32_dpp v40, v29, v4 row_newbcast:8 row_mask:0xf bank_mask:0xf
v_and_b32_dpp v41, v29, v5 row_newbcast:8 row_mask:0xf bank_mask:0xf
v_and_b32_dpp v42, v29, v6 row_newbcast:8 row_mask:0xf bank_mask:0xf
v_and_b32_dpp v43, v29, v7 row_newbcast:8 row_mask:0xf bank_mask:0xf
v_mfma_f32_16x16x32_bf16 v[20:23], v[36:39], a[176:179], v[20:23]
v_and_b32_dpp v44, v29, v4 row_newbcast:12 row_mask:0xf bank_mask:0xf
v_and_b32_dpp v45, v29, v5 row_newbcast:12 row_mask:0xf bank_mask:0xf
v_and_b32_dpp v46, v29, v6 row_newbcast:12 row_mask:0xf bank_mask:0xf
v_and_b32_dpp v47, v29, v7 row_newbcast:12 row_mask:0xf bank_mask:0xf
v_mfma_f32_16x16x32_bf16 v[20:23], v[40:43], a[180:183], v[20:23]
v_and_b32_dpp v48, v29, v4 row_newbcast:1 row_mask:0xf bank_mask:0xf
v_and_b32_dpp v49, v29, v5 row_newbcast:1 row_mask:0xf bank_mask:0xf
v_and_b32_dpp v50, v29, v6 row_newbcast:1 row_mask:0xf bank_mask:0xf
v_and_b32_dpp v51, v29, v7 row_newbcast:1 row_mask:0xf bank_mask:0xf
v_mfma_f32_16x16x32_bf16 v[20:23], v[44:47], a[184:187], v[20:23]
v_and_b32_dpp v36, v29, v4 row_newbcast:5 row_mask:0xf bank_mask:0xf
v_and_b32_dpp v37, v29, v5 row_newbcast:5 row_mask:0xf bank_mask:0xf
v_and_b32_dpp v38, v29, v6 row_newbcast:5 row_mask:0xf bank_mask:0xf
v_and_b32_dpp v39, v29, v7 row_newbcast:5 row_mask:0xf bank_mask:0xf
v_mfma_f32_16x16x32_bf16 v[20:23], v[48:51], a[188:191], v[20:23]
v_and_b32_dpp v40, v29, v4 row_newbcast:9 row_mask:0xf bank_mask:0xf
v_and_b32_dpp v41, v29, v5 row_newbcast:9 row_mask:0xf bank_mask:0xf
v_and_b32_dpp v42, v29, v6 row_newbcast:9 row_mask:0xf bank_mask:0xf
v_and_b32_dpp v43, v29, v7 row_newbcast:9 row_mask:0xf bank_mask:0xf
v_mfma_f32_16x16x32_bf16 v[20:23], v[36:39], a[192:195], v[20:23]
v_and_b32_dpp v44, v29, v4 row_newbcast:13 row_mask:0xf bank_mask:0xf
v_and_b32_dpp v45, v29, v5 row_newbcast:13 row_mask:0xf bank_mask:0xf
v_and_b32_dpp v46, v29, v6 row_newbcast:13 row_mask:0xf bank_mask:0xf
v_and_b32_dpp v47, v29, v7 row_newbcast:13 row_mask:0xf bank_mask:0xf
v_mfma_f32_16x16x32_bf16 v[20:23], v[40:43], a[196:199], v[20:23]
v_and_b32_dpp v48, v29, v4 row_newbcast:2 row_mask:0xf bank_mask:0xf
v_and_b32_dpp v49, v29, v5 row_newbcast:2 row_mask:0xf bank_mask:0xf
v_and_b32_dpp v50, v29, v6 row_newbcast:2 row_mask:0xf bank_mask:0xf
v_and_b32_dpp v51, v29, v7 row_newbcast:2 row_mask:0xf bank_mask:0xf
v_mfma_f32_16x16x32_bf16 v[20:23], v[44:47], a[200:203], v[20:23]
v_and_b32_dpp v36, v29, v4 row_newbcast:6 row_mask:0xf bank_mask:0xf
v_and_b32_dpp v37, v29, v5 row_newbcast:6 row_mask:0xf bank_mask:0xf
v_and_b32_dpp v38, v29, v6 row_newbcast:6 row_mask:0xf bank_mask:0xf
v_and_b32_dpp v39, v29, v7 row_newbcast:6 row_mask:0xf bank_mask:0xf
v_mfma_f32_16x16x32_bf16 v[20:23], v[48:51], a[204:207], v[20:23]
v_and_b32_dpp v40, v29, v4 row_newbcast:10 row_mask:0xf bank_mask:0xf
v_and_b32_dpp v41, v29, v5 row_newbcast:10 row_mask:0xf bank_mask:0xf
v_and_b32_dpp v42, v29, v6 row_newbcast:10 row_mask:0xf bank_mask:0xf
v_and_b32_dpp v43, v29, v7 row_newbcast:10 row_mask:0xf bank_mask:0xf
v_mfma_f32_16x16x32_bf16 v[20:23], v[36:39], a[208:211], v[20:23]
v_and_b32_dpp v44, v29, v4 row_newbcast:14 row_mask:0xf bank_mask:0xf
v_and_b32_dpp v45, v29, v5 row_newbcast:14 row_mask:0xf bank_mask:0xf
v_and_b32_dpp v46, v29, v6 row_newbcast:14 row_mask:0xf bank_mask:0xf
v_and_b32_dpp v47, v29, v7 row_newbcast:14 row_mask:0xf bank_mask:0xf
v_mfma_f32_16x16x32_bf16 v[20:23], v[40:43], a[212:215], v[20:23]
v_and_b32_dpp v48, v29, v4 row_newbcast:3 row_mask:0xf bank_mask:0xf
v_and_b32_dpp v49, v29, v5 row_newbcast:3 row_mask:0xf bank_mask:0xf
v_and_b32_dpp v50, v29, v6 row_newbcast:3 row_mask:0xf bank_mask:0xf
v_and_b32_dpp v51, v29, v7 row_newbcast:3 row_mask:0xf bank_mask:0xf
v_mfma_f32_16x16x32_bf16 v[20:23], v[44:47], a[216:219], v[20:23]
v_and_b32_dpp v36, v29, v4 row_newbcast:7 row_mask:0xf bank_mask:0xf
v_and_b32_dpp v37, v29, v5 row_newbcast:7 row_mask:0xf bank_mask:0xf
v_and_b32_dpp v38, v29, v6 row_newbcast:7 row_mask:0xf bank_mask:0xf
v_and_b32_dpp v39, v29, v7 row_newbcast:7 row_mask:0xf bank_mask:0xf
v_mfma_f32_16x16x32_bf16 v[20:23], v[48:51], a[220:223], v[20:23]
v_and_b32_dpp v40, v29, v4 row_newbcast:11 row_mask:0xf bank_mask:0xf
v_and_b32_dpp v41, v29, v5 row_newbcast:11 row_mask:0xf bank_mask:0xf
v_and_b32_dpp v42, v29, v6 row_newbcast:11 row_mask:0xf bank_mask:0xf
v_and_b32_dpp v43, v29, v7 row_newbcast:11 row_mask:0xf bank_mask:0xf
v_mfma_f32_16x16x32_bf16 v[20:23], v[36:39], a[224:227], v[20:23]
v_and_b32_dpp v44, v29, v4 row_newbcast:15 row_mask:0xf bank_mask:0xf
v_and_b32_dpp v45, v29, v5 row_newbcast:15 row_mask:0xf bank_mask:0xf
v_and_b32_dpp v46, v29, v6 row_newbcast:15 row_mask:0xf bank_mask:0xf
v_and_b32_dpp v47, v29, v7 row_newbcast:15 row_mask:0xf bank_mask:0xf
v_mfma_f32_16x16x32_bf16 v[20:23], v[40:43], a[228:231], v[20:23]
v_and_b32_dpp v48, v30, v4 row_newbcast:0 row_mask:0xf bank_mask:0xf
v_and_b32_dpp v49, v30, v5 row_newbcast:0 row_mask:0xf bank_mask:0xf
v_and_b32_dpp v50, v30, v6 row_newbcast:0 row_mask:0xf bank_mask:0xf
v_and_b32_dpp v51, v30, v7 row_newbcast:0 row_mask:0xf bank_mask:0xf
v_mfma_f32_16x16x32_bf16 v[20:23], v[44:47], a[232:235], v[20:23]
v_and_b32_dpp v36, v30, v4 row_newbcast:4 row_mask:0xf bank_mask:0xf
v_and_b32_dpp v37, v30, v5 row_newbcast:4 row_mask:0xf bank_mask:0xf
v_and_b32_dpp v38, v30, v6 row_newbcast:4 row_mask:0xf bank_mask:0xf
v_and_b32_dpp v39, v30, v7 row_newbcast:4 row_mask:0xf bank_mask:0xf
v_mfma_f32_16x16x32_bf16 v[20:23], v[48:51], a[236:239], v[20:23]
v_and_b32_dpp v40, v30, v4 row_newbcast:8 row_mask:0xf bank_mask:0xf
v_and_b32_dpp v41, v30, v5 row_newbcast:8 row_mask:0xf bank_mask:0xf
v_and_b32_dpp v42, v30, v6 row_newbcast:8 row_mask:0xf bank_mask:0xf
v_and_b32_dpp v43, v30, v7 row_newbcast:8 row_mask:0xf bank_mask:0xf
v_mfma_f32_16x16x32_bf16 v[20:23], v[36:39], a[240:243], v[20:23]
v_and_b32_dpp v44, v30, v4 row_newbcast:12 row_mask:0xf bank_mask:0xf
v_and_b32_dpp v45, v30, v5 row_newbcast:12 row_mask:0xf bank_mask:0xf
v_and_b32_dpp v46, v30, v6 row_newbcast:12 row_mask:0xf bank_mask:0xf
v_and_b32_dpp v47, v30, v7 row_newbcast:12 row_mask:0xf bank_mask:0xf
v_mfma_f32_16x16x32_bf16 v[20:23], v[40:43], a[244:247], v[20:23]
v_and_b32_dpp v48, v30, v4 row_newbcast:1 row_mask:0xf bank_mask:0xf
v_and_b32_dpp v49, v30, v5 row_newbcast:1 row_mask:0xf bank_mask:0xf
v_and_b32_dpp v50, v30, v6 row_newbcast:1 row_mask:0xf bank_mask:0xf
v_and_b32_dpp v51, v30, v7 row_newbcast:1 row_mask:0xf bank_mask:0xf
v_mfma_f32_16x16x32_bf16 v[20:23], v[44:47], a[248:251], v[20:23]
s_nop 0
v_mfma_f32_16x16x32_bf16 v[20:23], v[48:51], a[252:255], v[20:23]
v_add_u32 v33, s68, v0
s_nop 6
v_writelane_b32 v20, s62, 32
v_writelane_b32 v21, s63, 32
s_mov_b32 exec_lo, 0xffffffff
s_mov_b32 exec_hi, 0x1
ds_write_b128 v33, v[20:23] offset:0
s_mov_b64 exec, -1
v_mov_b32 v34, s85
v_add_u32 v33, s85, v0
s_bitcmp0_b32 s40, 1
s_waitcnt lgkmcnt(0)
s_barrier
s_cbranch_scc0 Lp41
ds_read_b64 v[52:53], v34 offset:512
ds_read_b64 v[54:55], v34 offset:1040
ds_read_b64 v[16:17], v34 offset:1568
ds_read_b64 v[18:19], v34 offset:2096
s_mov_b32 exec_lo, 0xffffffff
s_mov_b32 exec_hi, 0x0
ds_read_b128 v[36:39], v33 offset:0
ds_read_b128 v[40:43], v33 offset:528
ds_read_b128 v[44:47], v33 offset:1056
ds_read_b128 v[48:51], v33 offset:1584
s_mov_b64 exec, -1
s_waitcnt lgkmcnt(4)
v_max3_f32 v33, v52, v54, v16
v_max_f32 v33, v33, v18
v_sub_f32 v52, v52, v33
v_sub_f32 v54, v54, v33
v_sub_f32 v16, v16, v33
v_sub_f32 v18, v18, v33
v_exp_f32 v52, v52
v_exp_f32 v54, v54
v_exp_f32 v16, v16
v_exp_f32 v18, v18
v_mul_f32 v35, v52, v53
v_fmac_f32 v35, v54, v55
v_fmac_f32 v35, v16, v17
v_fmac_f32 v35, v18, v19
s_waitcnt lgkmcnt(0)
v_mul_f32 v36, v52, v36
v_mul_f32 v37, v52, v37
v_mul_f32 v38, v52, v38
v_mul_f32 v39, v52, v39
v_fmac_f32 v36, v54, v40
v_fmac_f32 v37, v54, v41
v_fmac_f32 v38, v54, v42
v_fmac_f32 v39, v54, v43
v_fmac_f32 v36, v16, v44
v_fmac_f32 v37, v16, v45
v_fmac_f32 v38, v16, v46
v_fmac_f32 v39, v16, v47
v_fmac_f32 v36, v18, v48
v_fmac_f32 v37, v18, v49
v_fmac_f32 v38, v18, v50
v_fmac_f32 v39, v18, v51
v_cvt_pk_bf16_f32 v36, v36, v37
v_cvt_pk_bf16_f32 v37, v38, v39
s_mov_b32 exec_lo, 0x0
s_mov_b32 exec_hi, 0xff
v_mov_b32 v36, v33
v_or_b32 v37, s83, v35
s_mov_b32 exec_lo, -1
v_and_or_b32 v36, v36, -2, s89
v_and_or_b32 v37, v37, -2, s89
s_cmp_lg_u32 s83, 0
s_cbranch_scc1 Lp42
buffer_store_dwordx2 v[36:37], v32, s[12:15], s52 offen
s_branch Lp43
Lp42:
buffer_store_dwordx2 v[36:37], v32, s[12:15], s52 offen sc1
Lp43:
s_mov_b64 exec, -1
Lp41:
s_xor_b32 s52, s52, 640
s_endpgm
L_chain:
s_lshl_b32 s43, s41, 2
s_add_u32 s44, s43, s40
s_add_u32 s43, s43, s42
s_mov_b32 s95, s43
v_lshrrev_b32 v1, 4, v0
v_and_b32 v2, 15, v0
v_lshlrev_b32 v26, 4, v2
v_min_u32 v22, 39, v0
s_mul_i32 s66, s44, 56320
s_mul_i32 s67, s42, 7040
s_add_u32 s66, s66, s67
s_add_u32 s66, s66, 0x100000
v_lshl_add_u32 v22, v22, 4, s66
v_lshlrev_b32 v44, 4, v0
s_lshl_b32 s66, s40, 15
s_lshl_b32 s67, s43, 10
s_add_u32 s66, s66, s67
s_add_u32 s66, s66, 0x400000
v_add_u32 v5, s66, v44
s_cmp_lt_u32 s40, 2
s_cbranch_scc1 Lt44
s_lshl_b32 s66, s43, 8
s_add_u32 s66, s66, 0x340000
v_and_b32 v5, 1, v1
v_lshl_add_u32 v5, v5, 13, v26
v_add_u32 v5, s66, v5
s_nop 1
Lt44:
v_mov_b32 v40, -1
v_mov_b32 v41, -1
v_mov_b32 v42, -1
v_mov_b32 v43, -1
v_cmp_gt_u32 vcc, 20, v0
s_nop 1
v_cndmask_b32 v48, 0, v40, vcc
v_cndmask_b32 v49, 0, v40, vcc
v_cndmask_b32 v50, 0, v40, vcc
v_cndmask_b32 v51, 0, v40, vcc
s_lshl_b32 s68, s40, 10
s_lshl_b32 s66, s95, 12
s_add_u32 s66, s66, s68
buffer_store_dwordx4 v[40:43], v44, s[12:15], s66 offen sc1
s_mov_b32 s68, 0
s_mul_i32 s66, s68, 640
s_cmp_eq_u32 s42, 3
s_cselect_b32 s67, 0, 28160
s_add_u32 s67, s67, s66
s_lshl_b32 s68, s68, 16
buffer_store_dwordx4 v[48:51], v22, s[12:15], s66 offen sc1
buffer_store_dwordx4 v[48:51], v22, s[12:15], s67 offen sc1
buffer_store_dwordx4 v[40:43], v5, s[12:15], s68 offen sc1
s_mov_b32 s68, 1
s_mul_i32 s66, s68, 640
s_cmp_eq_u32 s42, 3
s_cselect_b32 s67, 0, 28160
s_add_u32 s67, s67, s66
s_lshl_b32 s68, s68, 16
buffer_store_dwordx4 v[48:51], v22, s[12:15], s66 offen sc1
buffer_store_dwordx4 v[48:51], v22, s[12:15], s67 offen sc1
buffer_store_dwordx4 v[40:43], v5, s[12:15], s68 offen sc1
s_mov_b32 s8, s16
s_and_b32 s9, s17, 0xffff
s_mov_b32 s10, 0x2000
s_mov_b32 s11, 0x20000
v_lshrrev_b32 v28, 3, v0
v_and_b32 v29, 7, v0
v_lshlrev_b32 v30, 10, v28
v_lshl_add_u32 v30, v29, 5, v30
s_lshl_b32 s66, s40, 8
buffer_load_dwordx4 v[32:35], v30, s[8:11], s66 offen
buffer_load_dwordx4 v[36:39], v30, s[8:11], s66 offen offset:16
v_and_b32 v24, 1, v1
v_lshlrev_b32 v24, 6, v24
v_lshrrev_b32 v25, 1, v1
v_lshlrev_b32 v14, 1, v1
s_mov_b32 s4, s22
s_and_b32 s5, s23, 0xffff
s_mov_b32 s6, 0x400000
s_mov_b32 s7, 0x20000
v_lshl_add_u32 v27, v14, 13, v26
s_lshl_b32 s66, s40, 20
s_lshl_b32 s67, s95, 8
s_add_u32 s66, s66, s67
s_add_u32 s67, s66, 0
buffer_load_dwordx4 v[128:131], v27, s[4:7], s67 offen nt
s_add_u32 s67, s66, 65536
buffer_load_dwordx4 v[132:135], v27, s[4:7], s67 offen nt
s_add_u32 s67, s66, 131072
buffer_load_dwordx4 v[136:139], v27, s[4:7], s67 offen nt
s_add_u32 s67, s66, 196608
buffer_load_dwordx4 v[140:143], v27, s[4:7], s67 offen nt
s_add_u32 s67, s66, 8192
buffer_load_dwordx4 v[144:147], v27, s[4:7], s67 offen nt
s_add_u32 s67, s66, 73728
buffer_load_dwordx4 v[148:151], v27, s[4:7], s67 offen nt
s_add_u32 s67, s66, 139264
buffer_load_dwordx4 v[152:155], v27, s[4:7], s67 offen nt
s_add_u32 s67, s66, 204800
buffer_load_dwordx4 v[156:159], v27, s[4:7], s67 offen nt
s_add_u32 s67, s66, 262144
buffer_load_dwordx4 v[160:163], v27, s[4:7], s67 offen nt
s_add_u32 s67, s66, 327680
buffer_load_dwordx4 v[164:167], v27, s[4:7], s67 offen nt
s_add_u32 s67, s66, 393216
buffer_load_dwordx4 v[168:171], v27, s[4:7], s67 offen nt
s_add_u32 s67, s66, 458752
buffer_load_dwordx4 v[172:175], v27, s[4:7], s67 offen nt
s_add_u32 s67, s66, 270336
buffer_load_dwordx4 v[176:179], v27, s[4:7], s67 offen nt
s_add_u32 s67, s66, 335872
buffer_load_dwordx4 v[180:183], v27, s[4:7], s67 offen nt
s_add_u32 s67, s66, 401408
buffer_load_dwordx4 v[184:187], v27, s[4:7], s67 offen nt
s_add_u32 s67, s66, 466944
buffer_load_dwordx4 v[188:191], v27, s[4:7], s67 offen nt
s_add_u32 s67, s66, 524288
buffer_load_dwordx4 v[192:195], v27, s[4:7], s67 offen nt
s_add_u32 s67, s66, 589824
buffer_load_dwordx4 v[196:199], v27, s[4:7], s67 offen nt
s_add_u32 s67, s66, 655360
buffer_load_dwordx4 v[200:203], v27, s[4:7], s67 offen nt
s_add_u32 s67, s66, 720896
buffer_load_dwordx4 v[204:207], v27, s[4:7], s67 offen nt
s_add_u32 s67, s66, 532480
buffer_load_dwordx4 v[208:211], v27, s[4:7], s67 offen nt
s_add_u32 s67, s66, 598016
buffer_load_dwordx4 v[212:215], v27, s[4:7], s67 offen nt
s_add_u32 s67, s66, 663552
buffer_load_dwordx4 v[216:219], v27, s[4:7], s67 offen nt
s_add_u32 s67, s66, 729088
buffer_load_dwordx4 v[220:223], v27, s[4:7], s67 offen nt
s_add_u32 s67, s66, 786432
buffer_load_dwordx4 v[224:227], v27, s[4:7], s67 offen nt
s_add_u32 s67, s66, 851968
buffer_load_dwordx4 v[228:231], v27, s[4:7], s67 offen nt
s_add_u32 s67, s66, 917504
buffer_load_dwordx4 v[232:235], v27, s[4:7], s67 offen nt
s_add_u32 s67, s66, 983040
buffer_load_dwordx4 v[236:239], v27, s[4:7], s67 offen nt
s_add_u32 s67, s66, 794624
buffer_load_dwordx4 v[240:243], v27, s[4:7], s67 offen nt
s_add_u32 s67, s66, 860160
buffer_load_dwordx4 v[244:247], v27, s[4:7], s67 offen nt
s_add_u32 s67, s66, 925696
buffer_load_dwordx4 v[248:251], v27, s[4:7], s67 offen nt
s_add_u32 s67, s66, 991232
buffer_load_dwordx4 v[252:255], v27, s[4:7], s67 offen nt
s_mov_b32 s8, s24
s_and_b32 s9, s25, 0xffff
s_mov_b32 s10, 0x400000
s_mov_b32 s11, 0x20000
v_lshl_add_u32 v13, v1, 14, v26
s_lshl_b32 s93, s44, 17
s_lshl_b32 s67, s42, 8
s_add_u32 s93, s93, s67
s_mov_b32 s45, 0x05040100
s_mov_b32 s46, 0x07060302
s_mov_b32 s52, 0x0
s_mov_b32 s53, 0xffffffff
s_mov_b32 s54, 0xcccccccc
s_mov_b32 s55, 0xcccccccc
s_mov_b32 s56, 0x40408080
s_mov_b32 s57, 0x10102020
s_mov_b32 s58, 0xff00ff00
s_mov_b32 s59, 0xff00ff00
s_mov_b32 s70, 0x1010101
s_mov_b32 s71, 0x1010101
s_mov_b32 s72, 0x2020202
s_mov_b32 s73, 0x2020202
s_mov_b32 s74, 0x4040404
s_mov_b32 s75, 0x4040404
s_mov_b32 s76, 0x8080808
s_mov_b32 s77, 0x8080808
s_mov_b32 s78, 0x10101010
s_mov_b32 s79, 0x10101010
s_mov_b32 s80, 0x20202020
s_mov_b32 s81, 0x20202020
s_mov_b32 s82, 0x40404040
s_mov_b32 s83, 0x40404040
s_mov_b32 s84, 0x80808080
s_mov_b32 s85, 0x80808080
s_mul_i32 s66, s44, 56320
s_add_u32 s66, s66, 0x100000
v_mul_u32_u24 v3, 7040, v1
v_add3_u32 v3, v3, v26, s66
v_min_u32 v4, 2, v1
v_mul_u32_u24 v4, 7040, v4
s_add_u32 s66, s66, 28160
v_add3_u32 v4, v4, v26, s66
s_lshl_b32 s66, s40, 8
v_lshl_add_u32 v7, v1, 10, v26
v_add_u32 v7, s66, v7
s_mov_b32 s67, s66
s_lshl_b32 s66, s43, 10
s_add_u32 s67, s67, s66
v_and_b32 v8, 7, v2
v_lshlrev_b32 v8, 3, v8
v_lshl_add_u32 v8, v1, 6, v8
v_add_u32 v8, s67, v8
s_lshl_b32 s66, s43, 8
v_and_b32 v9, 31, v0
v_lshl_add_u32 v9, v9, 3, s66
s_mul_i32 s66, s40, 960
v_lshl_add_u32 v45, v0, 2, s66
v_mov_b32 v46, 0x3f803f80
ds_write_b32 v45, v46 offset:16000
v_and_b32 v10, 3, v2
v_min_u32 v10, 2, v10
v_mul_u32_u24 v10, 320, v10
v_lshl_add_u32 v10, v1, 4, v10
v_add_u32 v10, s66, v10
v_mul_u32_u24 v11, 320, v25
v_lshrrev_b32 v24, 3, v24
v_add3_u32 v11, v11, v24, v26
v_add_u32 v11, s66, v11
s_lshl_b32 s66, s40, 10
v_lshlrev_b32 v12, 9, v2
v_lshl_add_u32 v12, v1, 7, v12
v_add_u32 v12, s66, v12
s_mul_i32 s94, s40, 2880
v_mul_u32_u24 v44, 320, v28
v_lshrrev_b32 v45, 1, v29
v_lshl_add_u32 v44, v45, 6, v44
v_and_b32 v45, 1, v29
v_lshl_add_u32 v44, v45, 2, v44
v_add_u32 v44, s94, v44
v_lshl_add_u32 v45, v0, 2, s94
v_mov_b32 v46, 0x3f803f80
ds_write_b32 v45, v46 offset:2560
s_waitcnt vmcnt(32)
ds_write_b16 v44, v32 offset:0
ds_write_b16_d16_hi v44, v32 offset:8
ds_write_b16 v44, v33 offset:16
ds_write_b16_d16_hi v44, v33 offset:24
ds_write_b16 v44, v34 offset:32
ds_write_b16_d16_hi v44, v34 offset:40
ds_write_b16 v44, v35 offset:48
ds_write_b16_d16_hi v44, v35 offset:56
ds_write_b16 v44, v36 offset:2
ds_write_b16_d16_hi v44, v36 offset:10
ds_write_b16 v44, v37 offset:18
ds_write_b16_d16_hi v44, v37 offset:26
ds_write_b16 v44, v38 offset:34
ds_write_b16_d16_hi v44, v38 offset:42
ds_write_b16 v44, v39 offset:50
ds_write_b16_d16_hi v44, v39 offset:58
s_barrier
s_cmp_lg_u32 s40, 0
s_cbranch_scc1 Lc49
s_getreg_b32 s66, hwreg(HW_REG_XCC_ID, 0, 4)
s_or_b32 s66, s66, 0x80
v_mov_b32 v24, s43
v_mov_b32 v25, s66
s_mov_b64 exec, 1
global_store_byte v24, v25, s[36:37] sc1
s_mov_b64 exec, -1
Lc49:
s_mul_i32 s66, s43, 49152
s_lshl_b32 s67, s40, 8
s_add_u32 s66, s66, s67
v_lshlrev_b32 v26, 4, v2
v_lshl_add_u32 v20, v1, 10, v26
v_add_u32 v20, s66, v20
v_and_b32 v21, 1, v1
v_mul_u32_u24 v21, 24, v21
v_lshrrev_b32 v27, 1, v1
v_add3_u32 v21, v21, v27, 4
v_lshl_add_u32 v21, v21, 10, v26
v_add_u32 v21, s66, v21
s_mul_i32 s66, s40, 352256
s_mul_i32 s67, s43, 96
s_add_u32 s66, s66, s67
v_mul_u32_u24 v14, 2752, v14
v_and_b32 v27, 7, v2
v_mul_u32_u24 v27, 12, v27
v_add3_u32 v14, v14, v27, s66
s_waitcnt vmcnt(24)
v_perm_b32 v24, v132, v128, s45
v_accvgpr_write_b32 a0, v24
v_perm_b32 v25, v140, v136, s45
v_accvgpr_write_b32 a1, v25
v_perm_b32 v26, v148, v144, s45
v_accvgpr_write_b32 a2, v26
v_perm_b32 v27, v156, v152, s45
v_accvgpr_write_b32 a3, v27
v_perm_b32 v28, v132, v128, s46
v_accvgpr_write_b32 a4, v28
v_perm_b32 v29, v140, v136, s46
v_accvgpr_write_b32 a5, v29
v_perm_b32 v30, v148, v144, s46
v_accvgpr_write_b32 a6, v30
v_perm_b32 v31, v156, v152, s46
v_accvgpr_write_b32 a7, v31
v_perm_b32 v24, v133, v129, s45
v_accvgpr_write_b32 a8, v24
v_perm_b32 v25, v141, v137, s45
v_accvgpr_write_b32 a9, v25
v_perm_b32 v26, v149, v145, s45
v_accvgpr_write_b32 a10, v26
v_perm_b32 v27, v157, v153, s45
v_accvgpr_write_b32 a11, v27
v_perm_b32 v28, v133, v129, s46
v_accvgpr_write_b32 a12, v28
v_perm_b32 v29, v141, v137, s46
v_accvgpr_write_b32 a13, v29
v_perm_b32 v30, v149, v145, s46
v_accvgpr_write_b32 a14, v30
v_perm_b32 v31, v157, v153, s46
v_accvgpr_write_b32 a15, v31
v_perm_b32 v24, v134, v130, s45
v_accvgpr_write_b32 a16, v24
v_perm_b32 v25, v142, v138, s45
v_accvgpr_write_b32 a17, v25
v_perm_b32 v26, v150, v146, s45
v_accvgpr_write_b32 a18, v26
v_perm_b32 v27, v158, v154, s45
v_accvgpr_write_b32 a19, v27
v_perm_b32 v28, v134, v130, s46
v_accvgpr_write_b32 a20, v28
v_perm_b32 v29, v142, v138, s46
v_accvgpr_write_b32 a21, v29
v_perm_b32 v30, v150, v146, s46
v_accvgpr_write_b32 a22, v30
v_perm_b32 v31, v158, v154, s46
v_accvgpr_write_b32 a23, v31
v_perm_b32 v24, v135, v131, s45
v_accvgpr_write_b32 a24, v24
v_perm_b32 v25, v143, v139, s45
v_accvgpr_write_b32 a25, v25
v_perm_b32 v26, v151, v147, s45
v_accvgpr_write_b32 a26, v26
v_perm_b32 v27, v159, v155, s45
v_accvgpr_write_b32 a27, v27
v_perm_b32 v28, v135, v131, s46
v_accvgpr_write_b32 a28, v28
v_perm_b32 v29, v143, v139, s46
v_accvgpr_write_b32 a29, v29
v_perm_b32 v30, v151, v147, s46
v_accvgpr_write_b32 a30, v30
v_perm_b32 v31, v159, v155, s46
v_accvgpr_write_b32 a31, v31
s_waitcnt vmcnt(16)
v_perm_b32 v24, v164, v160, s45
v_accvgpr_write_b32 a32, v24
v_perm_b32 v25, v172, v168, s45
v_accvgpr_write_b32 a33, v25
v_perm_b32 v26, v180, v176, s45
v_accvgpr_write_b32 a34, v26
v_perm_b32 v27, v188, v184, s45
v_accvgpr_write_b32 a35, v27
v_perm_b32 v28, v164, v160, s46
v_accvgpr_write_b32 a36, v28
v_perm_b32 v29, v172, v168, s46
v_accvgpr_write_b32 a37, v29
v_perm_b32 v30, v180, v176, s46
v_accvgpr_write_b32 a38, v30
v_perm_b32 v31, v188, v184, s46
v_accvgpr_write_b32 a39, v31
v_perm_b32 v24, v165, v161, s45
v_accvgpr_write_b32 a40, v24
v_perm_b32 v25, v173, v169, s45
v_accvgpr_write_b32 a41, v25
v_perm_b32 v26, v181, v177, s45
v_accvgpr_write_b32 a42, v26
v_perm_b32 v27, v189, v185, s45
v_accvgpr_write_b32 a43, v27
v_perm_b32 v28, v165, v161, s46
v_accvgpr_write_b32 a44, v28
v_perm_b32 v29, v173, v169, s46
v_accvgpr_write_b32 a45, v29
v_perm_b32 v30, v181, v177, s46
v_accvgpr_write_b32 a46, v30
v_perm_b32 v31, v189, v185, s46
v_accvgpr_write_b32 a47, v31
v_perm_b32 v24, v166, v162, s45
v_accvgpr_write_b32 a48, v24
v_perm_b32 v25, v174, v170, s45
v_accvgpr_write_b32 a49, v25
v_perm_b32 v26, v182, v178, s45
v_accvgpr_write_b32 a50, v26
v_perm_b32 v27, v190, v186, s45
v_accvgpr_write_b32 a51, v27
v_perm_b32 v28, v166, v162, s46
v_accvgpr_write_b32 a52, v28
v_perm_b32 v29, v174, v170, s46
v_accvgpr_write_b32 a53, v29
v_perm_b32 v30, v182, v178, s46
v_accvgpr_write_b32 a54, v30
v_perm_b32 v31, v190, v186, s46
v_accvgpr_write_b32 a55, v31
v_perm_b32 v24, v167, v163, s45
v_accvgpr_write_b32 a56, v24
v_perm_b32 v25, v175, v171, s45
v_accvgpr_write_b32 a57, v25
v_perm_b32 v26, v183, v179, s45
v_accvgpr_write_b32 a58, v26
v_perm_b32 v27, v191, v187, s45
v_accvgpr_write_b32 a59, v27
v_perm_b32 v28, v167, v163, s46
v_accvgpr_write_b32 a60, v28
v_perm_b32 v29, v175, v171, s46
v_accvgpr_write_b32 a61, v29
v_perm_b32 v30, v183, v179, s46
v_accvgpr_write_b32 a62, v30
v_perm_b32 v31, v191, v187, s46
v_accvgpr_write_b32 a63, v31
s_waitcnt vmcnt(8)
v_perm_b32 v24, v196, v192, s45
v_accvgpr_write_b32 a64, v24
v_perm_b32 v25, v204, v200, s45
v_accvgpr_write_b32 a65, v25
v_perm_b32 v26, v212, v208, s45
v_accvgpr_write_b32 a66, v26
v_perm_b32 v27, v220, v216, s45
v_accvgpr_write_b32 a67, v27
v_perm_b32 v28, v196, v192, s46
v_accvgpr_write_b32 a68, v28
v_perm_b32 v29, v204, v200, s46
v_accvgpr_write_b32 a69, v29
v_perm_b32 v30, v212, v208, s46
v_accvgpr_write_b32 a70, v30
v_perm_b32 v31, v220, v216, s46
v_accvgpr_write_b32 a71, v31
v_perm_b32 v24, v197, v193, s45
v_accvgpr_write_b32 a72, v24
v_perm_b32 v25, v205, v201, s45
v_accvgpr_write_b32 a73, v25
v_perm_b32 v26, v213, v209, s45
v_accvgpr_write_b32 a74, v26
v_perm_b32 v27, v221, v217, s45
v_accvgpr_write_b32 a75, v27
v_perm_b32 v28, v197, v193, s46
v_accvgpr_write_b32 a76, v28
v_perm_b32 v29, v205, v201, s46
v_accvgpr_write_b32 a77, v29
v_perm_b32 v30, v213, v209, s46
v_accvgpr_write_b32 a78, v30
v_perm_b32 v31, v221, v217, s46
v_accvgpr_write_b32 a79, v31
v_perm_b32 v24, v198, v194, s45
v_accvgpr_write_b32 a80, v24
v_perm_b32 v25, v206, v202, s45
v_accvgpr_write_b32 a81, v25
v_perm_b32 v26, v214, v210, s45
v_accvgpr_write_b32 a82, v26
v_perm_b32 v27, v222, v218, s45
v_accvgpr_write_b32 a83, v27
v_perm_b32 v28, v198, v194, s46
v_accvgpr_write_b32 a84, v28
v_perm_b32 v29, v206, v202, s46
v_accvgpr_write_b32 a85, v29
v_perm_b32 v30, v214, v210, s46
v_accvgpr_write_b32 a86, v30
v_perm_b32 v31, v222, v218, s46
v_accvgpr_write_b32 a87, v31
v_perm_b32 v24, v199, v195, s45
v_accvgpr_write_b32 a88, v24
v_perm_b32 v25, v207, v203, s45
v_accvgpr_write_b32 a89, v25
v_perm_b32 v26, v215, v211, s45
v_accvgpr_write_b32 a90, v26
v_perm_b32 v27, v223, v219, s45
v_accvgpr_write_b32 a91, v27
v_perm_b32 v28, v199, v195, s46
v_accvgpr_write_b32 a92, v28
v_perm_b32 v29, v207, v203, s46
v_accvgpr_write_b32 a93, v29
v_perm_b32 v30, v215, v211, s46
v_accvgpr_write_b32 a94, v30
v_perm_b32 v31, v223, v219, s46
v_accvgpr_write_b32 a95, v31
s_add_u32 s67, s93, 0
buffer_load_dwordx4 a[128:131], v13, s[8:11], s67 offen offset:0 nt
buffer_load_dwordx4 a[132:135], v13, s[8:11], s67 offen offset:1024 nt
buffer_load_dwordx4 a[136:139], v13, s[8:11], s67 offen offset:2048 nt
buffer_load_dwordx4 a[140:143], v13, s[8:11], s67 offen offset:3072 nt
s_add_u32 s67, s93, 8192
buffer_load_dwordx4 a[144:147], v13, s[8:11], s67 offen offset:0 nt
buffer_load_dwordx4 a[148:151], v13, s[8:11], s67 offen offset:1024 nt
buffer_load_dwordx4 a[152:155], v13, s[8:11], s67 offen offset:2048 nt
buffer_load_dwordx4 a[156:159], v13, s[8:11], s67 offen offset:3072 nt
s_add_u32 s67, s93, 65536
buffer_load_dwordx4 a[160:163], v13, s[8:11], s67 offen offset:0 nt
buffer_load_dwordx4 a[164:167], v13, s[8:11], s67 offen offset:1024 nt
buffer_load_dwordx4 a[168:171], v13, s[8:11], s67 offen offset:2048 nt
buffer_load_dwordx4 a[172:175], v13, s[8:11], s67 offen offset:3072 nt
s_add_u32 s67, s93, 73728
buffer_load_dwordx4 a[176:179], v13, s[8:11], s67 offen offset:0 nt
buffer_load_dwordx4 a[180:183], v13, s[8:11], s67 offen offset:1024 nt
buffer_load_dwordx4 a[184:187], v13, s[8:11], s67 offen offset:2048 nt
buffer_load_dwordx4 a[188:191], v13, s[8:11], s67 offen offset:3072 nt
s_waitcnt vmcnt(16)
v_perm_b32 v24, v228, v224, s45
v_accvgpr_write_b32 a96, v24
v_perm_b32 v25, v236, v232, s45
v_accvgpr_write_b32 a97, v25
v_perm_b32 v26, v244, v240, s45
v_accvgpr_write_b32 a98, v26
v_perm_b32 v27, v252, v248, s45
v_accvgpr_write_b32 a99, v27
v_perm_b32 v28, v228, v224, s46
v_accvgpr_write_b32 a100, v28
v_perm_b32 v29, v236, v232, s46
v_accvgpr_write_b32 a101, v29
v_perm_b32 v30, v244, v240, s46
v_accvgpr_write_b32 a102, v30
v_perm_b32 v31, v252, v248, s46
v_accvgpr_write_b32 a103, v31
v_perm_b32 v24, v229, v225, s45
v_accvgpr_write_b32 a104, v24
v_perm_b32 v25, v237, v233, s45
v_accvgpr_write_b32 a105, v25
v_perm_b32 v26, v245, v241, s45
v_accvgpr_write_b32 a106, v26
v_perm_b32 v27, v253, v249, s45
v_accvgpr_write_b32 a107, v27
v_perm_b32 v28, v229, v225, s46
v_accvgpr_write_b32 a108, v28
v_perm_b32 v29, v237, v233, s46
v_accvgpr_write_b32 a109, v29
v_perm_b32 v30, v245, v241, s46
v_accvgpr_write_b32 a110, v30
v_perm_b32 v31, v253, v249, s46
v_accvgpr_write_b32 a111, v31
v_perm_b32 v24, v230, v226, s45
v_accvgpr_write_b32 a112, v24
v_perm_b32 v25, v238, v234, s45
v_accvgpr_write_b32 a113, v25
v_perm_b32 v26, v246, v242, s45
v_accvgpr_write_b32 a114, v26
v_perm_b32 v27, v254, v250, s45
v_accvgpr_write_b32 a115, v27
v_perm_b32 v28, v230, v226, s46
v_accvgpr_write_b32 a116, v28
v_perm_b32 v29, v238, v234, s46
v_accvgpr_write_b32 a117, v29
v_perm_b32 v30, v246, v242, s46
v_accvgpr_write_b32 a118, v30
v_perm_b32 v31, v254, v250, s46
v_accvgpr_write_b32 a119, v31
v_perm_b32 v24, v231, v227, s45
v_accvgpr_write_b32 a120, v24
v_perm_b32 v25, v239, v235, s45
v_accvgpr_write_b32 a121, v25
v_perm_b32 v26, v247, v243, s45
v_accvgpr_write_b32 a122, v26
v_perm_b32 v27, v255, v251, s45
v_accvgpr_write_b32 a123, v27
v_perm_b32 v28, v231, v227, s46
v_accvgpr_write_b32 a124, v28
v_perm_b32 v29, v239, v235, s46
v_accvgpr_write_b32 a125, v29
v_perm_b32 v30, v247, v243, s46
v_accvgpr_write_b32 a126, v30
v_perm_b32 v31, v255, v251, s46
v_accvgpr_write_b32 a127, v31
s_add_u32 s67, s93, 4096
buffer_load_dwordx4 a[192:195], v13, s[8:11], s67 offen offset:0 nt
buffer_load_dwordx4 a[196:199], v13, s[8:11], s67 offen offset:1024 nt
buffer_load_dwordx4 a[200:203], v13, s[8:11], s67 offen offset:2048 nt
buffer_load_dwordx4 a[204:207], v13, s[8:11], s67 offen offset:3072 nt
s_add_u32 s67, s93, 12288
buffer_load_dwordx4 a[208:211], v13, s[8:11], s67 offen offset:0 nt
buffer_load_dwordx4 a[212:215], v13, s[8:11], s67 offen offset:1024 nt
buffer_load_dwordx4 a[216:219], v13, s[8:11], s67 offen offset:2048 nt
buffer_load_dwordx4 a[220:223], v13, s[8:11], s67 offen offset:3072 nt
s_add_u32 s67, s93, 69632
buffer_load_dwordx4 a[224:227], v13, s[8:11], s67 offen offset:0 nt
buffer_load_dwordx4 a[228:231], v13, s[8:11], s67 offen offset:1024 nt
buffer_load_dwordx4 a[232:235], v13, s[8:11], s67 offen offset:2048 nt
buffer_load_dwordx4 a[236:239], v13, s[8:11], s67 offen offset:3072 nt
s_add_u32 s67, s93, 77824
buffer_load_dwordx4 a[240:243], v13, s[8:11], s67 offen offset:0 nt
buffer_load_dwordx4 a[244:247], v13, s[8:11], s67 offen offset:1024 nt
buffer_load_dwordx4 a[248:251], v13, s[8:11], s67 offen offset:2048 nt
buffer_load_dwordx4 a[252:255], v13, s[8:11], s67 offen offset:3072 nt
v_min_u32 v24, 8, v2
v_mul_u32_u24 v24, 320, v24
v_lshl_add_u32 v24, v1, 4, v24
v_add_u32 v28, s94, v24
s_waitcnt lgkmcnt(0)
ds_read_b128 v[32:35], v28 offset:0
ds_read_b128 v[36:39], v28 offset:64
ds_read_b128 v[40:43], v28 offset:128
ds_read_b128 v[44:47], v28 offset:192
s_waitcnt lgkmcnt(3)
v_mfma_f32_16x16x32_bf16 v[24:27], v[32:35], v[32:35], 0
v_mfma_f32_16x16x32_bf16 v[48:51], a[0:3], v[32:35], 0
v_mfma_f32_16x16x32_bf16 v[52:55], a[4:7], v[32:35], 0
v_mfma_f32_16x16x32_bf16 v[56:59], a[8:11], v[32:35], 0
v_mfma_f32_16x16x32_bf16 v[60:63], a[12:15], v[32:35], 0
v_mfma_f32_16x16x32_bf16 v[64:67], a[16:19], v[32:35], 0
v_mfma_f32_16x16x32_bf16 v[68:71], a[20:23], v[32:35], 0
v_mfma_f32_16x16x32_bf16 v[72:75], a[24:27], v[32:35], 0
v_mfma_f32_16x16x32_bf16 v[76:79], a[28:31], v[32:35], 0
s_waitcnt lgkmcnt(2)
v_mfma_f32_16x16x32_bf16 v[24:27], v[36:39], v[36:39], v[24:27]
v_mfma_f32_16x16x32_bf16 v[48:51], a[32:35], v[36:39], v[48:51]
v_mfma_f32_16x16x32_bf16 v[52:55], a[36:39], v[36:39], v[52:55]
v_mfma_f32_16x16x32_bf16 v[56:59], a[40:43], v[36:39], v[56:59]
v_mfma_f32_16x16x32_bf16 v[60:63], a[44:47], v[36:39], v[60:63]
v_mfma_f32_16x16x32_bf16 v[64:67], a[48:51], v[36:39], v[64:67]
v_mfma_f32_16x16x32_bf16 v[68:71], a[52:55], v[36:39], v[68:71]
v_mfma_f32_16x16x32_bf16 v[72:75], a[56:59], v[36:39], v[72:75]
v_mfma_f32_16x16x32_bf16 v[76:79], a[60:63], v[36:39], v[76:79]
s_waitcnt lgkmcnt(1)
v_mfma_f32_16x16x32_bf16 v[24:27], v[40:43], v[40:43], v[24:27]
v_mfma_f32_16x16x32_bf16 v[48:51], a[64:67], v[40:43], v[48:51]
v_mfma_f32_16x16x32_bf16 v[52:55], a[68:71], v[40:43], v[52:55]
v_mfma_f32_16x16x32_bf16 v[56:59], a[72:75], v[40:43], v[56:59]
v_mfma_f32_16x16x32_bf16 v[60:63], a[76:79], v[40:43], v[60:63]
v_mfma_f32_16x16x32_bf16 v[64:67], a[80:83], v[40:43], v[64:67]
v_mfma_f32_16x16x32_bf16 v[68:71], a[84:87], v[40:43], v[68:71]
v_mfma_f32_16x16x32_bf16 v[72:75], a[88:91], v[40:43], v[72:75]
v_mfma_f32_16x16x32_bf16 v[76:79], a[92:95], v[40:43], v[76:79]
s_waitcnt lgkmcnt(0)
v_mfma_f32_16x16x32_bf16 v[24:27], v[44:47], v[44:47], v[24:27]
v_mfma_f32_16x16x32_bf16 v[48:51], a[96:99], v[44:47], v[48:51]
v_mfma_f32_16x16x32_bf16 v[52:55], a[100:103], v[44:47], v[52:55]
v_mfma_f32_16x16x32_bf16 v[56:59], a[104:107], v[44:47], v[56:59]
v_mfma_f32_16x16x32_bf16 v[60:63], a[108:111], v[44:47], v[60:63]
v_mfma_f32_16x16x32_bf16 v[64:67], a[112:115], v[44:47], v[64:67]
v_mfma_f32_16x16x32_bf16 v[68:71], a[116:119], v[44:47], v[68:71]
v_mfma_f32_16x16x32_bf16 v[72:75], a[120:123], v[44:47], v[72:75]
v_mfma_f32_16x16x32_bf16 v[76:79], a[124:127], v[44:47], v[76:79]
s_mul_i32 s66, s40, 9216
v_lshlrev_b32 v28, 10, v2
v_lshl_add_u32 v28, v1, 7, v28
v_add_u32 v28, s66, v28
s_mov_b32 exec_lo, 0x1ff01ff
s_mov_b32 exec_hi, 0x1ff01ff
ds_write_b128 v28, v[24:27] offset:20992
ds_write_b128 v28, v[48:51] offset:20480
ds_write_b128 v28, v[52:55] offset:20496
ds_write_b128 v28, v[56:59] offset:20512
ds_write_b128 v28, v[60:63] offset:20528
ds_write_b128 v28, v[64:67] offset:20544
ds_write_b128 v28, v[68:71] offset:20560
ds_write_b128 v28, v[72:75] offset:20576
ds_write_b128 v28, v[76:79] offset:20592
s_mov_b64 exec, -1
s_waitcnt lgkmcnt(0)
s_barrier
v_lshlrev_b32 v24, 2, v0
v_and_b32 v31, 3, v0
v_lshlrev_b32 v31, 5, v31
v_and_b32 v30, 12, v0
v_lshl_add_u32 v30, v1, 7, v30
v_add_u32 v13, v31, v30
ds_read_b32 v48, v13 offset:28672
ds_read_b32 v49, v13 offset:28688
ds_read_b32 v50, v13 offset:37888
ds_read_b32 v51, v13 offset:37904
ds_read_b32 v52, v13 offset:47104
ds_read_b32 v53, v13 offset:47120
ds_read_b32 v54, v13 offset:56320
ds_read_b32 v55, v13 offset:56336
s_waitcnt lgkmcnt(0)
v_add_f32 v48, v48, v50
v_add_f32 v52, v52, v54
v_add_f32 v18, v48, v52
v_add_f32 v49, v49, v51
v_add_f32 v53, v53, v55
v_add_f32 v19, v49, v53
s_lshl_b32 s66, s40, 11
v_add_u32 v31, s66, v13
v_mov_b32 v30, s66
s_lshr_b32 s67, s40, 1
s_lshl_b32 s67, s67, 7
s_add_u32 s66, s66, s67
s_and_b32 s67, s40, 1
s_lshl_b32 s67, s67, 3
s_add_u32 s66, s66, s67
v_mov_b32 v29, s66
s_lshl_b32 s66, s95, 12
s_lshl_b32 s67, s40, 9
s_add_u32 s66, s66, s67
ds_read_b32 v56, v29 offset:20992
ds_read_b32 v58, v30 offset:21248
ds_read_b32 v60, v29 offset:30208
ds_read_b32 v62, v30 offset:30464
ds_read_b32 v64, v29 offset:39424
ds_read_b32 v66, v30 offset:39680
ds_read_b32 v68, v29 offset:48640
ds_read_b32 v70, v30 offset:48896
s_waitcnt lgkmcnt(0)
ds_read_b32 v48, v31 offset:20480
ds_read_b32 v49, v31 offset:20496
ds_read_b32 v50, v31 offset:29696
ds_read_b32 v51, v31 offset:29712
ds_read_b32 v52, v31 offset:38912
ds_read_b32 v53, v31 offset:38928
ds_read_b32 v54, v31 offset:48128
ds_read_b32 v55, v31 offset:48144
s_waitcnt lgkmcnt(8)
v_add_f32 v56, v56, v60
v_add_f32 v64, v64, v68
v_add_f32 v58, v58, v62
v_add_f32 v66, v66, v70
v_add_f32 v56, v56, v64
v_add_f32 v58, v58, v66
v_mul_f32 v60, 0x3b000000, v58
v_mul_f32 v56, 0x3b000000, v56
v_fma_f32 v56, -v60, v60, v56
v_max_f32 v56, 0, v56
v_add_f32 v56, 0x3727c5ac, v56
v_rsq_f32 v61, v56
s_waitcnt lgkmcnt(0)
v_pk_add_f32 v[48:49], v[48:49], v[50:51]
v_pk_add_f32 v[52:53], v[52:53], v[54:55]
v_pk_add_f32 v[48:49], v[48:49], v[52:53]
v_fma_f32 v48, -v60, v18, v48
v_fma_f32 v49, -v60, v19, v49
v_mul_f32 v48, v48, v61
v_mul_f32 v49, v49, v61
v_cvt_pk_bf16_f32 v48, v48, v49
v_min_u32 v48, -2, v48
buffer_store_dword v48, v24, s[12:15], s66 offen offset:0 sc1
ds_read_b32 v56, v29 offset:22020
ds_read_b32 v58, v30 offset:22272
ds_read_b32 v60, v29 offset:31236
ds_read_b32 v62, v30 offset:31488
ds_read_b32 v64, v29 offset:40452
ds_read_b32 v66, v30 offset:40704
ds_read_b32 v68, v29 offset:49668
ds_read_b32 v70, v30 offset:49920
s_waitcnt lgkmcnt(0)
ds_read_b32 v48, v31 offset:21504
ds_read_b32 v49, v31 offset:21520
ds_read_b32 v50, v31 offset:30720
ds_read_b32 v51, v31 offset:30736
ds_read_b32 v52, v31 offset:39936
ds_read_b32 v53, v31 offset:39952
ds_read_b32 v54, v31 offset:49152
ds_read_b32 v55, v31 offset:49168
s_waitcnt lgkmcnt(8)
v_add_f32 v56, v56, v60
v_add_f32 v64, v64, v68
v_add_f32 v58, v58, v62
v_add_f32 v66, v66, v70
v_add_f32 v56, v56, v64
v_add_f32 v58, v58, v66
v_mul_f32 v60, 0x3b000000, v58
v_mul_f32 v56, 0x3b000000, v56
v_fma_f32 v56, -v60, v60, v56
v_max_f32 v56, 0, v56
v_add_f32 v56, 0x3727c5ac, v56
v_rsq_f32 v61, v56
s_waitcnt lgkmcnt(0)
v_pk_add_f32 v[48:49], v[48:49], v[50:51]
v_pk_add_f32 v[52:53], v[52:53], v[54:55]
v_pk_add_f32 v[48:49], v[48:49], v[52:53]
v_fma_f32 v48, -v60, v18, v48
v_fma_f32 v49, -v60, v19, v49
v_mul_f32 v48, v48, v61
v_mul_f32 v49, v49, v61
v_cvt_pk_bf16_f32 v48, v48, v49
v_min_u32 v48, -2, v48
buffer_store_dword v48, v24, s[12:15], s66 offen offset:256 sc1
s_mov_b32 s4, s32
s_and_b32 s5, s33, 0xffff
s_mov_b32 s6, 0x158000
s_mov_b32 s7, 0x20000
buffer_load_dwordx4 v[80:83], v20, s[4:7], 0 offen nt
v_add_u32 v20, 6144, v20
buffer_load_dwordx4 v[84:87], v20, s[4:7], 0 offen nt
v_add_u32 v20, 6144, v20
buffer_load_dwordx4 v[88:91], v20, s[4:7], 0 offen nt
v_add_u32 v20, 6144, v20
buffer_load_dwordx4 v[92:95], v20, s[4:7], 0 offen nt
v_add_u32 v20, 6144, v20
buffer_load_dwordx4 v[96:99], v20, s[4:7], 0 offen nt
v_add_u32 v20, 6144, v20
buffer_load_dwordx4 v[100:103], v20, s[4:7], 0 offen nt
v_add_u32 v20, 6144, v20
buffer_load_dwordx4 v[104:107], v20, s[4:7], 0 offen nt
v_add_u32 v20, 6144, v20
buffer_load_dwordx4 v[108:111], v20, s[4:7], 0 offen nt
v_add_u32 v20, 6144, v20
buffer_load_dwordx4 v[112:115], v21, s[4:7], 0 offen nt
v_add_u32 v21, 6144, v21
buffer_load_dwordx4 v[116:119], v21, s[4:7], 0 offen nt
v_add_u32 v21, 6144, v21
buffer_load_dwordx4 v[120:123], v21, s[4:7], 0 offen nt
v_add_u32 v21, 6144, v21
buffer_load_dwordx4 v[124:127], v21, s[4:7], 0 offen nt
v_add_u32 v21, 6144, v21
s_mov_b32 s4, s28
s_and_b32 s5, s29, 0xffff
s_mov_b32 s6, 0x158000
s_mov_b32 s7, 0x20000
s_mov_b32 s8, s30
s_and_b32 s9, s31, 0xffff
s_mov_b32 s10, 0x158000
s_mov_b32 s11, 0x20000
s_barrier
s_waitcnt vmcnt(14)
v_add_u32 v15, 0, v14
s_not_b64 exec, s[58:59]
buffer_load_dwordx3 v[128:130], v15, s[4:7], 0 offen nt
s_mov_b64 exec, s[58:59]
buffer_load_dwordx3 v[128:130], v15, s[8:11], 0 offen nt
s_mov_b64 exec, -1
v_add_u32 v16, 22016, v14
s_not_b64 exec, s[58:59]
buffer_load_dwordx3 v[132:134], v16, s[4:7], 0 offen nt
s_mov_b64 exec, s[58:59]
buffer_load_dwordx3 v[132:134], v16, s[8:11], 0 offen nt
s_mov_b64 exec, -1
v_add_u32 v17, 44032, v14
s_not_b64 exec, s[58:59]
buffer_load_dwordx3 v[136:138], v17, s[4:7], 0 offen nt
s_mov_b64 exec, s[58:59]
buffer_load_dwordx3 v[136:138], v17, s[8:11], 0 offen nt
s_mov_b64 exec, -1
v_add_u32 v15, 66048, v14
s_not_b64 exec, s[58:59]
buffer_load_dwordx3 v[140:142], v15, s[4:7], 0 offen nt
s_mov_b64 exec, s[58:59]
buffer_load_dwordx3 v[140:142], v15, s[8:11], 0 offen nt
s_mov_b64 exec, -1
v_add_u32 v16, 2752, v14
s_not_b64 exec, s[58:59]
buffer_load_dwordx3 v[144:146], v16, s[4:7], 0 offen nt
s_mov_b64 exec, s[58:59]
buffer_load_dwordx3 v[144:146], v16, s[8:11], 0 offen nt
s_mov_b64 exec, -1
v_add_u32 v17, 24768, v14
s_not_b64 exec, s[58:59]
buffer_load_dwordx3 v[148:150], v17, s[4:7], 0 offen nt
s_mov_b64 exec, s[58:59]
buffer_load_dwordx3 v[148:150], v17, s[8:11], 0 offen nt
s_mov_b64 exec, -1
v_add_u32 v15, 46784, v14
s_not_b64 exec, s[58:59]
buffer_load_dwordx3 v[152:154], v15, s[4:7], 0 offen nt
s_mov_b64 exec, s[58:59]
buffer_load_dwordx3 v[152:154], v15, s[8:11], 0 offen nt
s_mov_b64 exec, -1
v_add_u32 v16, 68800, v14
s_not_b64 exec, s[58:59]
buffer_load_dwordx3 v[156:158], v16, s[4:7], 0 offen nt
s_mov_b64 exec, s[58:59]
buffer_load_dwordx3 v[156:158], v16, s[8:11], 0 offen nt
s_mov_b64 exec, -1
v_accvgpr_read_b32 v32, a128
v_accvgpr_read_b32 v33, a129
v_accvgpr_read_b32 v34, a130
v_accvgpr_read_b32 v35, a131
v_accvgpr_read_b32 v36, a132
v_accvgpr_read_b32 v37, a133
v_accvgpr_read_b32 v38, a134
v_accvgpr_read_b32 v39, a135
v_accvgpr_read_b32 v40, a136
v_accvgpr_read_b32 v41, a137
v_accvgpr_read_b32 v42, a138
v_accvgpr_read_b32 v43, a139
v_accvgpr_read_b32 v44, a140
v_accvgpr_read_b32 v45, a141
v_accvgpr_read_b32 v46, a142
v_accvgpr_read_b32 v47, a143
v_accvgpr_read_b32 v48, a144
v_accvgpr_read_b32 v49, a145
v_accvgpr_read_b32 v50, a146
v_accvgpr_read_b32 v51, a147
v_accvgpr_read_b32 v52, a148
v_accvgpr_read_b32 v53, a149
v_accvgpr_read_b32 v54, a150
v_accvgpr_read_b32 v55, a151
v_accvgpr_read_b32 v56, a152
v_accvgpr_read_b32 v57, a153
v_accvgpr_read_b32 v58, a154
v_accvgpr_read_b32 v59, a155
v_accvgpr_read_b32 v60, a156
v_accvgpr_read_b32 v61, a157
v_accvgpr_read_b32 v62, a158
v_accvgpr_read_b32 v63, a159
v_perm_b32 v24, v36, v32, s45
v_accvgpr_write_b32 a128, v24
v_perm_b32 v25, v44, v40, s45
v_accvgpr_write_b32 a129, v25
v_perm_b32 v26, v52, v48, s45
v_accvgpr_write_b32 a130, v26
v_perm_b32 v27, v60, v56, s45
v_accvgpr_write_b32 a131, v27
v_perm_b32 v28, v36, v32, s46
v_accvgpr_write_b32 a132, v28
v_perm_b32 v29, v44, v40, s46
v_accvgpr_write_b32 a133, v29
v_perm_b32 v30, v52, v48, s46
v_accvgpr_write_b32 a134, v30
v_perm_b32 v31, v60, v56, s46
v_accvgpr_write_b32 a135, v31
v_perm_b32 v24, v37, v33, s45
v_accvgpr_write_b32 a136, v24
v_perm_b32 v25, v45, v41, s45
v_accvgpr_write_b32 a137, v25
v_perm_b32 v26, v53, v49, s45
v_accvgpr_write_b32 a138, v26
v_perm_b32 v27, v61, v57, s45
v_accvgpr_write_b32 a139, v27
v_perm_b32 v28, v37, v33, s46
v_accvgpr_write_b32 a140, v28
v_perm_b32 v29, v45, v41, s46
v_accvgpr_write_b32 a141, v29
v_perm_b32 v30, v53, v49, s46
v_accvgpr_write_b32 a142, v30
v_perm_b32 v31, v61, v57, s46
v_accvgpr_write_b32 a143, v31
v_perm_b32 v24, v38, v34, s45
v_accvgpr_write_b32 a144, v24
v_perm_b32 v25, v46, v42, s45
v_accvgpr_write_b32 a145, v25
v_perm_b32 v26, v54, v50, s45
v_accvgpr_write_b32 a146, v26
v_perm_b32 v27, v62, v58, s45
v_accvgpr_write_b32 a147, v27
v_perm_b32 v28, v38, v34, s46
v_accvgpr_write_b32 a148, v28
v_perm_b32 v29, v46, v42, s46
v_accvgpr_write_b32 a149, v29
v_perm_b32 v30, v54, v50, s46
v_accvgpr_write_b32 a150, v30
v_perm_b32 v31, v62, v58, s46
v_accvgpr_write_b32 a151, v31
v_perm_b32 v24, v39, v35, s45
v_accvgpr_write_b32 a152, v24
v_perm_b32 v25, v47, v43, s45
v_accvgpr_write_b32 a153, v25
v_perm_b32 v26, v55, v51, s45
v_accvgpr_write_b32 a154, v26
v_perm_b32 v27, v63, v59, s45
v_accvgpr_write_b32 a155, v27
v_perm_b32 v28, v39, v35, s46
v_accvgpr_write_b32 a156, v28
v_perm_b32 v29, v47, v43, s46
v_accvgpr_write_b32 a157, v29
v_perm_b32 v30, v55, v51, s46
v_accvgpr_write_b32 a158, v30
v_perm_b32 v31, v63, v59, s46
v_accvgpr_write_b32 a159, v31
v_add_u32 v15, 88064, v14
s_not_b64 exec, s[58:59]
buffer_load_dwordx3 v[160:162], v15, s[4:7], 0 offen nt
s_mov_b64 exec, s[58:59]
buffer_load_dwordx3 v[160:162], v15, s[8:11], 0 offen nt
s_mov_b64 exec, -1
v_add_u32 v16, 110080, v14
s_not_b64 exec, s[58:59]
buffer_load_dwordx3 v[164:166], v16, s[4:7], 0 offen nt
s_mov_b64 exec, s[58:59]
buffer_load_dwordx3 v[164:166], v16, s[8:11], 0 offen nt
s_mov_b64 exec, -1
v_add_u32 v17, 132096, v14
s_not_b64 exec, s[58:59]
buffer_load_dwordx3 v[168:170], v17, s[4:7], 0 offen nt
s_mov_b64 exec, s[58:59]
buffer_load_dwordx3 v[168:170], v17, s[8:11], 0 offen nt
s_mov_b64 exec, -1
v_add_u32 v15, 154112, v14
s_not_b64 exec, s[58:59]
buffer_load_dwordx3 v[172:174], v15, s[4:7], 0 offen nt
s_mov_b64 exec, s[58:59]
buffer_load_dwordx3 v[172:174], v15, s[8:11], 0 offen nt
s_mov_b64 exec, -1
v_add_u32 v16, 90816, v14
s_not_b64 exec, s[58:59]
buffer_load_dwordx3 v[176:178], v16, s[4:7], 0 offen nt
s_mov_b64 exec, s[58:59]
buffer_load_dwordx3 v[176:178], v16, s[8:11], 0 offen nt
s_mov_b64 exec, -1
v_add_u32 v17, 112832, v14
s_not_b64 exec, s[58:59]
buffer_load_dwordx3 v[180:182], v17, s[4:7], 0 offen nt
s_mov_b64 exec, s[58:59]
buffer_load_dwordx3 v[180:182], v17, s[8:11], 0 offen nt
s_mov_b64 exec, -1
v_add_u32 v15, 134848, v14
s_not_b64 exec, s[58:59]
buffer_load_dwordx3 v[184:186], v15, s[4:7], 0 offen nt
s_mov_b64 exec, s[58:59]
buffer_load_dwordx3 v[184:186], v15, s[8:11], 0 offen nt
s_mov_b64 exec, -1
v_add_u32 v16, 156864, v14
s_not_b64 exec, s[58:59]
buffer_load_dwordx3 v[188:190], v16, s[4:7], 0 offen nt
s_mov_b64 exec, s[58:59]
buffer_load_dwordx3 v[188:190], v16, s[8:11], 0 offen nt
s_mov_b64 exec, -1
v_accvgpr_read_b32 v32, a160
v_accvgpr_read_b32 v33, a161
v_accvgpr_read_b32 v34, a162
v_accvgpr_read_b32 v35, a163
v_accvgpr_read_b32 v36, a164
v_accvgpr_read_b32 v37, a165
v_accvgpr_read_b32 v38, a166
v_accvgpr_read_b32 v39, a167
v_accvgpr_read_b32 v40, a168
v_accvgpr_read_b32 v41, a169
v_accvgpr_read_b32 v42, a170
v_accvgpr_read_b32 v43, a171
v_accvgpr_read_b32 v44, a172
v_accvgpr_read_b32 v45, a173
v_accvgpr_read_b32 v46, a174
v_accvgpr_read_b32 v47, a175
v_accvgpr_read_b32 v48, a176
v_accvgpr_read_b32 v49, a177
v_accvgpr_read_b32 v50, a178
v_accvgpr_read_b32 v51, a179
v_accvgpr_read_b32 v52, a180
v_accvgpr_read_b32 v53, a181
v_accvgpr_read_b32 v54, a182
v_accvgpr_read_b32 v55, a183
v_accvgpr_read_b32 v56, a184
v_accvgpr_read_b32 v57, a185
v_accvgpr_read_b32 v58, a186
v_accvgpr_read_b32 v59, a187
v_accvgpr_read_b32 v60, a188
v_accvgpr_read_b32 v61, a189
v_accvgpr_read_b32 v62, a190
v_accvgpr_read_b32 v63, a191
v_perm_b32 v24, v36, v32, s45
v_accvgpr_write_b32 a160, v24
v_perm_b32 v25, v44, v40, s45
v_accvgpr_write_b32 a161, v25
v_perm_b32 v26, v52, v48, s45
v_accvgpr_write_b32 a162, v26
v_perm_b32 v27, v60, v56, s45
v_accvgpr_write_b32 a163, v27
v_perm_b32 v28, v36, v32, s46
v_accvgpr_write_b32 a164, v28
v_perm_b32 v29, v44, v40, s46
v_accvgpr_write_b32 a165, v29
v_perm_b32 v30, v52, v48, s46
v_accvgpr_write_b32 a166, v30
v_perm_b32 v31, v60, v56, s46
v_accvgpr_write_b32 a167, v31
v_perm_b32 v24, v37, v33, s45
v_accvgpr_write_b32 a168, v24
v_perm_b32 v25, v45, v41, s45
v_accvgpr_write_b32 a169, v25
v_perm_b32 v26, v53, v49, s45
v_accvgpr_write_b32 a170, v26
v_perm_b32 v27, v61, v57, s45
v_accvgpr_write_b32 a171, v27
v_perm_b32 v28, v37, v33, s46
v_accvgpr_write_b32 a172, v28
v_perm_b32 v29, v45, v41, s46
v_accvgpr_write_b32 a173, v29
v_perm_b32 v30, v53, v49, s46
v_accvgpr_write_b32 a174, v30
v_perm_b32 v31, v61, v57, s46
v_accvgpr_write_b32 a175, v31
v_perm_b32 v24, v38, v34, s45
v_accvgpr_write_b32 a176, v24
v_perm_b32 v25, v46, v42, s45
v_accvgpr_write_b32 a177, v25
v_perm_b32 v26, v54, v50, s45
v_accvgpr_write_b32 a178, v26
v_perm_b32 v27, v62, v58, s45
v_accvgpr_write_b32 a179, v27
v_perm_b32 v28, v38, v34, s46
v_accvgpr_write_b32 a180, v28
v_perm_b32 v29, v46, v42, s46
v_accvgpr_write_b32 a181, v29
v_perm_b32 v30, v54, v50, s46
v_accvgpr_write_b32 a182, v30
v_perm_b32 v31, v62, v58, s46
v_accvgpr_write_b32 a183, v31
v_perm_b32 v24, v39, v35, s45
v_accvgpr_write_b32 a184, v24
v_perm_b32 v25, v47, v43, s45
v_accvgpr_write_b32 a185, v25
v_perm_b32 v26, v55, v51, s45
v_accvgpr_write_b32 a186, v26
v_perm_b32 v27, v63, v59, s45
v_accvgpr_write_b32 a187, v27
v_perm_b32 v28, v39, v35, s46
v_accvgpr_write_b32 a188, v28
v_perm_b32 v29, v47, v43, s46
v_accvgpr_write_b32 a189, v29
v_perm_b32 v30, v55, v51, s46
v_accvgpr_write_b32 a190, v30
v_perm_b32 v31, v63, v59, s46
v_accvgpr_write_b32 a191, v31
v_add_u32 v15, 176128, v14
s_not_b64 exec, s[58:59]
buffer_load_dwordx3 v[192:194], v15, s[4:7], 0 offen nt
s_mov_b64 exec, s[58:59]
buffer_load_dwordx3 v[192:194], v15, s[8:11], 0 offen nt
s_mov_b64 exec, -1
v_add_u32 v16, 198144, v14
s_not_b64 exec, s[58:59]
buffer_load_dwordx3 v[196:198], v16, s[4:7], 0 offen nt
s_mov_b64 exec, s[58:59]
buffer_load_dwordx3 v[196:198], v16, s[8:11], 0 offen nt
s_mov_b64 exec, -1
v_add_u32 v17, 220160, v14
s_not_b64 exec, s[58:59]
buffer_load_dwordx3 v[200:202], v17, s[4:7], 0 offen nt
s_mov_b64 exec, s[58:59]
buffer_load_dwordx3 v[200:202], v17, s[8:11], 0 offen nt
s_mov_b64 exec, -1
v_add_u32 v15, 242176, v14
s_not_b64 exec, s[58:59]
buffer_load_dwordx3 v[204:206], v15, s[4:7], 0 offen nt
s_mov_b64 exec, s[58:59]
buffer_load_dwordx3 v[204:206], v15, s[8:11], 0 offen nt
s_mov_b64 exec, -1
v_add_u32 v16, 178880, v14
s_not_b64 exec, s[58:59]
buffer_load_dwordx3 v[208:210], v16, s[4:7], 0 offen nt
s_mov_b64 exec, s[58:59]
buffer_load_dwordx3 v[208:210], v16, s[8:11], 0 offen nt
s_mov_b64 exec, -1
v_add_u32 v17, 200896, v14
s_not_b64 exec, s[58:59]
buffer_load_dwordx3 v[212:214], v17, s[4:7], 0 offen nt
s_mov_b64 exec, s[58:59]
buffer_load_dwordx3 v[212:214], v17, s[8:11], 0 offen nt
s_mov_b64 exec, -1
v_add_u32 v15, 222912, v14
s_not_b64 exec, s[58:59]
buffer_load_dwordx3 v[216:218], v15, s[4:7], 0 offen nt
s_mov_b64 exec, s[58:59]
buffer_load_dwordx3 v[216:218], v15, s[8:11], 0 offen nt
s_mov_b64 exec, -1
v_add_u32 v16, 244928, v14
s_not_b64 exec, s[58:59]
buffer_load_dwordx3 v[220:222], v16, s[4:7], 0 offen nt
s_mov_b64 exec, s[58:59]
buffer_load_dwordx3 v[220:222], v16, s[8:11], 0 offen nt
s_mov_b64 exec, -1
v_accvgpr_read_b32 v32, a192
v_accvgpr_read_b32 v33, a193
v_accvgpr_read_b32 v34, a194
v_accvgpr_read_b32 v35, a195
v_accvgpr_read_b32 v36, a196
v_accvgpr_read_b32 v37, a197
v_accvgpr_read_b32 v38, a198
v_accvgpr_read_b32 v39, a199
v_accvgpr_read_b32 v40, a200
v_accvgpr_read_b32 v41, a201
v_accvgpr_read_b32 v42, a202
v_accvgpr_read_b32 v43, a203
v_accvgpr_read_b32 v44, a204
v_accvgpr_read_b32 v45, a205
v_accvgpr_read_b32 v46, a206
v_accvgpr_read_b32 v47, a207
v_accvgpr_read_b32 v48, a208
v_accvgpr_read_b32 v49, a209
v_accvgpr_read_b32 v50, a210
v_accvgpr_read_b32 v51, a211
v_accvgpr_read_b32 v52, a212
v_accvgpr_read_b32 v53, a213
v_accvgpr_read_b32 v54, a214
v_accvgpr_read_b32 v55, a215
v_accvgpr_read_b32 v56, a216
v_accvgpr_read_b32 v57, a217
v_accvgpr_read_b32 v58, a218
v_accvgpr_read_b32 v59, a219
v_accvgpr_read_b32 v60, a220
v_accvgpr_read_b32 v61, a221
v_accvgpr_read_b32 v62, a222
v_accvgpr_read_b32 v63, a223
v_perm_b32 v24, v36, v32, s45
v_accvgpr_write_b32 a192, v24
v_perm_b32 v25, v44, v40, s45
v_accvgpr_write_b32 a193, v25
v_perm_b32 v26, v52, v48, s45
v_accvgpr_write_b32 a194, v26
v_perm_b32 v27, v60, v56, s45
v_accvgpr_write_b32 a195, v27
v_perm_b32 v28, v36, v32, s46
v_accvgpr_write_b32 a196, v28
v_perm_b32 v29, v44, v40, s46
v_accvgpr_write_b32 a197, v29
v_perm_b32 v30, v52, v48, s46
v_accvgpr_write_b32 a198, v30
v_perm_b32 v31, v60, v56, s46
v_accvgpr_write_b32 a199, v31
v_perm_b32 v24, v37, v33, s45
v_accvgpr_write_b32 a200, v24
v_perm_b32 v25, v45, v41, s45
v_accvgpr_write_b32 a201, v25
v_perm_b32 v26, v53, v49, s45
v_accvgpr_write_b32 a202, v26
v_perm_b32 v27, v61, v57, s45
v_accvgpr_write_b32 a203, v27
v_perm_b32 v28, v37, v33, s46
v_accvgpr_write_b32 a204, v28
v_perm_b32 v29, v45, v41, s46
v_accvgpr_write_b32 a205, v29
v_perm_b32 v30, v53, v49, s46
v_accvgpr_write_b32 a206, v30
v_perm_b32 v31, v61, v57, s46
v_accvgpr_write_b32 a207, v31
v_perm_b32 v24, v38, v34, s45
v_accvgpr_write_b32 a208, v24
v_perm_b32 v25, v46, v42, s45
v_accvgpr_write_b32 a209, v25
v_perm_b32 v26, v54, v50, s45
v_accvgpr_write_b32 a210, v26
v_perm_b32 v27, v62, v58, s45
v_accvgpr_write_b32 a211, v27
v_perm_b32 v28, v38, v34, s46
v_accvgpr_write_b32 a212, v28
v_perm_b32 v29, v46, v42, s46
v_accvgpr_write_b32 a213, v29
v_perm_b32 v30, v54, v50, s46
v_accvgpr_write_b32 a214, v30
v_perm_b32 v31, v62, v58, s46
v_accvgpr_write_b32 a215, v31
v_perm_b32 v24, v39, v35, s45
v_accvgpr_write_b32 a216, v24
v_perm_b32 v25, v47, v43, s45
v_accvgpr_write_b32 a217, v25
v_perm_b32 v26, v55, v51, s45
v_accvgpr_write_b32 a218, v26
v_perm_b32 v27, v63, v59, s45
v_accvgpr_write_b32 a219, v27
v_perm_b32 v28, v39, v35, s46
v_accvgpr_write_b32 a220, v28
v_perm_b32 v29, v47, v43, s46
v_accvgpr_write_b32 a221, v29
v_perm_b32 v30, v55, v51, s46
v_accvgpr_write_b32 a222, v30
v_perm_b32 v31, v63, v59, s46
v_accvgpr_write_b32 a223, v31
s_waitcnt vmcnt(44)
v_add_u32 v15, 264192, v14
s_not_b64 exec, s[58:59]
buffer_load_dwordx3 v[224:226], v15, s[4:7], 0 offen nt
s_mov_b64 exec, s[58:59]
buffer_load_dwordx3 v[224:226], v15, s[8:11], 0 offen nt
s_mov_b64 exec, -1
v_add_u32 v16, 286208, v14
s_not_b64 exec, s[58:59]
buffer_load_dwordx3 v[228:230], v16, s[4:7], 0 offen nt
s_mov_b64 exec, s[58:59]
buffer_load_dwordx3 v[228:230], v16, s[8:11], 0 offen nt
s_mov_b64 exec, -1
v_add_u32 v17, 308224, v14
s_not_b64 exec, s[58:59]
buffer_load_dwordx3 v[232:234], v17, s[4:7], 0 offen nt
s_mov_b64 exec, s[58:59]
buffer_load_dwordx3 v[232:234], v17, s[8:11], 0 offen nt
s_mov_b64 exec, -1
v_add_u32 v15, 330240, v14
s_not_b64 exec, s[58:59]
buffer_load_dwordx3 v[236:238], v15, s[4:7], 0 offen nt
s_mov_b64 exec, s[58:59]
buffer_load_dwordx3 v[236:238], v15, s[8:11], 0 offen nt
s_mov_b64 exec, -1
v_add_u32 v16, 266944, v14
s_not_b64 exec, s[58:59]
buffer_load_dwordx3 v[240:242], v16, s[4:7], 0 offen nt
s_mov_b64 exec, s[58:59]
buffer_load_dwordx3 v[240:242], v16, s[8:11], 0 offen nt
s_mov_b64 exec, -1
v_add_u32 v17, 288960, v14
s_not_b64 exec, s[58:59]
buffer_load_dwordx3 v[244:246], v17, s[4:7], 0 offen nt
s_mov_b64 exec, s[58:59]
buffer_load_dwordx3 v[244:246], v17, s[8:11], 0 offen nt
s_mov_b64 exec, -1
v_add_u32 v15, 310976, v14
s_not_b64 exec, s[58:59]
buffer_load_dwordx3 v[248:250], v15, s[4:7], 0 offen nt
s_mov_b64 exec, s[58:59]
buffer_load_dwordx3 v[248:250], v15, s[8:11], 0 offen nt
s_mov_b64 exec, -1
v_add_u32 v16, 332992, v14
s_not_b64 exec, s[58:59]
buffer_load_dwordx3 v[252:254], v16, s[4:7], 0 offen nt
s_mov_b64 exec, s[58:59]
buffer_load_dwordx3 v[252:254], v16, s[8:11], 0 offen nt
s_mov_b64 exec, -1
v_accvgpr_read_b32 v32, a224
v_accvgpr_read_b32 v33, a225
v_accvgpr_read_b32 v34, a226
v_accvgpr_read_b32 v35, a227
v_accvgpr_read_b32 v36, a228
v_accvgpr_read_b32 v37, a229
v_accvgpr_read_b32 v38, a230
v_accvgpr_read_b32 v39, a231
v_accvgpr_read_b32 v40, a232
v_accvgpr_read_b32 v41, a233
v_accvgpr_read_b32 v42, a234
v_accvgpr_read_b32 v43, a235
v_accvgpr_read_b32 v44, a236
v_accvgpr_read_b32 v45, a237
v_accvgpr_read_b32 v46, a238
v_accvgpr_read_b32 v47, a239
v_accvgpr_read_b32 v48, a240
v_accvgpr_read_b32 v49, a241
v_accvgpr_read_b32 v50, a242
v_accvgpr_read_b32 v51, a243
v_accvgpr_read_b32 v52, a244
v_accvgpr_read_b32 v53, a245
v_accvgpr_read_b32 v54, a246
v_accvgpr_read_b32 v55, a247
v_accvgpr_read_b32 v56, a248
v_accvgpr_read_b32 v57, a249
v_accvgpr_read_b32 v58, a250
v_accvgpr_read_b32 v59, a251
v_accvgpr_read_b32 v60, a252
v_accvgpr_read_b32 v61, a253
v_accvgpr_read_b32 v62, a254
v_accvgpr_read_b32 v63, a255
v_perm_b32 v24, v36, v32, s45
v_accvgpr_write_b32 a224, v24
v_perm_b32 v25, v44, v40, s45
v_accvgpr_write_b32 a225, v25
v_perm_b32 v26, v52, v48, s45
v_accvgpr_write_b32 a226, v26
v_perm_b32 v27, v60, v56, s45
v_accvgpr_write_b32 a227, v27
v_perm_b32 v28, v36, v32, s46
v_accvgpr_write_b32 a228, v28
v_perm_b32 v29, v44, v40, s46
v_accvgpr_write_b32 a229, v29
v_perm_b32 v30, v52, v48, s46
v_accvgpr_write_b32 a230, v30
v_perm_b32 v31, v60, v56, s46
v_accvgpr_write_b32 a231, v31
v_perm_b32 v24, v37, v33, s45
v_accvgpr_write_b32 a232, v24
v_perm_b32 v25, v45, v41, s45
v_accvgpr_write_b32 a233, v25
v_perm_b32 v26, v53, v49, s45
v_accvgpr_write_b32 a234, v26
v_perm_b32 v27, v61, v57, s45
v_accvgpr_write_b32 a235, v27
v_perm_b32 v28, v37, v33, s46
v_accvgpr_write_b32 a236, v28
v_perm_b32 v29, v45, v41, s46
v_accvgpr_write_b32 a237, v29
v_perm_b32 v30, v53, v49, s46
v_accvgpr_write_b32 a238, v30
v_perm_b32 v31, v61, v57, s46
v_accvgpr_write_b32 a239, v31
v_perm_b32 v24, v38, v34, s45
v_accvgpr_write_b32 a240, v24
v_perm_b32 v25, v46, v42, s45
v_accvgpr_write_b32 a241, v25
v_perm_b32 v26, v54, v50, s45
v_accvgpr_write_b32 a242, v26
v_perm_b32 v27, v62, v58, s45
v_accvgpr_write_b32 a243, v27
v_perm_b32 v28, v38, v34, s46
v_accvgpr_write_b32 a244, v28
v_perm_b32 v29, v46, v42, s46
v_accvgpr_write_b32 a245, v29
v_perm_b32 v30, v54, v50, s46
v_accvgpr_write_b32 a246, v30
v_perm_b32 v31, v62, v58, s46
v_accvgpr_write_b32 a247, v31
v_perm_b32 v24, v39, v35, s45
v_accvgpr_write_b32 a248, v24
v_perm_b32 v25, v47, v43, s45
v_accvgpr_write_b32 a249, v25
v_perm_b32 v26, v55, v51, s45
v_accvgpr_write_b32 a250, v26
v_perm_b32 v27, v63, v59, s45
v_accvgpr_write_b32 a251, v27
v_perm_b32 v28, v39, v35, s46
v_accvgpr_write_b32 a252, v28
v_perm_b32 v29, v47, v43, s46
v_accvgpr_write_b32 a253, v29
v_perm_b32 v30, v55, v51, s46
v_accvgpr_write_b32 a254, v30
v_perm_b32 v31, v63, v59, s46
v_accvgpr_write_b32 a255, v31
s_waitcnt vmcnt(0)
v_perm_b32 v32, v228, v224, s45
v_perm_b32 v33, v236, v232, s45
v_perm_b32 v34, v244, v240, s45
v_perm_b32 v35, v252, v248, s45
v_perm_b32 v36, v228, v224, s46
v_perm_b32 v37, v236, v232, s46
v_perm_b32 v38, v244, v240, s46
v_perm_b32 v39, v252, v248, s46
v_perm_b32 v40, v229, v225, s45
v_perm_b32 v41, v237, v233, s45
v_perm_b32 v42, v245, v241, s45
v_perm_b32 v43, v253, v249, s45
v_perm_b32 v44, v229, v225, s46
v_perm_b32 v45, v237, v233, s46
v_perm_b32 v46, v245, v241, s46
v_perm_b32 v47, v253, v249, s46
v_perm_b32 v48, v230, v226, s45
v_perm_b32 v49, v238, v234, s45
v_perm_b32 v50, v246, v242, s45
v_perm_b32 v51, v254, v250, s45
v_perm_b32 v52, v230, v226, s46
v_perm_b32 v53, v238, v234, s46
v_perm_b32 v54, v246, v242, s46
v_perm_b32 v55, v254, v250, s46
v_perm_b32 v56, v196, v192, s45
v_perm_b32 v57, v204, v200, s45
v_perm_b32 v58, v212, v208, s45
v_perm_b32 v59, v220, v216, s45
v_perm_b32 v60, v196, v192, s46
v_perm_b32 v61, v204, v200, s46
v_perm_b32 v62, v212, v208, s46
v_perm_b32 v63, v220, v216, s46
v_perm_b32 v64, v197, v193, s45
v_perm_b32 v65, v205, v201, s45
v_perm_b32 v66, v213, v209, s45
v_perm_b32 v67, v221, v217, s45
v_perm_b32 v68, v197, v193, s46
v_perm_b32 v69, v205, v201, s46
v_perm_b32 v70, v213, v209, s46
v_perm_b32 v71, v221, v217, s46
v_perm_b32 v72, v198, v194, s45
v_perm_b32 v73, v206, v202, s45
v_perm_b32 v74, v214, v210, s45
v_perm_b32 v75, v222, v218, s45
v_perm_b32 v76, v198, v194, s46
v_perm_b32 v77, v206, v202, s46
v_perm_b32 v78, v214, v210, s46
v_perm_b32 v79, v222, v218, s46
v_perm_b32 v208, v84, v80, s45
v_perm_b32 v209, v92, v88, s45
v_perm_b32 v210, v100, v96, s45
v_perm_b32 v211, v108, v104, s45
v_perm_b32 v212, v84, v80, s46
v_perm_b32 v213, v92, v88, s46
v_perm_b32 v214, v100, v96, s46
v_perm_b32 v215, v108, v104, s46
v_perm_b32 v216, v85, v81, s45
v_perm_b32 v217, v93, v89, s45
v_perm_b32 v218, v101, v97, s45
v_perm_b32 v219, v109, v105, s45
v_perm_b32 v220, v85, v81, s46
v_perm_b32 v221, v93, v89, s46
v_perm_b32 v222, v101, v97, s46
v_perm_b32 v223, v109, v105, s46
v_perm_b32 v224, v86, v82, s45
v_perm_b32 v225, v94, v90, s45
v_perm_b32 v226, v102, v98, s45
v_perm_b32 v227, v110, v106, s45
v_perm_b32 v228, v86, v82, s46
v_perm_b32 v229, v94, v90, s46
v_perm_b32 v230, v102, v98, s46
v_perm_b32 v231, v110, v106, s46
v_perm_b32 v232, v87, v83, s45
v_perm_b32 v233, v95, v91, s45
v_perm_b32 v234, v103, v99, s45
v_perm_b32 v235, v111, v107, s45
v_perm_b32 v236, v87, v83, s46
v_perm_b32 v237, v95, v91, s46
v_perm_b32 v238, v103, v99, s46
v_perm_b32 v239, v111, v107, s46
v_perm_b32 v240, v116, v112, s45
v_perm_b32 v241, v124, v120, s45
v_perm_b32 v242, v116, v112, s46
v_perm_b32 v243, v124, v120, s46
v_perm_b32 v244, v117, v113, s45
v_perm_b32 v245, v125, v121, s45
v_perm_b32 v246, v117, v113, s46
v_perm_b32 v247, v125, v121, s46
v_perm_b32 v248, v118, v114, s45
v_perm_b32 v249, v126, v122, s45
v_perm_b32 v250, v118, v114, s46
v_perm_b32 v251, v126, v122, s46
v_perm_b32 v252, v119, v115, s45
v_perm_b32 v253, v127, v123, s45
v_perm_b32 v254, v119, v115, s46
v_perm_b32 v255, v127, v123, s46
v_perm_b32 v80, v132, v128, s45
v_perm_b32 v81, v140, v136, s45
v_perm_b32 v82, v148, v144, s45
v_perm_b32 v83, v156, v152, s45
v_perm_b32 v84, v132, v128, s46
v_perm_b32 v85, v140, v136, s46
v_perm_b32 v86, v148, v144, s46
v_perm_b32 v87, v156, v152, s46
v_perm_b32 v88, v133, v129, s45
v_perm_b32 v89, v141, v137, s45
v_perm_b32 v90, v149, v145, s45
v_perm_b32 v91, v157, v153, s45
v_perm_b32 v92, v133, v129, s46
v_perm_b32 v93, v141, v137, s46
v_perm_b32 v94, v149, v145, s46
v_perm_b32 v95, v157, v153, s46
v_perm_b32 v96, v134, v130, s45
v_perm_b32 v97, v142, v138, s45
v_perm_b32 v98, v150, v146, s45
v_perm_b32 v99, v158, v154, s45
v_perm_b32 v100, v134, v130, s46
v_perm_b32 v101, v142, v138, s46
v_perm_b32 v102, v150, v146, s46
v_perm_b32 v103, v158, v154, s46
v_perm_b32 v136, v164, v160, s45
v_perm_b32 v137, v172, v168, s45
v_perm_b32 v138, v180, v176, s45
v_perm_b32 v139, v188, v184, s45
v_perm_b32 v140, v164, v160, s46
v_perm_b32 v141, v172, v168, s46
v_perm_b32 v142, v180, v176, s46
v_perm_b32 v143, v188, v184, s46
v_perm_b32 v144, v165, v161, s45
v_perm_b32 v145, v173, v169, s45
v_perm_b32 v146, v181, v177, s45
v_perm_b32 v147, v189, v185, s45
v_perm_b32 v148, v165, v161, s46
v_perm_b32 v149, v173, v169, s46
v_perm_b32 v150, v181, v177, s46
v_perm_b32 v151, v189, v185, s46
v_perm_b32 v152, v166, v162, s45
v_perm_b32 v153, v174, v170, s45
v_perm_b32 v154, v182, v178, s45
v_perm_b32 v155, v190, v186, s45
v_perm_b32 v156, v166, v162, s46
v_perm_b32 v157, v174, v170, s46
v_perm_b32 v158, v182, v178, s46
v_perm_b32 v159, v190, v186, s46
v_mov_b32 v112, v80
v_mov_b32 v113, v81
v_mov_b32 v114, v82
v_mov_b32 v115, v83
v_mov_b32 v116, v84
v_mov_b32 v117, v85
v_mov_b32 v118, v86
v_mov_b32 v119, v87
v_mov_b32 v120, v88
v_mov_b32 v121, v89
v_mov_b32 v122, v90
v_mov_b32 v123, v91
v_mov_b32 v124, v92
v_mov_b32 v125, v93
v_mov_b32 v126, v94
v_mov_b32 v127, v95
v_mov_b32 v128, v96
v_mov_b32 v129, v97
v_mov_b32 v130, v98
v_mov_b32 v131, v99
v_mov_b32 v132, v100
v_mov_b32 v133, v101
v_mov_b32 v134, v102
v_mov_b32 v135, v103
v_mov_b32 v160, v56
v_mov_b32 v161, v57
v_mov_b32 v162, v58
v_mov_b32 v163, v59
v_mov_b32 v164, v60
v_mov_b32 v165, v61
v_mov_b32 v166, v62
v_mov_b32 v167, v63
v_mov_b32 v168, v64
v_mov_b32 v169, v65
v_mov_b32 v170, v66
v_mov_b32 v171, v67
v_mov_b32 v172, v68
v_mov_b32 v173, v69
v_mov_b32 v174, v70
v_mov_b32 v175, v71
v_mov_b32 v176, v72
v_mov_b32 v177, v73
v_mov_b32 v178, v74
v_mov_b32 v179, v75
v_mov_b32 v180, v76
v_mov_b32 v181, v77
v_mov_b32 v182, v78
v_mov_b32 v183, v79
v_mov_b32 v184, v32
v_mov_b32 v185, v33
v_mov_b32 v186, v34
v_mov_b32 v187, v35
v_mov_b32 v188, v36
v_mov_b32 v189, v37
v_mov_b32 v190, v38
v_mov_b32 v191, v39
v_mov_b32 v192, v40
v_mov_b32 v193, v41
v_mov_b32 v194, v42
v_mov_b32 v195, v43
v_mov_b32 v196, v44
v_mov_b32 v197, v45
v_mov_b32 v198, v46
v_mov_b32 v199, v47
v_mov_b32 v200, v48
v_mov_b32 v201, v49
v_mov_b32 v202, v50
v_mov_b32 v203, v51
v_mov_b32 v204, v52
v_mov_b32 v205, v53
v_mov_b32 v206, v54
v_mov_b32 v207, v55
v_mov_b32 v25, 0xffff
v_mov_b32 v26, 0xffff0000
v_cmp_eq_u32 vcc, 0, v2
s_nop 1
v_cndmask_b32 v80, 0, v25, vcc
v_cmp_eq_u32 vcc, 1, v2
s_nop 1
v_cndmask_b32 v80, v80, v26, vcc
v_and_b32 v88, 0x3f803f80, v80
v_cmp_eq_u32 vcc, 2, v2
s_nop 1
v_cndmask_b32 v81, 0, v25, vcc
v_cmp_eq_u32 vcc, 3, v2
s_nop 1
v_cndmask_b32 v81, v81, v26, vcc
v_and_b32 v89, 0x3f803f80, v81
v_cmp_eq_u32 vcc, 4, v2
s_nop 1
v_cndmask_b32 v82, 0, v25, vcc
v_cmp_eq_u32 vcc, 5, v2
s_nop 1
v_cndmask_b32 v82, v82, v26, vcc
v_and_b32 v90, 0x3f803f80, v82
v_cmp_eq_u32 vcc, 6, v2
s_nop 1
v_cndmask_b32 v83, 0, v25, vcc
v_cmp_eq_u32 vcc, 7, v2
s_nop 1
v_cndmask_b32 v83, v83, v26, vcc
v_and_b32 v91, 0x3f803f80, v83
v_cmp_eq_u32 vcc, 8, v2
s_nop 1
v_cndmask_b32 v84, 0, v25, vcc
v_cmp_eq_u32 vcc, 9, v2
s_nop 1
v_cndmask_b32 v84, v84, v26, vcc
v_and_b32 v92, 0x3f803f80, v84
v_cmp_eq_u32 vcc, 10, v2
s_nop 1
v_cndmask_b32 v85, 0, v25, vcc
v_cmp_eq_u32 vcc, 11, v2
s_nop 1
v_cndmask_b32 v85, v85, v26, vcc
v_and_b32 v93, 0x3f803f80, v85
v_cmp_eq_u32 vcc, 12, v2
s_nop 1
v_cndmask_b32 v86, 0, v25, vcc
v_cmp_eq_u32 vcc, 13, v2
s_nop 1
v_cndmask_b32 v86, v86, v26, vcc
v_and_b32 v94, 0x3f803f80, v86
v_cmp_eq_u32 vcc, 14, v2
s_nop 1
v_cndmask_b32 v87, 0, v25, vcc
v_cmp_eq_u32 vcc, 15, v2
s_nop 1
v_cndmask_b32 v87, v87, v26, vcc
v_and_b32 v95, 0x3f803f80, v87
v_and_b32 v28, 31, v0
v_min_u32 v27, 23, v28
v_lshrrev_b32 v29, 2, v27
v_and_b32 v27, 3, v27
v_lshlrev_b32 v27, 3, v27
v_lshl_add_u32 v27, v29, 6, v27
v_and_b32 v101, 32, v0
v_lshl_add_u32 v96, v101, 4, v27
s_mul_i32 s66, s40, 320
v_mul_u32_u24 v29, 5, v101
v_lshl_add_u32 v97, v28, 2, v29
v_add_u32 v97, s66, v97
v_lshrrev_b32 v29, 3, v2
v_mul_u32_u24 v29, 160, v29
v_add_u32 v29, s66, v29
v_lshl_add_u32 v98, v1, 4, v29
v_lshl_add_u32 v99, v1, 3, v29
s_lshl_b32 s66, s40, 10
v_lshlrev_b32 v100, 9, v2
v_lshl_add_u32 v100, v1, 4, v100
v_add_u32 v100, s66, v100
v_lshlrev_b32 v101, 4, v101
v_lshlrev_b32 v102, 4, v0
v_lshlrev_b32 v103, 2, v0
v_and_b32 v29, 1, v1
v_lshlrev_b32 v29, 3, v29
v_lshl_add_u32 v29, v2, 4, v29
v_add_u32 v110, s94, v29
v_lshrrev_b32 v27, 1, v0
v_lshlrev_b32 v27, 10, v27
v_and_b32 v28, 1, v2
v_lshl_add_u32 v27, v28, 4, v27
s_lshl_b32 s66, s43, 5
v_add_u32 v104, s66, v27
s_lshr_b32 s66, s43, 3
s_lshl_b32 s68, s66, 8
s_mul_i32 s66, s66, 3
s_and_b32 s67, s40, 1
s_add_u32 s66, s66, s67
s_mul_i32 s66, s66, 320
s_and_b32 s67, s43, 7
s_lshl_b32 s69, s67, 5
s_add_u32 s66, s66, s69
v_and_b32 v29, 31, v29
v_add_u32 v105, s66, v29
s_lshr_b32 s67, s67, 1
s_lshl_b32 s67, s67, 6
s_add_u32 s68, s68, s67
s_and_b32 s67, s43, 1
s_lshl_b32 s67, s67, 3
s_add_u32 s68, s68, s67
v_lshrrev_b32 v106, 2, v29
v_add_u32 v106, s68, v106
s_mul_i32 s66, s44, 56320
s_add_u32 s66, s66, 0x100000
v_add_u32 v6, v0, v1
v_and_b32 v6, 7, v6
v_min_u32 v6, 6, v6
v_mul_u32_u24 v6, 7040, v6
v_add_u32 v6, s66, v6
v_mov_b32 v32, 0x3f803f80
v_mov_b32 v33, 0x3f803f80
v_mov_b32 v34, 0x3f803f80
v_mov_b32 v35, 0x3f803f80
v_mov_b32 v36, 0x3f803f80
v_mov_b32 v37, 0x3f803f80
v_mov_b32 v38, 0x3f803f80
v_mov_b32 v39, 0x3f803f80
v_mov_b32 v40, 0x3f803f80
v_mov_b32 v41, 0x3f803f80
v_mov_b32 v42, 0x3f803f80
v_mov_b32 v43, 0x3f803f80
v_mov_b32 v44, 0x3f803f80
v_mov_b32 v45, 0x3f803f80
v_mov_b32 v46, 0x3f803f80
v_mov_b32 v47, 0x3f803f80
s_waitcnt lgkmcnt(3)
v_mfma_f32_16x16x32_bf16 v[48:51], v[112:115], v[32:35], 0
v_mfma_f32_16x16x32_bf16 v[52:55], v[116:119], v[32:35], 0
v_mfma_f32_16x16x32_bf16 v[56:59], v[120:123], v[32:35], 0
v_mfma_f32_16x16x32_bf16 v[60:63], v[124:127], v[32:35], 0
v_mfma_f32_16x16x32_bf16 v[64:67], v[128:131], v[32:35], 0
v_mfma_f32_16x16x32_bf16 v[68:71], v[132:135], v[32:35], 0
s_waitcnt lgkmcnt(2)
v_mfma_f32_16x16x32_bf16 v[48:51], v[136:139], v[36:39], v[48:51]
v_mfma_f32_16x16x32_bf16 v[52:55], v[140:143], v[36:39], v[52:55]
v_mfma_f32_16x16x32_bf16 v[56:59], v[144:147], v[36:39], v[56:59]
v_mfma_f32_16x16x32_bf16 v[60:63], v[148:151], v[36:39], v[60:63]
v_mfma_f32_16x16x32_bf16 v[64:67], v[152:155], v[36:39], v[64:67]
v_mfma_f32_16x16x32_bf16 v[68:71], v[156:159], v[36:39], v[68:71]
s_waitcnt lgkmcnt(1)
v_mfma_f32_16x16x32_bf16 v[48:51], v[160:163], v[40:43], v[48:51]
v_mfma_f32_16x16x32_bf16 v[52:55], v[164:167], v[40:43], v[52:55]
v_mfma_f32_16x16x32_bf16 v[56:59], v[168:171], v[40:43], v[56:59]
v_mfma_f32_16x16x32_bf16 v[60:63], v[172:175], v[40:43], v[60:63]
v_mfma_f32_16x16x32_bf16 v[64:67], v[176:179], v[40:43], v[64:67]
v_mfma_f32_16x16x32_bf16 v[68:71], v[180:183], v[40:43], v[68:71]
s_waitcnt lgkmcnt(0)
v_mfma_f32_16x16x32_bf16 v[48:51], v[184:187], v[44:47], v[48:51]
v_mfma_f32_16x16x32_bf16 v[52:55], v[188:191], v[44:47], v[52:55]
v_mfma_f32_16x16x32_bf16 v[56:59], v[192:195], v[44:47], v[56:59]
v_mfma_f32_16x16x32_bf16 v[60:63], v[196:199], v[44:47], v[60:63]
v_mfma_f32_16x16x32_bf16 v[64:67], v[200:203], v[44:47], v[64:67]
v_mfma_f32_16x16x32_bf16 v[68:71], v[204:207], v[44:47], v[68:71]
s_mov_b32 exec_lo, 0x30003
s_mov_b32 exec_hi, 0x30003
s_nop 0
ds_write_b128 v100, v[48:51] offset:24576
ds_write_b128 v100, v[52:55] offset:24640
ds_write_b128 v100, v[56:59] offset:24704
ds_write_b128 v100, v[60:63] offset:24768
ds_write_b128 v100, v[64:67] offset:24832
ds_write_b128 v100, v[68:71] offset:24896
s_mov_b64 exec, -1
s_waitcnt lgkmcnt(0)
s_barrier
ds_read_b64 v[48:49], v96 offset:24576
ds_read_b64 v[50:51], v96 offset:24608
ds_read_b64 v[52:53], v96 offset:25600
ds_read_b64 v[54:55], v96 offset:25632
ds_read_b64 v[56:57], v96 offset:26624
ds_read_b64 v[58:59], v96 offset:26656
ds_read_b64 v[60:61], v96 offset:27648
ds_read_b64 v[62:63], v96 offset:27680
s_waitcnt lgkmcnt(0)
v_pk_add_f32 v[48:49], v[48:49], v[52:53]
v_pk_add_f32 v[50:51], v[50:51], v[54:55]
v_pk_add_f32 v[56:57], v[56:57], v[60:61]
v_pk_add_f32 v[58:59], v[58:59], v[62:63]
v_pk_add_f32 v[14:15], v[48:49], v[56:57]
v_pk_add_f32 v[16:17], v[50:51], v[58:59]
s_mov_b32 s8, s34
s_and_b32 s9, s35, 0xffff
s_mov_b32 s10, 0x2000
s_mov_b32 s11, 0x20000
s_mov_b32 s4, 0x10001
s_mov_b32 s5, 0x10001
s_mov_b32 s6, 0x30003
s_mov_b32 s7, 0x30003
v_and_b32 v24, 28, v103
s_nop 1
Lc50:
global_load_dword v25, v24, s[36:37] sc1
s_waitcnt vmcnt(0)
v_and_b32 v25, 0x80808080, v25
v_cmp_ne_u32 vcc, 0x80808080, v25
s_nop 0
s_cbranch_vccz Lc51
s_sleep 2
s_sub_u32 s64, s64, 1
s_cmp_gt_i32 s64, 0
s_cbranch_scc1 Lc50
Lc51:
s_mov_b32 s47, 0
s_mov_b64 s[62:63], -1
L_job:
s_min_u32 s50, s47, 7
s_sub_u32 s51, s47, 2
s_cmp_lt_u32 s47, 2
s_cselect_b32 s49, 0, 1
s_cselect_b32 s51, s50, s51
s_and_b32 s48, s47, 1
s_bfe_u32 s96, s47, 0x10001
s_lshr_b32 s66, s47, 1
s_cmp_lg_u32 s66, 1
s_cbranch_scc1 Lj52
v_mov_b32 v32, -1
v_mov_b32 v33, -1
v_mov_b32 v34, -1
v_mov_b32 v35, -1
s_lshl_b32 s68, s47, 16
buffer_store_dwordx4 v[32:35], v5, s[12:15], s68 offen sc1
s_nop 1
Lj52:
s_mul_i32 s60, s48, 640
s_mul_i32 s61, s49, 320
s_add_u32 s61, s61, s60
v_mov_b32 v24, s60
v_mov_b32 v25, s61
v_cndmask_b32 v24, v24, v25, s[58:59]
v_add_u32 v107, v24, v6
s_sub_u32 s66, s47, 5
s_cmp_gt_u32 s47, 6
s_cselect_b32 s48, s66, s48
s_lshl_b32 s90, s48, 16
s_add_u32 s86, s90, 0x340000
s_add_u32 s87, s86, 4096
s_add_u32 s88, s86, 8192
s_add_u32 s89, s86, 12288
v_mov_b32 v24, s86
v_mov_b32 v25, s88
v_cndmask_b32 v24, v24, v25, s[52:53]
v_add_u32 v108, v24, v9
s_add_u32 s90, s90, 0x400000
s_add_u32 s92, s90, 32768
v_mov_b32 v24, s90
v_mov_b32 v25, s92
v_cndmask_b32 v24, v24, v25, s[58:59]
v_add_u32 v109, v24, v8
s_mul_i32 s66, s50, 320
s_mul_i32 s67, s51, 320
v_mov_b32 v24, s66
v_mov_b32 v25, s67
v_cndmask_b32 v24, v24, v25, s[52:53]
v_add_u32 v23, v24, v110
s_mov_b32 s67, 2560
v_lshl_add_u32 v111, v1, 4, s94
v_mov_b32 v24, s66
v_mov_b32 v25, s67
v_cndmask_b32 v24, v24, v25, s[54:55]
v_add_u32 v111, v24, v111
s_lshl_b32 s91, s95, 12
s_lshl_b32 s66, s47, 8
s_add_u32 s91, s91, s66
La53:
buffer_load_dwordx2 v[24:25], v107, s[12:15], 0 offen offset:256 sc1
buffer_load_dwordx4 v[48:51], v3, s[12:15], s60 offen sc1
buffer_load_dwordx4 v[52:55], v4, s[12:15], s60 offen sc1
buffer_load_dwordx4 v[56:59], v3, s[12:15], s61 offen sc1
buffer_load_dwordx4 v[60:63], v4, s[12:15], s61 offen sc1
v_mov_b32 v27, 0xff800000
s_waitcnt vmcnt(4)
v_bitop3_b32 v26, v24, v25, s96 bitop3:0x7e
v_and_b32 v26, 1, v26
v_cmp_ne_u32 vcc, 0, v26
v_cndmask_b32 v24, v24, v27, s[56:57]
v_cndmask_b32 v25, v25, 0, s[56:57]
s_nop 0
s_cbranch_vccz La55
s_waitcnt vmcnt(0)
s_sleep 1
s_sub_u32 s64, s64, 1
s_cmp_gt_i32 s64, 0
s_cbranch_scc1 La53
La55:
v_max_f32_dpp v27, v24, v24 quad_perm:[1,0,3,2] row_mask:0xf bank_mask:0xf
s_nop 1
v_max_f32_dpp v27, v27, v27 quad_perm:[2,3,0,1] row_mask:0xf bank_mask:0xf
s_nop 1
v_max_f32_dpp v27, v27, v27 row_half_mirror row_mask:0xf bank_mask:0xf
v_sub_f32 v26, v24, v27
v_exp_f32 v26, v26
s_nop 0
v_cvt_pk_bf16_f32 v26, v26, v26
v_and_b32 v27, 0xffff0000, v26
v_cmp_gt_i32 s[62:63], 0, v25
v_mul_f32_e64 v27, v27, |v25|
v_and_b32_dpp v64, v26, v80 row_newbcast:0 row_mask:0xf bank_mask:0xf
v_and_b32_dpp v65, v26, v81 row_newbcast:0 row_mask:0xf bank_mask:0xf
v_and_b32_dpp v66, v26, v82 row_newbcast:0 row_mask:0xf bank_mask:0xf
v_and_b32_dpp v67, v26, v83 row_newbcast:0 row_mask:0xf bank_mask:0xf
v_add_f32_dpp v27, v27, v27 quad_perm:[1,0,3,2] row_mask:0xf bank_mask:0xf
v_and_b32_dpp v68, v26, v80 row_newbcast:4 row_mask:0xf bank_mask:0xf
v_and_b32_dpp v69, v26, v81 row_newbcast:4 row_mask:0xf bank_mask:0xf
v_and_b32_dpp v70, v26, v82 row_newbcast:4 row_mask:0xf bank_mask:0xf
v_and_b32_dpp v71, v26, v83 row_newbcast:4 row_mask:0xf bank_mask:0xf
v_add_f32_dpp v27, v27, v27 quad_perm:[2,3,0,1] row_mask:0xf bank_mask:0xf
v_and_b32_dpp v72, v26, v84 row_newbcast:8 row_mask:0xf bank_mask:0xf
v_and_b32_dpp v73, v26, v85 row_newbcast:8 row_mask:0xf bank_mask:0xf
v_and_b32_dpp v74, v26, v86 row_newbcast:8 row_mask:0xf bank_mask:0xf
v_and_b32_dpp v75, v26, v87 row_newbcast:8 row_mask:0xf bank_mask:0xf
v_add_f32_dpp v27, v27, v27 row_half_mirror row_mask:0xf bank_mask:0xf
v_and_b32_dpp v76, v26, v84 row_newbcast:12 row_mask:0xf bank_mask:0xf
v_and_b32_dpp v77, v26, v85 row_newbcast:12 row_mask:0xf bank_mask:0xf
v_and_b32_dpp v78, v26, v86 row_newbcast:12 row_mask:0xf bank_mask:0xf
v_and_b32_dpp v79, v26, v87 row_newbcast:12 row_mask:0xf bank_mask:0xf
v_rcp_f32 v27, v27
s_waitcnt vmcnt(3)
v_mfma_f32_16x16x32_bf16 v[28:31], v[64:67], v[48:51], 0
v_bitop3_b32 v34, v48, v49, s96 bitop3:0x7e
v_bitop3_b32 v35, v50, v51, s96 bitop3:0x7e
v_or_b32 v26, v34, v35
s_waitcnt vmcnt(2)
v_mfma_f32_16x16x32_bf16 v[28:31], v[68:71], v[52:55], v[28:31]
v_bitop3_b32 v34, v52, v53, s96 bitop3:0x7e
v_bitop3_b32 v35, v54, v55, s96 bitop3:0x7e
v_or3_b32 v26, v26, v34, v35
s_waitcnt vmcnt(1)
v_mfma_f32_16x16x32_bf16 v[28:31], v[72:75], v[56:59], v[28:31]
v_bitop3_b32 v34, v56, v57, s96 bitop3:0x7e
v_bitop3_b32 v35, v58, v59, s96 bitop3:0x7e
v_or3_b32 v26, v26, v34, v35
s_waitcnt vmcnt(0)
v_mfma_f32_16x16x32_bf16 v[28:31], v[76:79], v[60:63], v[28:31]
v_bitop3_b32 v34, v60, v61, s96 bitop3:0x7e
v_bitop3_b32 v35, v62, v63, s96 bitop3:0x7e
v_or3_b32 v26, v26, v34, v35
v_mov_b32_dpp v32, v27 row_newbcast:0 row_mask:0x3 bank_mask:0xf
v_mov_b32_dpp v32, v27 row_newbcast:8 row_mask:0xc bank_mask:0xf
v_and_b32 v26, 1, v26
v_cmp_ne_u32 vcc, 0, v26
s_nop 0
s_cbranch_vccz La54
s_sub_u32 s64, s64, 1
s_cmp_gt_i32 s64, 0
s_cbranch_scc1 La53
La54:
s_cmp_gt_u32 s47, 6
s_cselect_b32 s96, 0, s96
v_mul_f32 v28, v28, v32
v_mul_f32 v29, v29, v32
v_mul_f32 v30, v30, v32
v_mul_f32 v31, v31, v32
v_cvt_pk_bf16_f32 v28, v28, v29
v_cvt_pk_bf16_f32 v29, v30, v31
ds_write_b64 v11, v[28:29] offset:11520
ds_read_b128 v[32:35], v10 offset:11520
ds_read_b128 v[36:39], v10 offset:11584
ds_read_b128 v[40:43], v10 offset:11648
ds_read_b128 v[44:47], v10 offset:11712
s_waitcnt lgkmcnt(3)
v_mfma_f32_16x16x32_bf16 v[48:51], a[128:131], v[32:35], 0
v_mfma_f32_16x16x32_bf16 v[52:55], a[132:135], v[32:35], 0
v_mfma_f32_16x16x32_bf16 v[56:59], a[136:139], v[32:35], 0
v_mfma_f32_16x16x32_bf16 v[60:63], a[140:143], v[32:35], 0
v_mfma_f32_16x16x32_bf16 v[64:67], a[144:147], v[32:35], 0
v_mfma_f32_16x16x32_bf16 v[68:71], a[148:151], v[32:35], 0
v_mfma_f32_16x16x32_bf16 v[72:75], a[152:155], v[32:35], 0
v_mfma_f32_16x16x32_bf16 v[76:79], a[156:159], v[32:35], 0
s_waitcnt lgkmcnt(2)
v_mfma_f32_16x16x32_bf16 v[48:51], a[160:163], v[36:39], v[48:51]
v_mfma_f32_16x16x32_bf16 v[52:55], a[164:167], v[36:39], v[52:55]
v_mfma_f32_16x16x32_bf16 v[56:59], a[168:171], v[36:39], v[56:59]
v_mfma_f32_16x16x32_bf16 v[60:63], a[172:175], v[36:39], v[60:63]
v_mfma_f32_16x16x32_bf16 v[64:67], a[176:179], v[36:39], v[64:67]
v_mfma_f32_16x16x32_bf16 v[68:71], a[180:183], v[36:39], v[68:71]
v_mfma_f32_16x16x32_bf16 v[72:75], a[184:187], v[36:39], v[72:75]
v_mfma_f32_16x16x32_bf16 v[76:79], a[188:191], v[36:39], v[76:79]
s_waitcnt lgkmcnt(1)
v_mfma_f32_16x16x32_bf16 v[48:51], a[192:195], v[40:43], v[48:51]
v_mfma_f32_16x16x32_bf16 v[52:55], a[196:199], v[40:43], v[52:55]
v_mfma_f32_16x16x32_bf16 v[56:59], a[200:203], v[40:43], v[56:59]
v_mfma_f32_16x16x32_bf16 v[60:63], a[204:207], v[40:43], v[60:63]
v_mfma_f32_16x16x32_bf16 v[64:67], a[208:211], v[40:43], v[64:67]
v_mfma_f32_16x16x32_bf16 v[68:71], a[212:215], v[40:43], v[68:71]
v_mfma_f32_16x16x32_bf16 v[72:75], a[216:219], v[40:43], v[72:75]
v_mfma_f32_16x16x32_bf16 v[76:79], a[220:223], v[40:43], v[76:79]
s_waitcnt lgkmcnt(0)
v_mfma_f32_16x16x32_bf16 v[48:51], a[224:227], v[44:47], v[48:51]
v_mfma_f32_16x16x32_bf16 v[52:55], a[228:231], v[44:47], v[52:55]
v_mfma_f32_16x16x32_bf16 v[56:59], a[232:235], v[44:47], v[56:59]
v_mfma_f32_16x16x32_bf16 v[60:63], a[236:239], v[44:47], v[60:63]
s_mov_b64 exec, s[6:7]
s_nop 3
ds_write_b128 v12, v[48:51] offset:20480
s_mov_b64 exec, -1
v_mfma_f32_16x16x32_bf16 v[64:67], a[240:243], v[44:47], v[64:67]
s_mov_b64 exec, s[6:7]
ds_write_b128 v12, v[52:55] offset:20496
s_mov_b64 exec, -1
v_mfma_f32_16x16x32_bf16 v[68:71], a[244:247], v[44:47], v[68:71]
s_mov_b64 exec, s[6:7]
ds_write_b128 v12, v[56:59] offset:20512
s_mov_b64 exec, -1
v_mfma_f32_16x16x32_bf16 v[72:75], a[248:251], v[44:47], v[72:75]
s_mov_b64 exec, s[6:7]
ds_write_b128 v12, v[60:63] offset:20528
s_mov_b64 exec, -1
v_mfma_f32_16x16x32_bf16 v[76:79], a[252:255], v[44:47], v[76:79]
s_mov_b64 exec, s[6:7]
ds_write_b128 v12, v[64:67] offset:20544
s_mov_b64 exec, -1
s_mov_b64 exec, s[6:7]
ds_write_b128 v12, v[68:71] offset:20560
ds_write_b128 v12, v[72:75] offset:20576
s_nop 1
ds_write_b128 v12, v[76:79] offset:20592
s_mov_b64 exec, -1
s_waitcnt lgkmcnt(0)
s_barrier
s_cmp_lg_u32 s40, 3
s_cbranch_scc1 La56
ds_read_b128 v[48:51], v102 offset:20480
ds_read_b128 v[52:55], v102 offset:21504
ds_read_b128 v[56:59], v102 offset:22528
ds_read_b128 v[60:63], v102 offset:23552
s_waitcnt lgkmcnt(0)
v_pk_add_f32 v[48:49], v[48:49], v[52:53]
v_pk_add_f32 v[50:51], v[50:51], v[54:55]
v_pk_add_f32 v[56:57], v[56:57], v[60:61]
v_pk_add_f32 v[58:59], v[58:59], v[62:63]
v_pk_add_f32 v[28:29], v[48:49], v[56:57]
v_pk_add_f32 v[30:31], v[50:51], v[58:59]
v_cvt_pk_bf16_f32 v26, v28, v29
v_cvt_pk_bf16_f32 v27, v30, v31
v_and_or_b32 v26, v26, -2, s96
v_and_or_b32 v27, v27, -2, s96
buffer_store_dwordx2 v[26:27], v108, s[12:15], 0 offen sc1
s_nop 0
La56:
ds_read_b64 v[24:25], v23 offset:0
s_waitcnt lgkmcnt(0)
v_lshlrev_b32 v32, 16, v24
v_and_b32 v33, 0xffff0000, v24
v_lshlrev_b32 v34, 16, v25
v_and_b32 v35, 0xffff0000, v25
s_waitcnt vmcnt(0)
s_barrier
Lb57:
buffer_load_dwordx4 v[48:51], v7, s[12:15], s86 offen sc1
buffer_load_dwordx4 v[52:55], v7, s[12:15], s87 offen sc1
buffer_load_dwordx4 v[56:59], v7, s[12:15], s88 offen sc1
buffer_load_dwordx4 v[60:63], v7, s[12:15], s89 offen sc1
s_waitcnt vmcnt(3)
v_mfma_f32_16x16x32_bf16 v[28:31], v[88:91], v[48:51], v[32:35]
v_bitop3_b32 v26, v48, v49, s96 bitop3:0x7e
v_bitop3_b32 v27, v50, v51, s96 bitop3:0x7e
v_or_b32 v24, v26, v27
s_waitcnt vmcnt(2)
v_mfma_f32_16x16x32_bf16 v[28:31], v[88:91], v[52:55], v[28:31]
v_bitop3_b32 v26, v52, v53, s96 bitop3:0x7e
v_bitop3_b32 v27, v54, v55, s96 bitop3:0x7e
v_or3_b32 v24, v24, v26, v27
s_waitcnt vmcnt(1)
v_mfma_f32_16x16x32_bf16 v[28:31], v[92:95], v[56:59], v[28:31]
v_bitop3_b32 v26, v56, v57, s96 bitop3:0x7e
v_bitop3_b32 v27, v58, v59, s96 bitop3:0x7e
v_or3_b32 v24, v24, v26, v27
s_waitcnt vmcnt(0)
v_mfma_f32_16x16x32_bf16 v[28:31], v[92:95], v[60:63], v[28:31]
v_bitop3_b32 v26, v60, v61, s96 bitop3:0x7e
v_bitop3_b32 v27, v62, v63, s96 bitop3:0x7e
v_or3_b32 v24, v24, v26, v27
v_and_b32 v24, 1, v24
v_cmp_ne_u32 vcc, 0, v24
s_nop 1
s_cbranch_vccz Lb58
s_sub_u32 s64, s64, 1
s_cmp_gt_i32 s64, 0
s_cbranch_scc1 Lb57
Lb58:
v_cvt_pk_bf16_f32 v20, v28, v29
v_cvt_pk_bf16_f32 v21, v30, v31
ds_write_b64 v11, v[20:21] offset:15360
ds_read_b128 v[32:35], v10 offset:15360
ds_read_b128 v[36:39], v10 offset:15424
ds_read_b128 v[40:43], v10 offset:15488
ds_read_b128 v[44:47], v10 offset:15552
s_waitcnt lgkmcnt(3)
v_mfma_f32_16x16x32_bf16 v[24:27], v[32:35], v[32:35], 0
v_mfma_f32_16x16x32_bf16 v[48:51], v[112:115], v[32:35], 0
v_mfma_f32_16x16x32_bf16 v[52:55], v[116:119], v[32:35], 0
v_mfma_f32_16x16x32_bf16 v[56:59], v[120:123], v[32:35], 0
v_mfma_f32_16x16x32_bf16 v[60:63], v[124:127], v[32:35], 0
v_mfma_f32_16x16x32_bf16 v[64:67], v[128:131], v[32:35], 0
v_mfma_f32_16x16x32_bf16 v[68:71], v[132:135], v[32:35], 0
s_waitcnt lgkmcnt(2)
v_mfma_f32_16x16x32_bf16 v[24:27], v[36:39], v[36:39], v[24:27]
v_mfma_f32_16x16x32_bf16 v[48:51], v[136:139], v[36:39], v[48:51]
v_mfma_f32_16x16x32_bf16 v[52:55], v[140:143], v[36:39], v[52:55]
v_mfma_f32_16x16x32_bf16 v[56:59], v[144:147], v[36:39], v[56:59]
v_mfma_f32_16x16x32_bf16 v[60:63], v[148:151], v[36:39], v[60:63]
v_mfma_f32_16x16x32_bf16 v[64:67], v[152:155], v[36:39], v[64:67]
v_mfma_f32_16x16x32_bf16 v[68:71], v[156:159], v[36:39], v[68:71]
s_waitcnt lgkmcnt(1)
v_mfma_f32_16x16x32_bf16 v[24:27], v[40:43], v[40:43], v[24:27]
v_mfma_f32_16x16x32_bf16 v[48:51], v[160:163], v[40:43], v[48:51]
v_mfma_f32_16x16x32_bf16 v[52:55], v[164:167], v[40:43], v[52:55]
v_mfma_f32_16x16x32_bf16 v[56:59], v[168:171], v[40:43], v[56:59]
v_mfma_f32_16x16x32_bf16 v[60:63], v[172:175], v[40:43], v[60:63]
v_mfma_f32_16x16x32_bf16 v[64:67], v[176:179], v[40:43], v[64:67]
v_mfma_f32_16x16x32_bf16 v[68:71], v[180:183], v[40:43], v[68:71]
s_waitcnt lgkmcnt(0)
v_mfma_f32_16x16x32_bf16 v[24:27], v[44:47], v[44:47], v[24:27]
v_mfma_f32_16x16x32_bf16 v[48:51], v[184:187], v[44:47], v[48:51]
v_mfma_f32_16x16x32_bf16 v[52:55], v[188:191], v[44:47], v[52:55]
v_mfma_f32_16x16x32_bf16 v[56:59], v[192:195], v[44:47], v[56:59]
s_mov_b64 exec, s[6:7]
s_nop 3
ds_write_b128 v100, v[24:27] offset:24960
s_mov_b64 exec, -1
v_mfma_f32_16x16x32_bf16 v[60:63], v[196:199], v[44:47], v[60:63]
s_mov_b64 exec, s[6:7]
ds_write_b128 v100, v[48:51] offset:24576
s_mov_b64 exec, -1
v_mfma_f32_16x16x32_bf16 v[64:67], v[200:203], v[44:47], v[64:67]
s_mov_b64 exec, s[6:7]
ds_write_b128 v100, v[52:55] offset:24640
s_mov_b64 exec, -1
v_mfma_f32_16x16x32_bf16 v[68:71], v[204:207], v[44:47], v[68:71]
s_mov_b64 exec, s[6:7]
ds_write_b128 v100, v[56:59] offset:24704
s_mov_b64 exec, -1
s_mov_b64 exec, s[6:7]
ds_write_b128 v100, v[60:63] offset:24768
ds_write_b128 v100, v[64:67] offset:24832
s_nop 1
ds_write_b128 v100, v[68:71] offset:24896
s_mov_b64 exec, -1
s_waitcnt lgkmcnt(0)
s_barrier
ds_read_b128 v[64:67], v101 offset:24960
ds_read_b128 v[68:71], v101 offset:25984
ds_read_b128 v[72:75], v101 offset:27008
ds_read_b128 v[76:79], v101 offset:28032
ds_read_b64 v[48:49], v96 offset:24576
ds_read_b64 v[50:51], v96 offset:24608
ds_read_b64 v[52:53], v96 offset:25600
ds_read_b64 v[54:55], v96 offset:25632
ds_read_b64 v[56:57], v96 offset:26624
ds_read_b64 v[58:59], v96 offset:26656
ds_read_b64 v[60:61], v96 offset:27648
ds_read_b64 v[62:63], v96 offset:27680
s_waitcnt lgkmcnt(8)
v_pk_add_f32 v[64:65], v[64:65], v[68:69]
v_pk_add_f32 v[66:67], v[66:67], v[70:71]
v_pk_add_f32 v[72:73], v[72:73], v[76:77]
v_pk_add_f32 v[74:75], v[74:75], v[78:79]
v_pk_add_f32 v[64:65], v[64:65], v[72:73]
v_pk_add_f32 v[66:67], v[66:67], v[74:75]
v_cndmask_b32 v64, v64, v65, s[52:53]
v_mul_f32 v24, 0x3b000000, v66
v_mul_f32 v64, 0x3b000000, v64
v_fma_f32 v64, -v24, v24, v64
v_max_f32 v64, 0, v64
v_add_f32 v64, 0x3727c5ac, v64
v_rsq_f32 v25, v64
s_nop 0
v_mul_f32 v26, 0xbfb8aa3b, v25
s_waitcnt lgkmcnt(0)
v_pk_add_f32 v[48:49], v[48:49], v[52:53]
v_pk_add_f32 v[50:51], v[50:51], v[54:55]
v_pk_add_f32 v[56:57], v[56:57], v[60:61]
v_pk_add_f32 v[58:59], v[58:59], v[62:63]
v_pk_add_f32 v[48:49], v[48:49], v[56:57]
v_pk_add_f32 v[50:51], v[50:51], v[58:59]
v_fma_f32 v48, -v24, v14, v48
v_fma_f32 v49, -v24, v15, v49
v_fma_f32 v50, -v24, v16, v50
v_fma_f32 v51, -v24, v17, v51
v_mul_f32 v48, v48, v26
v_mul_f32 v49, v49, v26
v_exp_f32 v48, v48
v_exp_f32 v49, v49
v_mul_f32 v50, v50, v25
v_mul_f32 v51, v51, v25
v_add_f32 v48, 1.0, v48
v_add_f32 v49, 1.0, v49
v_rcp_f32 v48, v48
v_rcp_f32 v49, v49
v_mul_f32 v48, v48, v50
v_mul_f32 v49, v49, v51
v_cvt_pk_bf16_f32 v48, v48, v49
ds_write_b32 v97, v48 offset:19200
ds_read_b128 v[32:35], v98 offset:19200
ds_read_b64 v[36:37], v99 offset:19264
s_waitcnt lgkmcnt(0)
v_cndmask_b32 v48, 0, v32, s[70:71]
v_cndmask_b32 v49, 0, v33, s[70:71]
v_cndmask_b32 v50, 0, v34, s[70:71]
v_cndmask_b32 v51, 0, v35, s[70:71]
v_cndmask_b32 v52, 0, v32, s[72:73]
v_cndmask_b32 v53, 0, v33, s[72:73]
v_cndmask_b32 v54, 0, v34, s[72:73]
v_cndmask_b32 v55, 0, v35, s[72:73]
v_mfma_f32_16x16x32_bf16 v[28:31], v[208:211], v[48:51], 0
v_cndmask_b32 v56, 0, v32, s[74:75]
v_cndmask_b32 v57, 0, v33, s[74:75]
v_cndmask_b32 v58, 0, v34, s[74:75]
v_cndmask_b32 v59, 0, v35, s[74:75]
v_mfma_f32_16x16x32_bf16 v[28:31], v[212:215], v[52:55], v[28:31]
v_cndmask_b32 v60, 0, v32, s[76:77]
v_cndmask_b32 v61, 0, v33, s[76:77]
v_cndmask_b32 v62, 0, v34, s[76:77]
v_cndmask_b32 v63, 0, v35, s[76:77]
v_mfma_f32_16x16x32_bf16 v[28:31], v[216:219], v[56:59], v[28:31]
v_cndmask_b32 v48, 0, v32, s[78:79]
v_cndmask_b32 v49, 0, v33, s[78:79]
v_cndmask_b32 v50, 0, v34, s[78:79]
v_cndmask_b32 v51, 0, v35, s[78:79]
v_mfma_f32_16x16x32_bf16 v[28:31], v[220:223], v[60:63], v[28:31]
v_cndmask_b32 v52, 0, v32, s[80:81]
v_cndmask_b32 v53, 0, v33, s[80:81]
v_cndmask_b32 v54, 0, v34, s[80:81]
v_cndmask_b32 v55, 0, v35, s[80:81]
v_mfma_f32_16x16x32_bf16 v[28:31], v[224:227], v[48:51], v[28:31]
v_cndmask_b32 v56, 0, v32, s[82:83]
v_cndmask_b32 v57, 0, v33, s[82:83]
v_cndmask_b32 v58, 0, v34, s[82:83]
v_cndmask_b32 v59, 0, v35, s[82:83]
v_mfma_f32_16x16x32_bf16 v[28:31], v[228:231], v[52:55], v[28:31]
v_cndmask_b32 v60, 0, v32, s[84:85]
v_cndmask_b32 v61, 0, v33, s[84:85]
v_cndmask_b32 v62, 0, v34, s[84:85]
v_cndmask_b32 v63, 0, v35, s[84:85]
v_mfma_f32_16x16x32_bf16 v[28:31], v[232:235], v[56:59], v[28:31]
v_cndmask_b32 v64, 0, v36, s[70:71]
v_cndmask_b32 v65, 0, v37, s[70:71]
v_cndmask_b32 v66, 0, v36, s[72:73]
v_cndmask_b32 v67, 0, v37, s[72:73]
v_mfma_f32_16x16x32_bf16 v[28:31], v[236:239], v[60:63], v[28:31]
v_cndmask_b32 v68, 0, v36, s[74:75]
v_cndmask_b32 v69, 0, v37, s[74:75]
v_cndmask_b32 v70, 0, v36, s[76:77]
v_cndmask_b32 v71, 0, v37, s[76:77]
v_cndmask_b32 v72, 0, v36, s[78:79]
v_cndmask_b32 v73, 0, v37, s[78:79]
v_mfma_f32_16x16x16_bf16 v[28:31], v[240:241], v[64:65], v[28:31]
v_cndmask_b32 v74, 0, v36, s[80:81]
v_cndmask_b32 v75, 0, v37, s[80:81]
v_mfma_f32_16x16x16_bf16 v[28:31], v[242:243], v[66:67], v[28:31]
v_cndmask_b32 v76, 0, v36, s[82:83]
v_cndmask_b32 v77, 0, v37, s[82:83]
v_mfma_f32_16x16x16_bf16 v[28:31], v[244:245], v[68:69], v[28:31]
v_cndmask_b32 v78, 0, v36, s[84:85]
v_cndmask_b32 v79, 0, v37, s[84:85]
v_mfma_f32_16x16x16_bf16 v[28:31], v[246:247], v[70:71], v[28:31]
v_mfma_f32_16x16x16_bf16 v[28:31], v[248:249], v[72:73], v[28:31]
v_mfma_f32_16x16x16_bf16 v[28:31], v[250:251], v[74:75], v[28:31]
v_mfma_f32_16x16x16_bf16 v[28:31], v[252:253], v[76:77], v[28:31]
v_mfma_f32_16x16x16_bf16 v[28:31], v[254:255], v[78:79], v[28:31]
v_lshlrev_b32 v32, 16, v20
v_and_b32 v33, 0xffff0000, v20
v_lshlrev_b32 v34, 16, v21
v_and_b32 v35, 0xffff0000, v21
s_nop 3
v_cvt_pk_bf16_f32 v26, v28, v29
v_cvt_pk_bf16_f32 v27, v30, v31
v_and_or_b32 v26, v26, -2, s96
v_and_or_b32 v27, v27, -2, s96
buffer_store_dwordx2 v[26:27], v109, s[12:15], 0 offen sc1
s_cmp_eq_u32 s47, 8
s_cbranch_scc1 L_last
s_waitcnt vmcnt(0)
Ld59:
s_mov_b32 s66, s90
buffer_load_dwordx4 v[48:51], v7, s[12:15], s66 offen sc1
s_add_u32 s66, s66, 4096
buffer_load_dwordx4 v[52:55], v7, s[12:15], s66 offen sc1
s_add_u32 s66, s66, 4096
buffer_load_dwordx4 v[56:59], v7, s[12:15], s66 offen sc1
s_add_u32 s66, s66, 4096
buffer_load_dwordx4 v[60:63], v7, s[12:15], s66 offen sc1
s_add_u32 s66, s66, 4096
buffer_load_dwordx4 v[64:67], v7, s[12:15], s66 offen sc1
s_add_u32 s66, s66, 4096
buffer_load_dwordx4 v[68:71], v7, s[12:15], s66 offen sc1
s_add_u32 s66, s66, 4096
buffer_load_dwordx4 v[72:75], v7, s[12:15], s66 offen sc1
s_add_u32 s66, s66, 4096
buffer_load_dwordx4 v[76:79], v7, s[12:15], s66 offen sc1
s_waitcnt vmcnt(7)
v_mfma_f32_16x16x32_bf16 v[28:31], v[88:91], v[48:51], v[32:35]
v_bitop3_b32 v26, v48, v49, s96 bitop3:0x7e
v_bitop3_b32 v27, v50, v51, s96 bitop3:0x7e
v_or_b32 v24, v26, v27
s_waitcnt vmcnt(6)
v_mfma_f32_16x16x32_bf16 v[28:31], v[88:91], v[52:55], v[28:31]
v_bitop3_b32 v26, v52, v53, s96 bitop3:0x7e
v_bitop3_b32 v27, v54, v55, s96 bitop3:0x7e
v_or3_b32 v24, v24, v26, v27
s_waitcnt vmcnt(5)
v_mfma_f32_16x16x32_bf16 v[28:31], v[88:91], v[56:59], v[28:31]
v_bitop3_b32 v26, v56, v57, s96 bitop3:0x7e
v_bitop3_b32 v27, v58, v59, s96 bitop3:0x7e
v_or3_b32 v24, v24, v26, v27
s_waitcnt vmcnt(4)
v_mfma_f32_16x16x32_bf16 v[28:31], v[88:91], v[60:63], v[28:31]
v_bitop3_b32 v26, v60, v61, s96 bitop3:0x7e
v_bitop3_b32 v27, v62, v63, s96 bitop3:0x7e
v_or3_b32 v24, v24, v26, v27
s_waitcnt vmcnt(3)
v_mfma_f32_16x16x32_bf16 v[28:31], v[88:91], v[64:67], v[28:31]
v_bitop3_b32 v26, v64, v65, s96 bitop3:0x7e
v_bitop3_b32 v27, v66, v67, s96 bitop3:0x7e
v_or3_b32 v24, v24, v26, v27
s_waitcnt vmcnt(2)
v_mfma_f32_16x16x32_bf16 v[28:31], v[88:91], v[68:71], v[28:31]
v_bitop3_b32 v26, v68, v69, s96 bitop3:0x7e
v_bitop3_b32 v27, v70, v71, s96 bitop3:0x7e
v_or3_b32 v24, v24, v26, v27
s_waitcnt vmcnt(1)
v_mfma_f32_16x16x32_bf16 v[28:31], v[88:91], v[72:75], v[28:31]
v_bitop3_b32 v26, v72, v73, s96 bitop3:0x7e
v_bitop3_b32 v27, v74, v75, s96 bitop3:0x7e
v_or3_b32 v24, v24, v26, v27
s_waitcnt vmcnt(0)
v_mfma_f32_16x16x32_bf16 v[28:31], v[88:91], v[76:79], v[28:31]
v_bitop3_b32 v26, v76, v77, s96 bitop3:0x7e
v_bitop3_b32 v27, v78, v79, s96 bitop3:0x7e
v_or3_b32 v24, v24, v26, v27
v_and_b32 v24, 1, v24
v_cmp_ne_u32 vcc, 0, v24
s_nop 1
s_cbranch_vccz Ld60
s_sub_u32 s64, s64, 1
s_cmp_gt_i32 s64, 0
s_cbranch_scc1 Ld59
Ld60:
v_cvt_pk_bf16_f32 v26, v28, v29
v_cvt_pk_bf16_f32 v27, v30, v31
s_mov_b32 exec_lo, 0xffffffff
s_mov_b32 exec_hi, 0x0
ds_write_b64 v23, v[26:27] offset:0
s_mov_b64 exec, -1
ds_read_b128 v[32:35], v111 offset:0
ds_read_b128 v[36:39], v111 offset:64
ds_read_b128 v[40:43], v111 offset:128
ds_read_b128 v[44:47], v111 offset:192
v_mov_b32 v30, 0
s_waitcnt lgkmcnt(3)
v_mfma_f32_16x16x32_bf16 v[24:27], v[32:35], v[32:35], 0
v_mfma_f32_16x16x32_bf16 v[48:51], a[0:3], v[32:35], 0
v_mfma_f32_16x16x32_bf16 v[52:55], a[4:7], v[32:35], 0
v_mfma_f32_16x16x32_bf16 v[56:59], a[8:11], v[32:35], 0
v_mfma_f32_16x16x32_bf16 v[60:63], a[12:15], v[32:35], 0
v_mfma_f32_16x16x32_bf16 v[64:67], a[16:19], v[32:35], 0
v_mfma_f32_16x16x32_bf16 v[68:71], a[20:23], v[32:35], 0
v_mfma_f32_16x16x32_bf16 v[72:75], a[24:27], v[32:35], 0
v_mfma_f32_16x16x32_bf16 v[76:79], a[28:31], v[32:35], 0
s_waitcnt lgkmcnt(2)
v_mfma_f32_16x16x32_bf16 v[24:27], v[36:39], v[36:39], v[24:27]
v_mfma_f32_16x16x32_bf16 v[48:51], a[32:35], v[36:39], v[48:51]
v_mfma_f32_16x16x32_bf16 v[52:55], a[36:39], v[36:39], v[52:55]
v_mfma_f32_16x16x32_bf16 v[56:59], a[40:43], v[36:39], v[56:59]
v_mfma_f32_16x16x32_bf16 v[60:63], a[44:47], v[36:39], v[60:63]
v_mfma_f32_16x16x32_bf16 v[64:67], a[48:51], v[36:39], v[64:67]
v_mfma_f32_16x16x32_bf16 v[68:71], a[52:55], v[36:39], v[68:71]
v_mfma_f32_16x16x32_bf16 v[72:75], a[56:59], v[36:39], v[72:75]
v_mfma_f32_16x16x32_bf16 v[76:79], a[60:63], v[36:39], v[76:79]
s_waitcnt lgkmcnt(1)
v_mfma_f32_16x16x32_bf16 v[24:27], v[40:43], v[40:43], v[24:27]
v_mfma_f32_16x16x32_bf16 v[48:51], a[64:67], v[40:43], v[48:51]
v_mfma_f32_16x16x32_bf16 v[52:55], a[68:71], v[40:43], v[52:55]
v_mfma_f32_16x16x32_bf16 v[56:59], a[72:75], v[40:43], v[56:59]
v_mfma_f32_16x16x32_bf16 v[60:63], a[76:79], v[40:43], v[60:63]
v_mfma_f32_16x16x32_bf16 v[64:67], a[80:83], v[40:43], v[64:67]
v_mfma_f32_16x16x32_bf16 v[68:71], a[84:87], v[40:43], v[68:71]
v_mfma_f32_16x16x32_bf16 v[72:75], a[88:91], v[40:43], v[72:75]
v_mfma_f32_16x16x32_bf16 v[76:79], a[92:95], v[40:43], v[76:79]
s_waitcnt lgkmcnt(0)
v_mfma_f32_16x16x32_bf16 v[24:27], v[44:47], v[44:47], v[24:27]
v_mfma_f32_16x16x32_bf16 v[48:51], a[96:99], v[44:47], v[48:51]
v_mfma_f32_16x16x32_bf16 v[52:55], a[100:103], v[44:47], v[52:55]
v_mfma_f32_16x16x32_bf16 v[56:59], a[104:107], v[44:47], v[56:59]
s_mov_b64 exec, s[4:5]
s_nop 3
ds_write_b128 v12, v[24:27] offset:29184
s_mov_b64 exec, -1
v_mfma_f32_16x16x32_bf16 v[60:63], a[108:111], v[44:47], v[60:63]
s_mov_b64 exec, s[4:5]
ds_write_b128 v12, v[48:51] offset:28672
s_mov_b64 exec, -1
v_mfma_f32_16x16x32_bf16 v[64:67], a[112:115], v[44:47], v[64:67]
s_mov_b64 exec, s[4:5]
ds_write_b128 v12, v[52:55] offset:28688
s_mov_b64 exec, -1
v_mfma_f32_16x16x32_bf16 v[68:71], a[116:119], v[44:47], v[68:71]
s_mov_b64 exec, s[4:5]
ds_write_b128 v12, v[56:59] offset:28704
s_mov_b64 exec, -1
v_mfma_f32_16x16x32_bf16 v[72:75], a[120:123], v[44:47], v[72:75]
s_mov_b64 exec, s[4:5]
ds_write_b128 v12, v[60:63] offset:28720
s_mov_b64 exec, -1
v_mfma_f32_16x16x32_bf16 v[76:79], a[124:127], v[44:47], v[76:79]
s_mov_b64 exec, s[4:5]
ds_write_b128 v12, v[64:67] offset:28736
s_mov_b64 exec, -1
s_mov_b64 exec, s[4:5]
ds_write_b128 v12, v[68:71] offset:28752
ds_write_b128 v12, v[72:75] offset:28768
s_nop 1
ds_write_b128 v12, v[76:79] offset:28784
s_mov_b64 exec, -1
s_waitcnt lgkmcnt(0)
s_barrier
s_cmp_lg_u32 s40, s42
s_cbranch_scc1 Ld61
ds_read_b128 v[56:59], v30 offset:29184
ds_read_b128 v[60:63], v30 offset:30208
ds_read_b128 v[64:67], v30 offset:31232
ds_read_b128 v[68:71], v30 offset:32256
ds_read_b32 v48, v13 offset:28672
ds_read_b32 v49, v13 offset:28688
ds_read_b32 v50, v13 offset:29696
ds_read_b32 v51, v13 offset:29712
ds_read_b32 v52, v13 offset:30720
ds_read_b32 v53, v13 offset:30736
ds_read_b32 v54, v13 offset:31744
ds_read_b32 v55, v13 offset:31760
s_waitcnt lgkmcnt(8)
v_add_f32 v56, v56, v60
v_add_f32 v64, v64, v68
v_add_f32 v58, v58, v62
v_add_f32 v66, v66, v70
v_add_f32 v56, v56, v64
v_add_f32 v58, v58, v66
v_mul_f32 v60, 0x3b000000, v58
v_mul_f32 v56, 0x3b000000, v56
v_fma_f32 v56, -v60, v60, v56
v_max_f32 v56, 0, v56
v_add_f32 v56, 0x3727c5ac, v56
v_rsq_f32 v61, v56
s_waitcnt lgkmcnt(0)
v_pk_add_f32 v[48:49], v[48:49], v[50:51]
v_pk_add_f32 v[52:53], v[52:53], v[54:55]
v_pk_add_f32 v[48:49], v[48:49], v[52:53]
v_fma_f32 v48, -v60, v18, v48
v_fma_f32 v49, -v60, v19, v49
v_mul_f32 v48, v48, v61
v_mul_f32 v49, v49, v61
v_cvt_pk_bf16_f32 v48, v48, v49
v_min_u32 v48, -2, v48
s_cmp_lg_u64 s[62:63], 0
s_cbranch_scc1 Ld62
buffer_store_dword v48, v103, s[12:15], s91 offen offset:2048
s_branch Ld61
Ld62:
buffer_store_dword v48, v103, s[12:15], s91 offen offset:2048 sc1
Ld61:
s_cmp_lt_u32 s47, 2
s_cbranch_scc1 L_next
s_cmp_lg_u32 s40, 1
s_cbranch_scc1 L_next
L_last:
s_cmp_gt_u32 s40, 1
s_cbranch_scc1 L_next
s_cmp_eq_u32 s40, 1
s_cselect_b32 s68, s51, s50
s_cselect_b32 s69, s92, s90
ds_read_b64 v[24:25], v105 offset:15360
s_lshl_b32 s68, s68, 10
s_waitcnt lgkmcnt(0)
v_lshlrev_b32 v32, 16, v24
v_and_b32 v33, 0xffff0000, v24
v_lshlrev_b32 v34, 16, v25
v_and_b32 v35, 0xffff0000, v25
s_waitcnt vmcnt(0)
s_nop 0
Le63:
buffer_load_dwordx4 v[48:51], v104, s[12:15], s69 offen sc1
s_waitcnt vmcnt(0)
v_mfma_f32_16x16x32_bf16 v[28:31], v[88:91], v[48:51], 0
v_bitop3_b32 v26, v48, v49, s96 bitop3:0x7e
v_bitop3_b32 v27, v50, v51, s96 bitop3:0x7e
v_or_b32 v24, v26, v27
v_and_b32 v24, 1, v24
v_cmp_ne_u32 vcc, 0, v24
s_nop 1
s_cbranch_vccz Le64
s_sub_u32 s64, s64, 1
s_cmp_gt_i32 s64, 0
s_cbranch_scc1 Le63
Le64:
v_add_f32_dpp v28, v28, v28 row_ror:2 row_mask:0xf bank_mask:0xf
v_add_f32_dpp v29, v29, v29 row_ror:2 row_mask:0xf bank_mask:0xf
v_add_f32_dpp v30, v30, v30 row_ror:2 row_mask:0xf bank_mask:0xf
v_add_f32_dpp v31, v31, v31 row_ror:2 row_mask:0xf bank_mask:0xf
v_add_f32_dpp v28, v28, v28 row_ror:4 row_mask:0xf bank_mask:0xf
v_add_f32_dpp v29, v29, v29 row_ror:4 row_mask:0xf bank_mask:0xf
v_add_f32_dpp v30, v30, v30 row_ror:4 row_mask:0xf bank_mask:0xf
v_add_f32_dpp v31, v31, v31 row_ror:4 row_mask:0xf bank_mask:0xf
v_add_f32_dpp v28, v28, v28 row_ror:8 row_mask:0xf bank_mask:0xf
v_add_f32_dpp v29, v29, v29 row_ror:8 row_mask:0xf bank_mask:0xf
v_add_f32_dpp v30, v30, v30 row_ror:8 row_mask:0xf bank_mask:0xf
v_add_f32_dpp v31, v31, v31 row_ror:8 row_mask:0xf bank_mask:0xf
v_add_f32 v28, v28, v32
v_add_f32 v29, v29, v33
v_add_f32 v30, v30, v34
v_add_f32 v31, v31, v35
v_cvt_pk_bf16_f32 v28, v28, v29
v_cvt_pk_bf16_f32 v29, v30, v31
s_mov_b32 exec_lo, 0x30003
s_mov_b32 exec_hi, 0x0
buffer_store_short v28, v106, s[8:11], s68 offen
buffer_store_short_d16_hi v28, v106, s[8:11], s68 offen offset:16
buffer_store_short v29, v106, s[8:11], s68 offen offset:32
buffer_store_short_d16_hi v29, v106, s[8:11], s68 offen offset:48
s_mov_b64 exec, -1
L_next:
s_add_u32 s47, s47, 1
s_cmp_lt_u32 s47, 9
s_cbranch_scc1 L_job
L_end:
s_endpgm
L_code_end:
.section .rodata,"a"
.p2align 6
.amdhsa_kernel interleave_layers__gqa_block_cached__glu_gated_glu__decode_kernel
  .amdhsa_next_free_vgpr 512
  .amdhsa_next_free_sgpr 102
  .amdhsa_accum_offset 256
  .amdhsa_group_segment_fixed_size 0
  .amdhsa_kernarg_size 96
  .amdhsa_user_sgpr_count 2
  .amdhsa_user_sgpr_kernarg_segment_ptr 1
  .amdhsa_system_sgpr_workgroup_id_x 1
.end_amdhsa_kernel
```
